```python
import torch

def _softmax(x, axis=-1):
    return torch.softmax(x, dim=axis)
def _gelu(x):
    return torch.nn.functional.gelu(x, approximate="tanh")
def _silu(x):
    return torch.nn.functional.silu(x)
def _sigmoid(x):
    return torch.sigmoid(x)
def _layernorm(x, axis=-1, eps=1e-5):
    m = x.mean(dim=axis, keepdim=True)
    v = x.var(dim=axis, keepdim=True, unbiased=False)
    return (x - m) / torch.sqrt(v + eps)
def _scatter_add(tgt, idx, src, axis=0):
    return tgt.clone().index_add_(axis, idx, src)
def _segment_sum(src, seg, n):
    out = torch.zeros((n,) + src.shape[1:], dtype=src.dtype)
    return out.index_add_(0, seg, src)
def _pad(x, pw):
    flat = tuple(v for pair in reversed(pw) for v in pair)
    return torch.nn.functional.pad(x, flat)

kernel_name = 'sequential_preLN__sliding_block__glu_gated_bilinear__prompt'

def setup_inputs():

    _w = (lambda a: (lambda t: t.to(torch.bfloat16) if t.is_floating_point() else t)(torch.as_tensor(a)))
    def _A_setup():
        B, S, D = 1, 2048, 1024
        return {
            "x": _w((lambda *s: torch.randn(*s, dtype=torch.bfloat16) * 0.05)(B, S, D)),
            "wqkv": _w((lambda *s: torch.randn(*s, dtype=torch.bfloat16) * 0.05)(D, 3 * D)),
            "wo": _w((lambda *s: torch.randn(*s, dtype=torch.bfloat16) * 0.05)(D, D)),
        }
    _A_in = _A_setup()

    def _B_setup():
        B, S, D, F = 1, 2048, 1024, 3584
        return {
            "x": _w((lambda *s: torch.randn(*s, dtype=torch.bfloat16) * 0.05)(B, S, D)),
            "w_gate": _w((lambda *s: torch.randn(*s, dtype=torch.bfloat16) * 0.8)(D, F) * (D ** -0.5)),
            "w_up": _w((lambda *s: torch.randn(*s, dtype=torch.bfloat16) * 0.8)(D, F) * (D ** -0.5)),
            "w_down": _w((lambda *s: torch.randn(*s, dtype=torch.bfloat16) * 0.8)(F, D) * (F ** -0.5)),
        }
    _B_in = _B_setup()

    return {
        "A_x": _A_in["x"],
        "A_wqkv": _A_in["wqkv"],
        "A_wo": _A_in["wo"],
        "B_x": _B_in["x"],
        "B_w_gate": _B_in["w_gate"],
        "B_w_up": _B_in["w_up"],
        "B_w_down": _B_in["w_down"],
    }

def reference(A_x, A_wqkv, A_wo, B_x, B_w_gate, B_w_up, B_w_down):
    def _A_ref(x, wqkv, wo):
        B, S, D = x.shape
        H = 32; Dh = D // H; W = 256
        qkv = (lambda x, *d: x.permute(*d))((x @ wqkv).reshape(B, S, 3, H, Dh), 2, 0, 3, 1, 4)
        q, k, v = qkv[0], qkv[1], qkv[2]
        scores = torch.einsum("bhqd,bhkd->bhqk", q, k) * (Dh ** -0.5)
        idx = torch.arange(S)
        mask = (idx[:, None] - idx[None, :] >= 0) & (idx[:, None] - idx[None, :] < W)
        scores = torch.where(mask[None, None], scores, -1e9)
        p = _softmax(scores, axis=-1)
        o = torch.einsum("bhqk,bhkd->bhqd", p, v)
        return (lambda x, *d: x.permute(*d))(o, 0, 2, 1, 3).reshape(B, S, D) @ wo

    def _B_ref(x, w_gate, w_up, w_down):
        g = torch.einsum("bsd,df->bsf", x, w_gate)
        u = torch.einsum("bsd,df->bsf", x, w_up)
        h = g * u
        return torch.einsum("bsf,fd->bsd", h, w_down)

    x = A_x
    h = x + _A_ref(_layernorm(x, axis=-1), A_wqkv, A_wo)
    h2 = h + _B_ref(_layernorm(h, axis=-1), B_w_gate, B_w_up, B_w_down)
    return h2
```

```asm
; @launch grid=(256,1,1) block=(512,1,1) lds=163840
.amdgcn_target "amdgcn-amd-amdhsa--gfx950"
.text
.globl sequential_preLN__sliding_block__glu_gated_bilinear__prompt_kernel
.p2align 8
.type sequential_preLN__sliding_block__glu_gated_bilinear__prompt_kernel,@function
sequential_preLN__sliding_block__glu_gated_bilinear__prompt_kernel:

    s_cmp_ge_u32 s2, 256
    s_cbranch_scc1 L_end_sequential_preLN__sliding_block__glu_gated_bilinear__prompt_kernel
    s_load_dwordx16 s[64:79], s[0:1], 0
    s_load_dwordx4 s[80:83], s[0:1], 64
    v_lshrrev_b32 v1, 6, v0
    v_and_b32 v0, 63, v0
    s_nop 0
    v_readfirstlane_b32 s40, v1
    s_mov_b32 s62, 0

    s_and_b32 s3, s2, 7
    s_lshr_b32 s4, s2, 3
    s_and_b32 s5, s3, 1
    s_lshl_b32 s5, s5, 3
    s_and_b32 s6, s4, 7
    s_add_u32 s41, s5, s6
    s_lshr_b32 s5, s3, 1
    s_lshl_b32 s5, s5, 2
    s_lshr_b32 s6, s4, 3
    s_add_u32 s42, s5, s6

    s_waitcnt lgkmcnt(0)
    s_add_u32 s28, s82, 48234496
    s_addc_u32 s29, s83, 0
    s_mov_b32 s30, 1048576
    s_mov_b32 s31, 0x20000
    s_mov_b32 s8, s64
    s_mov_b32 s9, s65
    s_mov_b32 s10, 4194304
    s_mov_b32 s11, 0x20000
    s_mov_b32 s12, s66
    s_mov_b32 s13, s67
    s_mov_b32 s14, 6291456
    s_mov_b32 s15, 0x20000

    s_cmp_ge_u32 s40, 6
    s_cbranch_scc1 L_sequential_preLN__sliding_block__glu_gated_bilinear__prompt_kernel_Ahelp_2
    s_cmp_ge_u32 s40, 4
    s_cbranch_scc1 L_sequential_preLN__sliding_block__glu_gated_bilinear__prompt_kernel_Aload_1

    s_barrier

    s_lshr_b32 s43, s40, 1
    s_and_b32 s44, s40, 1
    v_and_b32 v112, 15, v0
    v_lshrrev_b32 v113, 4, v0
    v_lshrrev_b32 v114, 1, v112
    v_xor_b32 v114, v114, v113
    s_lshl_b32 s3, s43, 6
    v_add_u32 v112, s3, v112
    v_lshlrev_b32 v112, 7, v112
    v_lshl_add_u32 v96, v114, 4, v112
    v_xor_b32 v97, 64, v96
    v_add_u32 v98, 81920, v96
    v_add_u32 v99, 81920, v97
    v_lshrrev_b32 v112, 5, v0
    v_lshlrev_b32 v112, 4, v112
    v_bfe_u32 v113, v0, 4, 1
    v_lshl_add_u32 v112, v113, 2, v112
    v_bfe_u32 v113, v0, 2, 2
    v_add_u32 v112, v112, v113
    v_bfe_u32 v113, v112, 1, 2
    v_mul_u32_u24 v112, 384, v112
    v_and_b32 v114, 1, v0
    v_lshl_add_u32 v112, v114, 3, v112
    v_bfe_u32 v114, v0, 1, 1
    v_lshl_add_u32 v112, v114, 4, v112
    v_add_u32 v112, 16384, v112

    s_lshl_b32 s3, s44, 1
    s_add_u32 s3, s3, 0
    v_xor_b32 v114, s3, v113
    v_lshl_add_u32 v100, v114, 5, v112
    v_add_u32 v106, 81920, v100

    s_lshl_b32 s3, s44, 1
    s_add_u32 s3, s3, 1
    v_xor_b32 v114, s3, v113
    v_lshl_add_u32 v101, v114, 5, v112
    v_add_u32 v107, 81920, v101

    s_lshl_b32 s3, s44, 1
    s_add_u32 s3, s3, 4
    v_xor_b32 v114, s3, v113
    v_lshl_add_u32 v102, v114, 5, v112
    v_add_u32 v108, 81920, v102

    s_lshl_b32 s3, s44, 1
    s_add_u32 s3, s3, 5
    v_xor_b32 v114, s3, v113
    v_lshl_add_u32 v103, v114, 5, v112
    v_add_u32 v109, 81920, v103

    s_lshl_b32 s3, s44, 1
    s_add_u32 s3, s3, 8
    v_xor_b32 v114, s3, v113
    v_lshl_add_u32 v104, v114, 5, v112
    v_add_u32 v110, 81920, v104

    s_lshl_b32 s3, s44, 1
    s_add_u32 s3, s3, 9
    v_xor_b32 v114, s3, v113
    v_lshl_add_u32 v105, v114, 5, v112
    v_add_u32 v111, 81920, v105

    v_mbcnt_lo_u32_b32 v112, -1, 0
    v_mbcnt_hi_u32_b32 v112, -1, v112

    v_and_b32 v148, 15, v112
    v_lshrrev_b32 v149, 4, v112
    s_lshl_b32 s3, s43, 9
    s_add_u32 s3, s3, 122880
    v_lshl_add_u32 v156, v148, 3, s3
    s_lshl_b32 s3, s44, 7
    s_add_u32 s3, s3, 123904
    v_lshl_add_u32 v157, v149, 4, s3
    v_and_b32 v150, 1, v149
    v_lshlrev_b32 v150, 1, v150
    v_lshrrev_b32 v151, 1, v149
    v_or_b32 v150, v150, v151
    v_lshrrev_b32 v151, 2, v148
    v_sub_u32 v152, 0, v151
    v_and_b32 v152, 3, v152
    v_and_b32 v151, 1, v151
    v_lshlrev_b32 v151, 1, v151
    v_xor_b32 v152, v152, v150
    v_xor_b32 v153, v151, v150
    v_lshlrev_b32 v151, 6, v148
    v_lshl_add_u32 v152, v152, 4, v151
    v_lshl_add_u32 v153, v153, 4, v151
    s_lshl_b32 s3, s41, 7
    s_lshl_b32 s4, s43, 6
    s_add_u32 s3, s3, s4
    v_add_u32 v154, s3, v148
    v_lshlrev_b32 v154, 6, v154
    v_lshl_add_u32 v154, v150, 4, v154
    s_lshl_b32 s3, s42, 1
    s_add_u32 s3, s3, s44
    s_add_u32 s4, s3, 32
    s_lshl_b32 s47, s4, 17
    s_add_u32 s4, s3, 64
    s_lshl_b32 s48, s4, 17
    s_lshl_b32 s6, s43, 12
    s_mul_i32 s7, s44, 24576
    s_add_u32 s7, s7, s6
    s_add_u32 s49, s7, 16384
    s_add_u32 s50, s49, 49152
    s_lshl_b32 s7, s44, 13
    s_add_u32 s7, s7, s6
    s_add_u32 s51, s7, 124928
    v_add_u32 v153, s50, v153
    v_add_u32 v155, s51, v152
    v_add_u32 v152, s49, v152
    s_mov_b32 s52, 1048744942

    s_add_u32 s16, s82, 4194304
    s_addc_u32 s17, s83, 0
    s_mov_b32 s18, 12582912
    s_mov_b32 s19, 0x20000
    s_barrier
    ds_read_b128 a[0:3], v96 offset:0
    ds_read_b128 a[4:7], v96 offset:2048
    ds_read_b128 a[8:11], v96 offset:4096
    ds_read_b128 a[12:15], v96 offset:6144
    ds_read_b64_tr_b16 a[32:33], v100 offset:0
    ds_read_b64_tr_b16 a[34:35], v100 offset:3072
    ds_read_b64_tr_b16 a[36:37], v101 offset:0
    ds_read_b64_tr_b16 a[38:39], v101 offset:3072
    ds_read_b64_tr_b16 a[40:41], v102 offset:0
    ds_read_b64_tr_b16 a[42:43], v102 offset:3072
    ds_read_b64_tr_b16 a[44:45], v103 offset:0
    ds_read_b64_tr_b16 a[46:47], v103 offset:3072
    ds_read_b64_tr_b16 a[48:49], v104 offset:0
    ds_read_b64_tr_b16 a[50:51], v104 offset:3072
    ds_read_b64_tr_b16 a[52:53], v105 offset:0
    ds_read_b64_tr_b16 a[54:55], v105 offset:3072
    s_waitcnt lgkmcnt(0)
    v_mfma_f32_16x16x32_bf16 v[0:3], a[32:35], a[0:3], 0
    ds_read_b128 a[16:19], v97 offset:0
    v_mfma_f32_16x16x32_bf16 v[4:7], a[32:35], a[4:7], 0
    ds_read_b128 a[20:23], v97 offset:2048
    v_mfma_f32_16x16x32_bf16 v[8:11], a[32:35], a[8:11], 0
    ds_read_b128 a[24:27], v97 offset:4096
    v_mfma_f32_16x16x32_bf16 v[12:15], a[32:35], a[12:15], 0
    ds_read_b128 a[28:31], v97 offset:6144
    v_mfma_f32_16x16x32_bf16 v[28:31], a[36:39], a[12:15], 0
    ds_read_b64_tr_b16 a[56:57], v100 offset:12288
    v_mfma_f32_16x16x32_bf16 v[24:27], a[36:39], a[8:11], 0
    ds_read_b64_tr_b16 a[58:59], v100 offset:15360
    v_mfma_f32_16x16x32_bf16 v[20:23], a[36:39], a[4:7], 0
    ds_read_b64_tr_b16 a[60:61], v101 offset:12288
    v_mfma_f32_16x16x32_bf16 v[16:19], a[36:39], a[0:3], 0
    ds_read_b64_tr_b16 a[62:63], v101 offset:15360
    v_mfma_f32_16x16x32_bf16 v[32:35], a[40:43], a[0:3], 0
    ds_read_b64_tr_b16 a[64:65], v102 offset:12288
    v_mfma_f32_16x16x32_bf16 v[36:39], a[40:43], a[4:7], 0
    ds_read_b64_tr_b16 a[66:67], v102 offset:15360
    v_mfma_f32_16x16x32_bf16 v[40:43], a[40:43], a[8:11], 0
    ds_read_b64_tr_b16 a[68:69], v103 offset:12288
    v_mfma_f32_16x16x32_bf16 v[44:47], a[40:43], a[12:15], 0
    ds_read_b64_tr_b16 a[70:71], v103 offset:15360
    v_mfma_f32_16x16x32_bf16 v[60:63], a[44:47], a[12:15], 0
    ds_read_b64_tr_b16 a[72:73], v104 offset:12288
    v_mfma_f32_16x16x32_bf16 v[56:59], a[44:47], a[8:11], 0
    ds_read_b64_tr_b16 a[74:75], v104 offset:15360
    v_mfma_f32_16x16x32_bf16 v[52:55], a[44:47], a[4:7], 0
    ds_read_b64_tr_b16 a[76:77], v105 offset:12288
    v_mfma_f32_16x16x32_bf16 v[48:51], a[44:47], a[0:3], 0
    ds_read_b64_tr_b16 a[78:79], v105 offset:15360
    v_mfma_f32_16x16x32_bf16 v[64:67], a[48:51], a[0:3], 0
    v_mfma_f32_16x16x32_bf16 v[68:71], a[48:51], a[4:7], 0
    v_mfma_f32_16x16x32_bf16 v[72:75], a[48:51], a[8:11], 0
    v_mfma_f32_16x16x32_bf16 v[76:79], a[48:51], a[12:15], 0
    v_mfma_f32_16x16x32_bf16 v[92:95], a[52:55], a[12:15], 0
    v_mfma_f32_16x16x32_bf16 v[88:91], a[52:55], a[8:11], 0
    v_mfma_f32_16x16x32_bf16 v[84:87], a[52:55], a[4:7], 0
    v_mfma_f32_16x16x32_bf16 v[80:83], a[52:55], a[0:3], 0
    s_waitcnt lgkmcnt(0)
    s_barrier
    v_mfma_f32_16x16x32_bf16 v[0:3], a[56:59], a[16:19], v[0:3]
    ds_read_b128 a[0:3], v96 offset:40960
    v_mfma_f32_16x16x32_bf16 v[4:7], a[56:59], a[20:23], v[4:7]
    ds_read_b128 a[4:7], v96 offset:43008
    v_mfma_f32_16x16x32_bf16 v[8:11], a[56:59], a[24:27], v[8:11]
    ds_read_b128 a[8:11], v96 offset:45056
    v_mfma_f32_16x16x32_bf16 v[12:15], a[56:59], a[28:31], v[12:15]
    ds_read_b128 a[12:15], v96 offset:47104
    v_mfma_f32_16x16x32_bf16 v[28:31], a[60:63], a[28:31], v[28:31]
    ds_read_b64_tr_b16 a[32:33], v100 offset:40960
    v_mfma_f32_16x16x32_bf16 v[24:27], a[60:63], a[24:27], v[24:27]
    ds_read_b64_tr_b16 a[34:35], v100 offset:44032
    v_mfma_f32_16x16x32_bf16 v[20:23], a[60:63], a[20:23], v[20:23]
    ds_read_b64_tr_b16 a[36:37], v101 offset:40960
    v_mfma_f32_16x16x32_bf16 v[16:19], a[60:63], a[16:19], v[16:19]
    ds_read_b64_tr_b16 a[38:39], v101 offset:44032
    v_mfma_f32_16x16x32_bf16 v[32:35], a[64:67], a[16:19], v[32:35]
    ds_read_b64_tr_b16 a[40:41], v102 offset:40960
    v_mfma_f32_16x16x32_bf16 v[36:39], a[64:67], a[20:23], v[36:39]
    ds_read_b64_tr_b16 a[42:43], v102 offset:44032
    v_mfma_f32_16x16x32_bf16 v[40:43], a[64:67], a[24:27], v[40:43]
    ds_read_b64_tr_b16 a[44:45], v103 offset:40960
    v_mfma_f32_16x16x32_bf16 v[44:47], a[64:67], a[28:31], v[44:47]
    ds_read_b64_tr_b16 a[46:47], v103 offset:44032
    v_mfma_f32_16x16x32_bf16 v[60:63], a[68:71], a[28:31], v[60:63]
    ds_read_b64_tr_b16 a[48:49], v104 offset:40960
    v_mfma_f32_16x16x32_bf16 v[56:59], a[68:71], a[24:27], v[56:59]
    ds_read_b64_tr_b16 a[50:51], v104 offset:44032
    v_mfma_f32_16x16x32_bf16 v[52:55], a[68:71], a[20:23], v[52:55]
    ds_read_b64_tr_b16 a[52:53], v105 offset:40960
    v_mfma_f32_16x16x32_bf16 v[48:51], a[68:71], a[16:19], v[48:51]
    ds_read_b64_tr_b16 a[54:55], v105 offset:44032
    v_mfma_f32_16x16x32_bf16 v[64:67], a[72:75], a[16:19], v[64:67]
    v_mfma_f32_16x16x32_bf16 v[68:71], a[72:75], a[20:23], v[68:71]
    v_mfma_f32_16x16x32_bf16 v[72:75], a[72:75], a[24:27], v[72:75]
    v_mfma_f32_16x16x32_bf16 v[76:79], a[72:75], a[28:31], v[76:79]
    v_mfma_f32_16x16x32_bf16 v[92:95], a[76:79], a[28:31], v[92:95]
    v_mfma_f32_16x16x32_bf16 v[88:91], a[76:79], a[24:27], v[88:91]
    v_mfma_f32_16x16x32_bf16 v[84:87], a[76:79], a[20:23], v[84:87]
    v_mfma_f32_16x16x32_bf16 v[80:83], a[76:79], a[16:19], v[80:83]
    s_waitcnt lgkmcnt(0)
    v_mfma_f32_16x16x32_bf16 v[0:3], a[32:35], a[0:3], v[0:3]
    ds_read_b128 a[16:19], v97 offset:40960
    v_mfma_f32_16x16x32_bf16 v[4:7], a[32:35], a[4:7], v[4:7]
    ds_read_b128 a[20:23], v97 offset:43008
    v_mfma_f32_16x16x32_bf16 v[8:11], a[32:35], a[8:11], v[8:11]
    ds_read_b128 a[24:27], v97 offset:45056
    v_mfma_f32_16x16x32_bf16 v[12:15], a[32:35], a[12:15], v[12:15]
    ds_read_b128 a[28:31], v97 offset:47104
    v_mfma_f32_16x16x32_bf16 v[28:31], a[36:39], a[12:15], v[28:31]
    ds_read_b64_tr_b16 a[56:57], v100 offset:53248
    v_mfma_f32_16x16x32_bf16 v[24:27], a[36:39], a[8:11], v[24:27]
    ds_read_b64_tr_b16 a[58:59], v100 offset:56320
    v_mfma_f32_16x16x32_bf16 v[20:23], a[36:39], a[4:7], v[20:23]
    ds_read_b64_tr_b16 a[60:61], v101 offset:53248
    v_mfma_f32_16x16x32_bf16 v[16:19], a[36:39], a[0:3], v[16:19]
    ds_read_b64_tr_b16 a[62:63], v101 offset:56320
    v_mfma_f32_16x16x32_bf16 v[32:35], a[40:43], a[0:3], v[32:35]
    ds_read_b64_tr_b16 a[64:65], v102 offset:53248
    v_mfma_f32_16x16x32_bf16 v[36:39], a[40:43], a[4:7], v[36:39]
    ds_read_b64_tr_b16 a[66:67], v102 offset:56320
    v_mfma_f32_16x16x32_bf16 v[40:43], a[40:43], a[8:11], v[40:43]
    ds_read_b64_tr_b16 a[68:69], v103 offset:53248
    v_mfma_f32_16x16x32_bf16 v[44:47], a[40:43], a[12:15], v[44:47]
    ds_read_b64_tr_b16 a[70:71], v103 offset:56320
    v_mfma_f32_16x16x32_bf16 v[60:63], a[44:47], a[12:15], v[60:63]
    ds_read_b64_tr_b16 a[72:73], v104 offset:53248
    v_mfma_f32_16x16x32_bf16 v[56:59], a[44:47], a[8:11], v[56:59]
    ds_read_b64_tr_b16 a[74:75], v104 offset:56320
    v_mfma_f32_16x16x32_bf16 v[52:55], a[44:47], a[4:7], v[52:55]
    ds_read_b64_tr_b16 a[76:77], v105 offset:53248
    v_mfma_f32_16x16x32_bf16 v[48:51], a[44:47], a[0:3], v[48:51]
    ds_read_b64_tr_b16 a[78:79], v105 offset:56320
    v_mfma_f32_16x16x32_bf16 v[64:67], a[48:51], a[0:3], v[64:67]
    v_mfma_f32_16x16x32_bf16 v[68:71], a[48:51], a[4:7], v[68:71]
    v_mfma_f32_16x16x32_bf16 v[72:75], a[48:51], a[8:11], v[72:75]
    v_mfma_f32_16x16x32_bf16 v[76:79], a[48:51], a[12:15], v[76:79]
    v_mfma_f32_16x16x32_bf16 v[92:95], a[52:55], a[12:15], v[92:95]
    v_mfma_f32_16x16x32_bf16 v[88:91], a[52:55], a[8:11], v[88:91]
    v_mfma_f32_16x16x32_bf16 v[84:87], a[52:55], a[4:7], v[84:87]
    v_mfma_f32_16x16x32_bf16 v[80:83], a[52:55], a[0:3], v[80:83]
    s_waitcnt lgkmcnt(0)
    s_barrier
    v_mfma_f32_16x16x32_bf16 v[0:3], a[56:59], a[16:19], v[0:3]
    ds_read_b128 a[0:3], v98 offset:0
    v_mfma_f32_16x16x32_bf16 v[4:7], a[56:59], a[20:23], v[4:7]
    ds_read_b128 a[4:7], v98 offset:2048
    v_mfma_f32_16x16x32_bf16 v[8:11], a[56:59], a[24:27], v[8:11]
    ds_read_b128 a[8:11], v98 offset:4096
    v_mfma_f32_16x16x32_bf16 v[12:15], a[56:59], a[28:31], v[12:15]
    ds_read_b128 a[12:15], v98 offset:6144
    v_mfma_f32_16x16x32_bf16 v[28:31], a[60:63], a[28:31], v[28:31]
    ds_read_b64_tr_b16 a[32:33], v106 offset:0
    v_mfma_f32_16x16x32_bf16 v[24:27], a[60:63], a[24:27], v[24:27]
    ds_read_b64_tr_b16 a[34:35], v106 offset:3072
    v_mfma_f32_16x16x32_bf16 v[20:23], a[60:63], a[20:23], v[20:23]
    ds_read_b64_tr_b16 a[36:37], v107 offset:0
    v_mfma_f32_16x16x32_bf16 v[16:19], a[60:63], a[16:19], v[16:19]
    ds_read_b64_tr_b16 a[38:39], v107 offset:3072
    v_mfma_f32_16x16x32_bf16 v[32:35], a[64:67], a[16:19], v[32:35]
    ds_read_b64_tr_b16 a[40:41], v108 offset:0
    v_mfma_f32_16x16x32_bf16 v[36:39], a[64:67], a[20:23], v[36:39]
    ds_read_b64_tr_b16 a[42:43], v108 offset:3072
    v_mfma_f32_16x16x32_bf16 v[40:43], a[64:67], a[24:27], v[40:43]
    ds_read_b64_tr_b16 a[44:45], v109 offset:0
    v_mfma_f32_16x16x32_bf16 v[44:47], a[64:67], a[28:31], v[44:47]
    ds_read_b64_tr_b16 a[46:47], v109 offset:3072
    v_mfma_f32_16x16x32_bf16 v[60:63], a[68:71], a[28:31], v[60:63]
    ds_read_b64_tr_b16 a[48:49], v110 offset:0
    v_mfma_f32_16x16x32_bf16 v[56:59], a[68:71], a[24:27], v[56:59]
    ds_read_b64_tr_b16 a[50:51], v110 offset:3072
    v_mfma_f32_16x16x32_bf16 v[52:55], a[68:71], a[20:23], v[52:55]
    ds_read_b64_tr_b16 a[52:53], v111 offset:0
    v_mfma_f32_16x16x32_bf16 v[48:51], a[68:71], a[16:19], v[48:51]
    ds_read_b64_tr_b16 a[54:55], v111 offset:3072
    v_mfma_f32_16x16x32_bf16 v[64:67], a[72:75], a[16:19], v[64:67]
    v_mfma_f32_16x16x32_bf16 v[68:71], a[72:75], a[20:23], v[68:71]
    v_mfma_f32_16x16x32_bf16 v[72:75], a[72:75], a[24:27], v[72:75]
    v_mfma_f32_16x16x32_bf16 v[76:79], a[72:75], a[28:31], v[76:79]
    v_mfma_f32_16x16x32_bf16 v[92:95], a[76:79], a[28:31], v[92:95]
    v_mfma_f32_16x16x32_bf16 v[88:91], a[76:79], a[24:27], v[88:91]
    v_mfma_f32_16x16x32_bf16 v[84:87], a[76:79], a[20:23], v[84:87]
    v_mfma_f32_16x16x32_bf16 v[80:83], a[76:79], a[16:19], v[80:83]
    s_waitcnt lgkmcnt(0)
    v_mfma_f32_16x16x32_bf16 v[0:3], a[32:35], a[0:3], v[0:3]
    ds_read_b128 a[16:19], v99 offset:0
    v_mfma_f32_16x16x32_bf16 v[4:7], a[32:35], a[4:7], v[4:7]
    ds_read_b128 a[20:23], v99 offset:2048
    v_mfma_f32_16x16x32_bf16 v[8:11], a[32:35], a[8:11], v[8:11]
    ds_read_b128 a[24:27], v99 offset:4096
    v_mfma_f32_16x16x32_bf16 v[12:15], a[32:35], a[12:15], v[12:15]
    ds_read_b128 a[28:31], v99 offset:6144
    v_mfma_f32_16x16x32_bf16 v[28:31], a[36:39], a[12:15], v[28:31]
    ds_read_b64_tr_b16 a[56:57], v106 offset:12288
    v_mfma_f32_16x16x32_bf16 v[24:27], a[36:39], a[8:11], v[24:27]
    ds_read_b64_tr_b16 a[58:59], v106 offset:15360
    v_mfma_f32_16x16x32_bf16 v[20:23], a[36:39], a[4:7], v[20:23]
    ds_read_b64_tr_b16 a[60:61], v107 offset:12288
    v_mfma_f32_16x16x32_bf16 v[16:19], a[36:39], a[0:3], v[16:19]
    ds_read_b64_tr_b16 a[62:63], v107 offset:15360
    v_mfma_f32_16x16x32_bf16 v[32:35], a[40:43], a[0:3], v[32:35]
    ds_read_b64_tr_b16 a[64:65], v108 offset:12288
    v_mfma_f32_16x16x32_bf16 v[36:39], a[40:43], a[4:7], v[36:39]
    ds_read_b64_tr_b16 a[66:67], v108 offset:15360
    v_mfma_f32_16x16x32_bf16 v[40:43], a[40:43], a[8:11], v[40:43]
    ds_read_b64_tr_b16 a[68:69], v109 offset:12288
    v_mfma_f32_16x16x32_bf16 v[44:47], a[40:43], a[12:15], v[44:47]
    ds_read_b64_tr_b16 a[70:71], v109 offset:15360
    v_mfma_f32_16x16x32_bf16 v[60:63], a[44:47], a[12:15], v[60:63]
    ds_read_b64_tr_b16 a[72:73], v110 offset:12288
    v_mfma_f32_16x16x32_bf16 v[56:59], a[44:47], a[8:11], v[56:59]
    ds_read_b64_tr_b16 a[74:75], v110 offset:15360
    v_mfma_f32_16x16x32_bf16 v[52:55], a[44:47], a[4:7], v[52:55]
    ds_read_b64_tr_b16 a[76:77], v111 offset:12288
    v_mfma_f32_16x16x32_bf16 v[48:51], a[44:47], a[0:3], v[48:51]
    ds_read_b64_tr_b16 a[78:79], v111 offset:15360
    v_mfma_f32_16x16x32_bf16 v[64:67], a[48:51], a[0:3], v[64:67]
    v_mfma_f32_16x16x32_bf16 v[68:71], a[48:51], a[4:7], v[68:71]
    v_mfma_f32_16x16x32_bf16 v[72:75], a[48:51], a[8:11], v[72:75]
    v_mfma_f32_16x16x32_bf16 v[76:79], a[48:51], a[12:15], v[76:79]
    v_mfma_f32_16x16x32_bf16 v[92:95], a[52:55], a[12:15], v[92:95]
    v_mfma_f32_16x16x32_bf16 v[88:91], a[52:55], a[8:11], v[88:91]
    v_mfma_f32_16x16x32_bf16 v[84:87], a[52:55], a[4:7], v[84:87]
    v_mfma_f32_16x16x32_bf16 v[80:83], a[52:55], a[0:3], v[80:83]
    s_waitcnt lgkmcnt(0)
    s_barrier
    v_mfma_f32_16x16x32_bf16 v[0:3], a[56:59], a[16:19], v[0:3]
    ds_read_b128 a[0:3], v96 offset:0
    v_mfma_f32_16x16x32_bf16 v[4:7], a[56:59], a[20:23], v[4:7]
    ds_read_b128 a[4:7], v96 offset:2048
    v_mfma_f32_16x16x32_bf16 v[8:11], a[56:59], a[24:27], v[8:11]
    ds_read_b128 a[8:11], v96 offset:4096
    v_mfma_f32_16x16x32_bf16 v[12:15], a[56:59], a[28:31], v[12:15]
    ds_read_b128 a[12:15], v96 offset:6144
    v_mfma_f32_16x16x32_bf16 v[28:31], a[60:63], a[28:31], v[28:31]
    ds_read_b64_tr_b16 a[32:33], v100 offset:0
    v_mfma_f32_16x16x32_bf16 v[24:27], a[60:63], a[24:27], v[24:27]
    ds_read_b64_tr_b16 a[34:35], v100 offset:3072
    v_mfma_f32_16x16x32_bf16 v[20:23], a[60:63], a[20:23], v[20:23]
    ds_read_b64_tr_b16 a[36:37], v101 offset:0
    v_mfma_f32_16x16x32_bf16 v[16:19], a[60:63], a[16:19], v[16:19]
    ds_read_b64_tr_b16 a[38:39], v101 offset:3072
    v_mfma_f32_16x16x32_bf16 v[32:35], a[64:67], a[16:19], v[32:35]
    ds_read_b64_tr_b16 a[40:41], v102 offset:0
    v_mfma_f32_16x16x32_bf16 v[36:39], a[64:67], a[20:23], v[36:39]
    ds_read_b64_tr_b16 a[42:43], v102 offset:3072
    v_mfma_f32_16x16x32_bf16 v[40:43], a[64:67], a[24:27], v[40:43]
    ds_read_b64_tr_b16 a[44:45], v103 offset:0
    v_mfma_f32_16x16x32_bf16 v[44:47], a[64:67], a[28:31], v[44:47]
    ds_read_b64_tr_b16 a[46:47], v103 offset:3072
    v_mfma_f32_16x16x32_bf16 v[60:63], a[68:71], a[28:31], v[60:63]
    ds_read_b64_tr_b16 a[48:49], v104 offset:0
    v_mfma_f32_16x16x32_bf16 v[56:59], a[68:71], a[24:27], v[56:59]
    ds_read_b64_tr_b16 a[50:51], v104 offset:3072
    v_mfma_f32_16x16x32_bf16 v[52:55], a[68:71], a[20:23], v[52:55]
    ds_read_b64_tr_b16 a[52:53], v105 offset:0
    v_mfma_f32_16x16x32_bf16 v[48:51], a[68:71], a[16:19], v[48:51]
    ds_read_b64_tr_b16 a[54:55], v105 offset:3072
    v_mfma_f32_16x16x32_bf16 v[64:67], a[72:75], a[16:19], v[64:67]
    v_mfma_f32_16x16x32_bf16 v[68:71], a[72:75], a[20:23], v[68:71]
    v_mfma_f32_16x16x32_bf16 v[72:75], a[72:75], a[24:27], v[72:75]
    v_mfma_f32_16x16x32_bf16 v[76:79], a[72:75], a[28:31], v[76:79]
    v_mfma_f32_16x16x32_bf16 v[92:95], a[76:79], a[28:31], v[92:95]
    v_mfma_f32_16x16x32_bf16 v[88:91], a[76:79], a[24:27], v[88:91]
    v_mfma_f32_16x16x32_bf16 v[84:87], a[76:79], a[20:23], v[84:87]
    v_mfma_f32_16x16x32_bf16 v[80:83], a[76:79], a[16:19], v[80:83]
    s_waitcnt lgkmcnt(0)
    s_mov_b32 s46, 1
L_sequential_preLN__sliding_block__glu_gated_bilinear__prompt_kernel_Acloop_4:
    v_mfma_f32_16x16x32_bf16 v[0:3], a[32:35], a[0:3], v[0:3]
    ds_read_b128 a[16:19], v97 offset:0
    v_mfma_f32_16x16x32_bf16 v[4:7], a[32:35], a[4:7], v[4:7]
    ds_read_b128 a[20:23], v97 offset:2048
    v_mfma_f32_16x16x32_bf16 v[8:11], a[32:35], a[8:11], v[8:11]
    ds_read_b128 a[24:27], v97 offset:4096
    v_mfma_f32_16x16x32_bf16 v[12:15], a[32:35], a[12:15], v[12:15]
    ds_read_b128 a[28:31], v97 offset:6144
    v_mfma_f32_16x16x32_bf16 v[28:31], a[36:39], a[12:15], v[28:31]
    ds_read_b64_tr_b16 a[56:57], v100 offset:12288
    v_mfma_f32_16x16x32_bf16 v[24:27], a[36:39], a[8:11], v[24:27]
    ds_read_b64_tr_b16 a[58:59], v100 offset:15360
    v_mfma_f32_16x16x32_bf16 v[20:23], a[36:39], a[4:7], v[20:23]
    ds_read_b64_tr_b16 a[60:61], v101 offset:12288
    v_mfma_f32_16x16x32_bf16 v[16:19], a[36:39], a[0:3], v[16:19]
    ds_read_b64_tr_b16 a[62:63], v101 offset:15360
    v_mfma_f32_16x16x32_bf16 v[32:35], a[40:43], a[0:3], v[32:35]
    ds_read_b64_tr_b16 a[64:65], v102 offset:12288
    v_mfma_f32_16x16x32_bf16 v[36:39], a[40:43], a[4:7], v[36:39]
    ds_read_b64_tr_b16 a[66:67], v102 offset:15360
    v_mfma_f32_16x16x32_bf16 v[40:43], a[40:43], a[8:11], v[40:43]
    ds_read_b64_tr_b16 a[68:69], v103 offset:12288
    v_mfma_f32_16x16x32_bf16 v[44:47], a[40:43], a[12:15], v[44:47]
    ds_read_b64_tr_b16 a[70:71], v103 offset:15360
    v_mfma_f32_16x16x32_bf16 v[60:63], a[44:47], a[12:15], v[60:63]
    ds_read_b64_tr_b16 a[72:73], v104 offset:12288
    v_mfma_f32_16x16x32_bf16 v[56:59], a[44:47], a[8:11], v[56:59]
    ds_read_b64_tr_b16 a[74:75], v104 offset:15360
    v_mfma_f32_16x16x32_bf16 v[52:55], a[44:47], a[4:7], v[52:55]
    ds_read_b64_tr_b16 a[76:77], v105 offset:12288
    v_mfma_f32_16x16x32_bf16 v[48:51], a[44:47], a[0:3], v[48:51]
    ds_read_b64_tr_b16 a[78:79], v105 offset:15360
    v_mfma_f32_16x16x32_bf16 v[64:67], a[48:51], a[0:3], v[64:67]
    v_mfma_f32_16x16x32_bf16 v[68:71], a[48:51], a[4:7], v[68:71]
    v_mfma_f32_16x16x32_bf16 v[72:75], a[48:51], a[8:11], v[72:75]
    v_mfma_f32_16x16x32_bf16 v[76:79], a[48:51], a[12:15], v[76:79]
    v_mfma_f32_16x16x32_bf16 v[92:95], a[52:55], a[12:15], v[92:95]
    v_mfma_f32_16x16x32_bf16 v[88:91], a[52:55], a[8:11], v[88:91]
    v_mfma_f32_16x16x32_bf16 v[84:87], a[52:55], a[4:7], v[84:87]
    v_mfma_f32_16x16x32_bf16 v[80:83], a[52:55], a[0:3], v[80:83]
    s_waitcnt lgkmcnt(0)
    s_barrier
    v_mfma_f32_16x16x32_bf16 v[0:3], a[56:59], a[16:19], v[0:3]
    ds_read_b128 a[0:3], v96 offset:40960
    v_mfma_f32_16x16x32_bf16 v[4:7], a[56:59], a[20:23], v[4:7]
    ds_read_b128 a[4:7], v96 offset:43008
    v_mfma_f32_16x16x32_bf16 v[8:11], a[56:59], a[24:27], v[8:11]
    ds_read_b128 a[8:11], v96 offset:45056
    v_mfma_f32_16x16x32_bf16 v[12:15], a[56:59], a[28:31], v[12:15]
    ds_read_b128 a[12:15], v96 offset:47104
    v_mfma_f32_16x16x32_bf16 v[28:31], a[60:63], a[28:31], v[28:31]
    ds_read_b64_tr_b16 a[32:33], v100 offset:40960
    v_mfma_f32_16x16x32_bf16 v[24:27], a[60:63], a[24:27], v[24:27]
    ds_read_b64_tr_b16 a[34:35], v100 offset:44032
    v_mfma_f32_16x16x32_bf16 v[20:23], a[60:63], a[20:23], v[20:23]
    ds_read_b64_tr_b16 a[36:37], v101 offset:40960
    v_mfma_f32_16x16x32_bf16 v[16:19], a[60:63], a[16:19], v[16:19]
    ds_read_b64_tr_b16 a[38:39], v101 offset:44032
    v_mfma_f32_16x16x32_bf16 v[32:35], a[64:67], a[16:19], v[32:35]
    ds_read_b64_tr_b16 a[40:41], v102 offset:40960
    v_mfma_f32_16x16x32_bf16 v[36:39], a[64:67], a[20:23], v[36:39]
    ds_read_b64_tr_b16 a[42:43], v102 offset:44032
    v_mfma_f32_16x16x32_bf16 v[40:43], a[64:67], a[24:27], v[40:43]
    ds_read_b64_tr_b16 a[44:45], v103 offset:40960
    v_mfma_f32_16x16x32_bf16 v[44:47], a[64:67], a[28:31], v[44:47]
    ds_read_b64_tr_b16 a[46:47], v103 offset:44032
    v_mfma_f32_16x16x32_bf16 v[60:63], a[68:71], a[28:31], v[60:63]
    ds_read_b64_tr_b16 a[48:49], v104 offset:40960
    v_mfma_f32_16x16x32_bf16 v[56:59], a[68:71], a[24:27], v[56:59]
    ds_read_b64_tr_b16 a[50:51], v104 offset:44032
    v_mfma_f32_16x16x32_bf16 v[52:55], a[68:71], a[20:23], v[52:55]
    ds_read_b64_tr_b16 a[52:53], v105 offset:40960
    v_mfma_f32_16x16x32_bf16 v[48:51], a[68:71], a[16:19], v[48:51]
    ds_read_b64_tr_b16 a[54:55], v105 offset:44032
    v_mfma_f32_16x16x32_bf16 v[64:67], a[72:75], a[16:19], v[64:67]
    v_mfma_f32_16x16x32_bf16 v[68:71], a[72:75], a[20:23], v[68:71]
    v_mfma_f32_16x16x32_bf16 v[72:75], a[72:75], a[24:27], v[72:75]
    v_mfma_f32_16x16x32_bf16 v[76:79], a[72:75], a[28:31], v[76:79]
    v_mfma_f32_16x16x32_bf16 v[92:95], a[76:79], a[28:31], v[92:95]
    v_mfma_f32_16x16x32_bf16 v[88:91], a[76:79], a[24:27], v[88:91]
    v_mfma_f32_16x16x32_bf16 v[84:87], a[76:79], a[20:23], v[84:87]
    v_mfma_f32_16x16x32_bf16 v[80:83], a[76:79], a[16:19], v[80:83]
    s_waitcnt lgkmcnt(0)
    v_mfma_f32_16x16x32_bf16 v[0:3], a[32:35], a[0:3], v[0:3]
    ds_read_b128 a[16:19], v97 offset:40960
    v_mfma_f32_16x16x32_bf16 v[4:7], a[32:35], a[4:7], v[4:7]
    ds_read_b128 a[20:23], v97 offset:43008
    v_mfma_f32_16x16x32_bf16 v[8:11], a[32:35], a[8:11], v[8:11]
    ds_read_b128 a[24:27], v97 offset:45056
    v_mfma_f32_16x16x32_bf16 v[12:15], a[32:35], a[12:15], v[12:15]
    ds_read_b128 a[28:31], v97 offset:47104
    v_mfma_f32_16x16x32_bf16 v[28:31], a[36:39], a[12:15], v[28:31]
    ds_read_b64_tr_b16 a[56:57], v100 offset:53248
    v_mfma_f32_16x16x32_bf16 v[24:27], a[36:39], a[8:11], v[24:27]
    ds_read_b64_tr_b16 a[58:59], v100 offset:56320
    v_mfma_f32_16x16x32_bf16 v[20:23], a[36:39], a[4:7], v[20:23]
    ds_read_b64_tr_b16 a[60:61], v101 offset:53248
    v_mfma_f32_16x16x32_bf16 v[16:19], a[36:39], a[0:3], v[16:19]
    ds_read_b64_tr_b16 a[62:63], v101 offset:56320
    v_mfma_f32_16x16x32_bf16 v[32:35], a[40:43], a[0:3], v[32:35]
    ds_read_b64_tr_b16 a[64:65], v102 offset:53248
    v_mfma_f32_16x16x32_bf16 v[36:39], a[40:43], a[4:7], v[36:39]
    ds_read_b64_tr_b16 a[66:67], v102 offset:56320
    v_mfma_f32_16x16x32_bf16 v[40:43], a[40:43], a[8:11], v[40:43]
    ds_read_b64_tr_b16 a[68:69], v103 offset:53248
    v_mfma_f32_16x16x32_bf16 v[44:47], a[40:43], a[12:15], v[44:47]
    ds_read_b64_tr_b16 a[70:71], v103 offset:56320
    v_mfma_f32_16x16x32_bf16 v[60:63], a[44:47], a[12:15], v[60:63]
    ds_read_b64_tr_b16 a[72:73], v104 offset:53248
    v_mfma_f32_16x16x32_bf16 v[56:59], a[44:47], a[8:11], v[56:59]
    ds_read_b64_tr_b16 a[74:75], v104 offset:56320
    v_mfma_f32_16x16x32_bf16 v[52:55], a[44:47], a[4:7], v[52:55]
    ds_read_b64_tr_b16 a[76:77], v105 offset:53248
    v_mfma_f32_16x16x32_bf16 v[48:51], a[44:47], a[0:3], v[48:51]
    ds_read_b64_tr_b16 a[78:79], v105 offset:56320
    v_mfma_f32_16x16x32_bf16 v[64:67], a[48:51], a[0:3], v[64:67]
    v_mfma_f32_16x16x32_bf16 v[68:71], a[48:51], a[4:7], v[68:71]
    v_mfma_f32_16x16x32_bf16 v[72:75], a[48:51], a[8:11], v[72:75]
    v_mfma_f32_16x16x32_bf16 v[76:79], a[48:51], a[12:15], v[76:79]
    v_mfma_f32_16x16x32_bf16 v[92:95], a[52:55], a[12:15], v[92:95]
    v_mfma_f32_16x16x32_bf16 v[88:91], a[52:55], a[8:11], v[88:91]
    v_mfma_f32_16x16x32_bf16 v[84:87], a[52:55], a[4:7], v[84:87]
    v_mfma_f32_16x16x32_bf16 v[80:83], a[52:55], a[0:3], v[80:83]
    s_waitcnt lgkmcnt(0)
    s_barrier
    v_mfma_f32_16x16x32_bf16 v[0:3], a[56:59], a[16:19], v[0:3]
    ds_read_b128 a[0:3], v98 offset:0
    v_mfma_f32_16x16x32_bf16 v[4:7], a[56:59], a[20:23], v[4:7]
    ds_read_b128 a[4:7], v98 offset:2048
    v_mfma_f32_16x16x32_bf16 v[8:11], a[56:59], a[24:27], v[8:11]
    ds_read_b128 a[8:11], v98 offset:4096
    v_mfma_f32_16x16x32_bf16 v[12:15], a[56:59], a[28:31], v[12:15]
    ds_read_b128 a[12:15], v98 offset:6144
    v_mfma_f32_16x16x32_bf16 v[28:31], a[60:63], a[28:31], v[28:31]
    ds_read_b64_tr_b16 a[32:33], v106 offset:0
    v_mfma_f32_16x16x32_bf16 v[24:27], a[60:63], a[24:27], v[24:27]
    ds_read_b64_tr_b16 a[34:35], v106 offset:3072
    v_mfma_f32_16x16x32_bf16 v[20:23], a[60:63], a[20:23], v[20:23]
    ds_read_b64_tr_b16 a[36:37], v107 offset:0
    v_mfma_f32_16x16x32_bf16 v[16:19], a[60:63], a[16:19], v[16:19]
    ds_read_b64_tr_b16 a[38:39], v107 offset:3072
    v_mfma_f32_16x16x32_bf16 v[32:35], a[64:67], a[16:19], v[32:35]
    ds_read_b64_tr_b16 a[40:41], v108 offset:0
    v_mfma_f32_16x16x32_bf16 v[36:39], a[64:67], a[20:23], v[36:39]
    ds_read_b64_tr_b16 a[42:43], v108 offset:3072
    v_mfma_f32_16x16x32_bf16 v[40:43], a[64:67], a[24:27], v[40:43]
    ds_read_b64_tr_b16 a[44:45], v109 offset:0
    v_mfma_f32_16x16x32_bf16 v[44:47], a[64:67], a[28:31], v[44:47]
    ds_read_b64_tr_b16 a[46:47], v109 offset:3072
    v_mfma_f32_16x16x32_bf16 v[60:63], a[68:71], a[28:31], v[60:63]
    ds_read_b64_tr_b16 a[48:49], v110 offset:0
    v_mfma_f32_16x16x32_bf16 v[56:59], a[68:71], a[24:27], v[56:59]
    ds_read_b64_tr_b16 a[50:51], v110 offset:3072
    v_mfma_f32_16x16x32_bf16 v[52:55], a[68:71], a[20:23], v[52:55]
    ds_read_b64_tr_b16 a[52:53], v111 offset:0
    v_mfma_f32_16x16x32_bf16 v[48:51], a[68:71], a[16:19], v[48:51]
    ds_read_b64_tr_b16 a[54:55], v111 offset:3072
    v_mfma_f32_16x16x32_bf16 v[64:67], a[72:75], a[16:19], v[64:67]
    v_mfma_f32_16x16x32_bf16 v[68:71], a[72:75], a[20:23], v[68:71]
    v_mfma_f32_16x16x32_bf16 v[72:75], a[72:75], a[24:27], v[72:75]
    v_mfma_f32_16x16x32_bf16 v[76:79], a[72:75], a[28:31], v[76:79]
    v_mfma_f32_16x16x32_bf16 v[92:95], a[76:79], a[28:31], v[92:95]
    v_mfma_f32_16x16x32_bf16 v[88:91], a[76:79], a[24:27], v[88:91]
    v_mfma_f32_16x16x32_bf16 v[84:87], a[76:79], a[20:23], v[84:87]
    v_mfma_f32_16x16x32_bf16 v[80:83], a[76:79], a[16:19], v[80:83]
    s_waitcnt lgkmcnt(0)
    v_mfma_f32_16x16x32_bf16 v[0:3], a[32:35], a[0:3], v[0:3]
    ds_read_b128 a[16:19], v99 offset:0
    v_mfma_f32_16x16x32_bf16 v[4:7], a[32:35], a[4:7], v[4:7]
    ds_read_b128 a[20:23], v99 offset:2048
    v_mfma_f32_16x16x32_bf16 v[8:11], a[32:35], a[8:11], v[8:11]
    ds_read_b128 a[24:27], v99 offset:4096
    v_mfma_f32_16x16x32_bf16 v[12:15], a[32:35], a[12:15], v[12:15]
    ds_read_b128 a[28:31], v99 offset:6144
    v_mfma_f32_16x16x32_bf16 v[28:31], a[36:39], a[12:15], v[28:31]
    ds_read_b64_tr_b16 a[56:57], v106 offset:12288
    v_mfma_f32_16x16x32_bf16 v[24:27], a[36:39], a[8:11], v[24:27]
    ds_read_b64_tr_b16 a[58:59], v106 offset:15360
    v_mfma_f32_16x16x32_bf16 v[20:23], a[36:39], a[4:7], v[20:23]
    ds_read_b64_tr_b16 a[60:61], v107 offset:12288
    v_mfma_f32_16x16x32_bf16 v[16:19], a[36:39], a[0:3], v[16:19]
    ds_read_b64_tr_b16 a[62:63], v107 offset:15360
    v_mfma_f32_16x16x32_bf16 v[32:35], a[40:43], a[0:3], v[32:35]
    ds_read_b64_tr_b16 a[64:65], v108 offset:12288
    v_mfma_f32_16x16x32_bf16 v[36:39], a[40:43], a[4:7], v[36:39]
    ds_read_b64_tr_b16 a[66:67], v108 offset:15360
    v_mfma_f32_16x16x32_bf16 v[40:43], a[40:43], a[8:11], v[40:43]
    ds_read_b64_tr_b16 a[68:69], v109 offset:12288
    v_mfma_f32_16x16x32_bf16 v[44:47], a[40:43], a[12:15], v[44:47]
    ds_read_b64_tr_b16 a[70:71], v109 offset:15360
    v_mfma_f32_16x16x32_bf16 v[60:63], a[44:47], a[12:15], v[60:63]
    ds_read_b64_tr_b16 a[72:73], v110 offset:12288
    v_mfma_f32_16x16x32_bf16 v[56:59], a[44:47], a[8:11], v[56:59]
    ds_read_b64_tr_b16 a[74:75], v110 offset:15360
    v_mfma_f32_16x16x32_bf16 v[52:55], a[44:47], a[4:7], v[52:55]
    ds_read_b64_tr_b16 a[76:77], v111 offset:12288
    v_mfma_f32_16x16x32_bf16 v[48:51], a[44:47], a[0:3], v[48:51]
    ds_read_b64_tr_b16 a[78:79], v111 offset:15360
    v_mfma_f32_16x16x32_bf16 v[64:67], a[48:51], a[0:3], v[64:67]
    v_mfma_f32_16x16x32_bf16 v[68:71], a[48:51], a[4:7], v[68:71]
    v_mfma_f32_16x16x32_bf16 v[72:75], a[48:51], a[8:11], v[72:75]
    v_mfma_f32_16x16x32_bf16 v[76:79], a[48:51], a[12:15], v[76:79]
    v_mfma_f32_16x16x32_bf16 v[92:95], a[52:55], a[12:15], v[92:95]
    v_mfma_f32_16x16x32_bf16 v[88:91], a[52:55], a[8:11], v[88:91]
    v_mfma_f32_16x16x32_bf16 v[84:87], a[52:55], a[4:7], v[84:87]
    v_mfma_f32_16x16x32_bf16 v[80:83], a[52:55], a[0:3], v[80:83]
    s_waitcnt lgkmcnt(0)
    s_barrier
    v_mfma_f32_16x16x32_bf16 v[0:3], a[56:59], a[16:19], v[0:3]
    ds_read_b128 a[0:3], v96 offset:0
    v_mfma_f32_16x16x32_bf16 v[4:7], a[56:59], a[20:23], v[4:7]
    ds_read_b128 a[4:7], v96 offset:2048
    v_mfma_f32_16x16x32_bf16 v[8:11], a[56:59], a[24:27], v[8:11]
    ds_read_b128 a[8:11], v96 offset:4096
    v_mfma_f32_16x16x32_bf16 v[12:15], a[56:59], a[28:31], v[12:15]
    ds_read_b128 a[12:15], v96 offset:6144
    v_mfma_f32_16x16x32_bf16 v[28:31], a[60:63], a[28:31], v[28:31]
    ds_read_b64_tr_b16 a[32:33], v100 offset:0
    v_mfma_f32_16x16x32_bf16 v[24:27], a[60:63], a[24:27], v[24:27]
    ds_read_b64_tr_b16 a[34:35], v100 offset:3072
    v_mfma_f32_16x16x32_bf16 v[20:23], a[60:63], a[20:23], v[20:23]
    ds_read_b64_tr_b16 a[36:37], v101 offset:0
    v_mfma_f32_16x16x32_bf16 v[16:19], a[60:63], a[16:19], v[16:19]
    ds_read_b64_tr_b16 a[38:39], v101 offset:3072
    v_mfma_f32_16x16x32_bf16 v[32:35], a[64:67], a[16:19], v[32:35]
    ds_read_b64_tr_b16 a[40:41], v102 offset:0
    v_mfma_f32_16x16x32_bf16 v[36:39], a[64:67], a[20:23], v[36:39]
    ds_read_b64_tr_b16 a[42:43], v102 offset:3072
    v_mfma_f32_16x16x32_bf16 v[40:43], a[64:67], a[24:27], v[40:43]
    ds_read_b64_tr_b16 a[44:45], v103 offset:0
    v_mfma_f32_16x16x32_bf16 v[44:47], a[64:67], a[28:31], v[44:47]
    ds_read_b64_tr_b16 a[46:47], v103 offset:3072
    v_mfma_f32_16x16x32_bf16 v[60:63], a[68:71], a[28:31], v[60:63]
    ds_read_b64_tr_b16 a[48:49], v104 offset:0
    v_mfma_f32_16x16x32_bf16 v[56:59], a[68:71], a[24:27], v[56:59]
    ds_read_b64_tr_b16 a[50:51], v104 offset:3072
    v_mfma_f32_16x16x32_bf16 v[52:55], a[68:71], a[20:23], v[52:55]
    ds_read_b64_tr_b16 a[52:53], v105 offset:0
    v_mfma_f32_16x16x32_bf16 v[48:51], a[68:71], a[16:19], v[48:51]
    ds_read_b64_tr_b16 a[54:55], v105 offset:3072
    v_mfma_f32_16x16x32_bf16 v[64:67], a[72:75], a[16:19], v[64:67]
    v_mfma_f32_16x16x32_bf16 v[68:71], a[72:75], a[20:23], v[68:71]
    v_mfma_f32_16x16x32_bf16 v[72:75], a[72:75], a[24:27], v[72:75]
    v_mfma_f32_16x16x32_bf16 v[76:79], a[72:75], a[28:31], v[76:79]
    v_mfma_f32_16x16x32_bf16 v[92:95], a[76:79], a[28:31], v[92:95]
    s_add_u32 s46, s46, 1
    s_cmp_lt_u32 s46, 5
    v_mfma_f32_16x16x32_bf16 v[88:91], a[76:79], a[24:27], v[88:91]
    v_mfma_f32_16x16x32_bf16 v[84:87], a[76:79], a[20:23], v[84:87]
    v_mfma_f32_16x16x32_bf16 v[80:83], a[76:79], a[16:19], v[80:83]
    s_waitcnt lgkmcnt(0)
    s_cbranch_scc1 L_sequential_preLN__sliding_block__glu_gated_bilinear__prompt_kernel_Acloop_4
    v_mfma_f32_16x16x32_bf16 v[0:3], a[32:35], a[0:3], v[0:3]
    ds_read_b128 a[16:19], v97 offset:0
    v_mfma_f32_16x16x32_bf16 v[4:7], a[32:35], a[4:7], v[4:7]
    ds_read_b128 a[20:23], v97 offset:2048
    v_mfma_f32_16x16x32_bf16 v[8:11], a[32:35], a[8:11], v[8:11]
    ds_read_b128 a[24:27], v97 offset:4096
    v_mfma_f32_16x16x32_bf16 v[12:15], a[32:35], a[12:15], v[12:15]
    ds_read_b128 a[28:31], v97 offset:6144
    v_mfma_f32_16x16x32_bf16 v[28:31], a[36:39], a[12:15], v[28:31]
    ds_read_b64_tr_b16 a[56:57], v100 offset:12288
    v_mfma_f32_16x16x32_bf16 v[24:27], a[36:39], a[8:11], v[24:27]
    ds_read_b64_tr_b16 a[58:59], v100 offset:15360
    v_mfma_f32_16x16x32_bf16 v[20:23], a[36:39], a[4:7], v[20:23]
    ds_read_b64_tr_b16 a[60:61], v101 offset:12288
    v_mfma_f32_16x16x32_bf16 v[16:19], a[36:39], a[0:3], v[16:19]
    ds_read_b64_tr_b16 a[62:63], v101 offset:15360
    v_mfma_f32_16x16x32_bf16 v[32:35], a[40:43], a[0:3], v[32:35]
    ds_read_b64_tr_b16 a[64:65], v102 offset:12288
    v_mfma_f32_16x16x32_bf16 v[36:39], a[40:43], a[4:7], v[36:39]
    ds_read_b64_tr_b16 a[66:67], v102 offset:15360
    v_mfma_f32_16x16x32_bf16 v[40:43], a[40:43], a[8:11], v[40:43]
    ds_read_b64_tr_b16 a[68:69], v103 offset:12288
    v_mfma_f32_16x16x32_bf16 v[44:47], a[40:43], a[12:15], v[44:47]
    ds_read_b64_tr_b16 a[70:71], v103 offset:15360
    v_mfma_f32_16x16x32_bf16 v[60:63], a[44:47], a[12:15], v[60:63]
    ds_read_b64_tr_b16 a[72:73], v104 offset:12288
    v_mfma_f32_16x16x32_bf16 v[56:59], a[44:47], a[8:11], v[56:59]
    ds_read_b64_tr_b16 a[74:75], v104 offset:15360
    v_mfma_f32_16x16x32_bf16 v[52:55], a[44:47], a[4:7], v[52:55]
    ds_read_b64_tr_b16 a[76:77], v105 offset:12288
    v_mfma_f32_16x16x32_bf16 v[48:51], a[44:47], a[0:3], v[48:51]
    ds_read_b64_tr_b16 a[78:79], v105 offset:15360
    v_mfma_f32_16x16x32_bf16 v[64:67], a[48:51], a[0:3], v[64:67]
    v_mfma_f32_16x16x32_bf16 v[68:71], a[48:51], a[4:7], v[68:71]
    v_mfma_f32_16x16x32_bf16 v[72:75], a[48:51], a[8:11], v[72:75]
    v_mfma_f32_16x16x32_bf16 v[76:79], a[48:51], a[12:15], v[76:79]
    v_mfma_f32_16x16x32_bf16 v[92:95], a[52:55], a[12:15], v[92:95]
    v_mfma_f32_16x16x32_bf16 v[88:91], a[52:55], a[8:11], v[88:91]
    v_mfma_f32_16x16x32_bf16 v[84:87], a[52:55], a[4:7], v[84:87]
    v_mfma_f32_16x16x32_bf16 v[80:83], a[52:55], a[0:3], v[80:83]
    s_waitcnt lgkmcnt(0)
    s_barrier
    v_mfma_f32_16x16x32_bf16 v[0:3], a[56:59], a[16:19], v[0:3]
    v_mfma_f32_16x16x32_bf16 v[4:7], a[56:59], a[20:23], v[4:7]
    v_mfma_f32_16x16x32_bf16 v[8:11], a[56:59], a[24:27], v[8:11]
    v_mfma_f32_16x16x32_bf16 v[12:15], a[56:59], a[28:31], v[12:15]
    v_mfma_f32_16x16x32_bf16 v[28:31], a[60:63], a[28:31], v[28:31]
    v_mfma_f32_16x16x32_bf16 v[24:27], a[60:63], a[24:27], v[24:27]
    v_mfma_f32_16x16x32_bf16 v[20:23], a[60:63], a[20:23], v[20:23]
    v_mfma_f32_16x16x32_bf16 v[16:19], a[60:63], a[16:19], v[16:19]
    v_mfma_f32_16x16x32_bf16 v[32:35], a[64:67], a[16:19], v[32:35]
    v_mfma_f32_16x16x32_bf16 v[36:39], a[64:67], a[20:23], v[36:39]
    v_mfma_f32_16x16x32_bf16 v[40:43], a[64:67], a[24:27], v[40:43]
    v_mfma_f32_16x16x32_bf16 v[44:47], a[64:67], a[28:31], v[44:47]
    v_mfma_f32_16x16x32_bf16 v[60:63], a[68:71], a[28:31], v[60:63]
    v_mfma_f32_16x16x32_bf16 v[56:59], a[68:71], a[24:27], v[56:59]
    v_mfma_f32_16x16x32_bf16 v[52:55], a[68:71], a[20:23], v[52:55]
    v_mfma_f32_16x16x32_bf16 v[48:51], a[68:71], a[16:19], v[48:51]
    v_mfma_f32_16x16x32_bf16 v[64:67], a[72:75], a[16:19], v[64:67]
    v_mfma_f32_16x16x32_bf16 v[68:71], a[72:75], a[20:23], v[68:71]
    v_mfma_f32_16x16x32_bf16 v[72:75], a[72:75], a[24:27], v[72:75]
    v_mfma_f32_16x16x32_bf16 v[76:79], a[72:75], a[28:31], v[76:79]
    v_mfma_f32_16x16x32_bf16 v[92:95], a[76:79], a[28:31], v[92:95]
    v_mfma_f32_16x16x32_bf16 v[88:91], a[76:79], a[24:27], v[88:91]
    v_mfma_f32_16x16x32_bf16 v[84:87], a[76:79], a[20:23], v[84:87]
    v_mfma_f32_16x16x32_bf16 v[80:83], a[76:79], a[16:19], v[80:83]
    ds_read_b64 v[116:117], v156 offset:0
    ds_read_b64 v[118:119], v156 offset:128
    ds_read_b64 v[120:121], v156 offset:256
    ds_read_b64 v[122:123], v156 offset:384
    ds_read_b128 v[132:135], v157 offset:256
    ds_read_b128 v[136:139], v157 offset:320
    ds_read_b128 v[140:143], v157 offset:512
    ds_read_b128 v[144:147], v157 offset:576
    ds_read_b128 v[124:127], v157 offset:0
    ds_read_b128 v[128:131], v157 offset:64
    s_waitcnt lgkmcnt(0)
    v_mov_b32 v96, v116
    v_mul_f32 v97, s52, v117
    v_mov_b32 v98, v118
    v_mul_f32 v99, s52, v119
    v_mov_b32 v100, v120
    v_mul_f32 v101, s52, v121
    v_mov_b32 v102, v122
    v_mul_f32 v103, s52, v123
    v_pk_fma_f32 v[32:33], v[132:133], v[116:117], v[32:33] op_sel:[0,0,0] op_sel_hi:[1,0,1] neg_lo:[0,1,0] neg_hi:[0,1,0]
    v_pk_fma_f32 v[34:35], v[134:135], v[116:117], v[34:35] op_sel:[0,0,0] op_sel_hi:[1,0,1] neg_lo:[0,1,0] neg_hi:[0,1,0]
    v_pk_mul_f32 v[32:33], v[32:33], v[116:117] op_sel:[0,1] op_sel_hi:[1,1]
    v_pk_mul_f32 v[34:35], v[34:35], v[116:117] op_sel:[0,1] op_sel_hi:[1,1]
    v_cvt_pk_bf16_f32 v104, v32, v33
    v_cvt_pk_bf16_f32 v105, v34, v35
    v_pk_fma_f32 v[48:49], v[136:137], v[116:117], v[48:49] op_sel:[0,0,0] op_sel_hi:[1,0,1] neg_lo:[0,1,0] neg_hi:[0,1,0]
    v_pk_fma_f32 v[50:51], v[138:139], v[116:117], v[50:51] op_sel:[0,0,0] op_sel_hi:[1,0,1] neg_lo:[0,1,0] neg_hi:[0,1,0]
    v_pk_mul_f32 v[48:49], v[48:49], v[116:117] op_sel:[0,1] op_sel_hi:[1,1]
    v_pk_mul_f32 v[50:51], v[50:51], v[116:117] op_sel:[0,1] op_sel_hi:[1,1]
    v_cvt_pk_bf16_f32 v106, v48, v49
    v_cvt_pk_bf16_f32 v107, v50, v51
    s_nop 1
    v_permlane16_swap_b32 v104, v106
    v_permlane16_swap_b32 v105, v107
    s_add_u32 s3, s47, 0
    buffer_store_dwordx4 v[104:107], v154, s[16:19], s3 offen sc1
    ds_write_b128 v152, v[104:107] offset:0
    v_pk_fma_f32 v[36:37], v[132:133], v[118:119], v[36:37] op_sel:[0,0,0] op_sel_hi:[1,0,1] neg_lo:[0,1,0] neg_hi:[0,1,0]
    v_pk_fma_f32 v[38:39], v[134:135], v[118:119], v[38:39] op_sel:[0,0,0] op_sel_hi:[1,0,1] neg_lo:[0,1,0] neg_hi:[0,1,0]
    v_pk_mul_f32 v[36:37], v[36:37], v[118:119] op_sel:[0,1] op_sel_hi:[1,1]
    v_pk_mul_f32 v[38:39], v[38:39], v[118:119] op_sel:[0,1] op_sel_hi:[1,1]
    v_cvt_pk_bf16_f32 v108, v36, v37
    v_cvt_pk_bf16_f32 v109, v38, v39
    v_pk_fma_f32 v[52:53], v[136:137], v[118:119], v[52:53] op_sel:[0,0,0] op_sel_hi:[1,0,1] neg_lo:[0,1,0] neg_hi:[0,1,0]
    v_pk_fma_f32 v[54:55], v[138:139], v[118:119], v[54:55] op_sel:[0,0,0] op_sel_hi:[1,0,1] neg_lo:[0,1,0] neg_hi:[0,1,0]
    v_pk_mul_f32 v[52:53], v[52:53], v[118:119] op_sel:[0,1] op_sel_hi:[1,1]
    v_pk_mul_f32 v[54:55], v[54:55], v[118:119] op_sel:[0,1] op_sel_hi:[1,1]
    v_cvt_pk_bf16_f32 v110, v52, v53
    v_cvt_pk_bf16_f32 v111, v54, v55
    s_nop 1
    v_permlane16_swap_b32 v108, v110
    v_permlane16_swap_b32 v109, v111
    s_add_u32 s3, s47, 1024
    buffer_store_dwordx4 v[108:111], v154, s[16:19], s3 offen sc1
    ds_write_b128 v152, v[108:111] offset:1024
    v_pk_fma_f32 v[40:41], v[132:133], v[120:121], v[40:41] op_sel:[0,0,0] op_sel_hi:[1,0,1] neg_lo:[0,1,0] neg_hi:[0,1,0]
    v_pk_fma_f32 v[42:43], v[134:135], v[120:121], v[42:43] op_sel:[0,0,0] op_sel_hi:[1,0,1] neg_lo:[0,1,0] neg_hi:[0,1,0]
    v_pk_mul_f32 v[40:41], v[40:41], v[120:121] op_sel:[0,1] op_sel_hi:[1,1]
    v_pk_mul_f32 v[42:43], v[42:43], v[120:121] op_sel:[0,1] op_sel_hi:[1,1]
    v_cvt_pk_bf16_f32 v160, v40, v41
    v_cvt_pk_bf16_f32 v161, v42, v43
    v_pk_fma_f32 v[56:57], v[136:137], v[120:121], v[56:57] op_sel:[0,0,0] op_sel_hi:[1,0,1] neg_lo:[0,1,0] neg_hi:[0,1,0]
    v_pk_fma_f32 v[58:59], v[138:139], v[120:121], v[58:59] op_sel:[0,0,0] op_sel_hi:[1,0,1] neg_lo:[0,1,0] neg_hi:[0,1,0]
    v_pk_mul_f32 v[56:57], v[56:57], v[120:121] op_sel:[0,1] op_sel_hi:[1,1]
    v_pk_mul_f32 v[58:59], v[58:59], v[120:121] op_sel:[0,1] op_sel_hi:[1,1]
    v_cvt_pk_bf16_f32 v162, v56, v57
    v_cvt_pk_bf16_f32 v163, v58, v59
    s_nop 1
    v_permlane16_swap_b32 v160, v162
    v_permlane16_swap_b32 v161, v163
    s_add_u32 s3, s47, 2048
    buffer_store_dwordx4 v[160:163], v154, s[16:19], s3 offen sc1
    ds_write_b128 v152, v[160:163] offset:2048
    v_pk_fma_f32 v[44:45], v[132:133], v[122:123], v[44:45] op_sel:[0,0,0] op_sel_hi:[1,0,1] neg_lo:[0,1,0] neg_hi:[0,1,0]
    v_pk_fma_f32 v[46:47], v[134:135], v[122:123], v[46:47] op_sel:[0,0,0] op_sel_hi:[1,0,1] neg_lo:[0,1,0] neg_hi:[0,1,0]
    v_pk_mul_f32 v[44:45], v[44:45], v[122:123] op_sel:[0,1] op_sel_hi:[1,1]
    v_pk_mul_f32 v[46:47], v[46:47], v[122:123] op_sel:[0,1] op_sel_hi:[1,1]
    v_cvt_pk_bf16_f32 v104, v44, v45
    v_cvt_pk_bf16_f32 v105, v46, v47
    v_pk_fma_f32 v[60:61], v[136:137], v[122:123], v[60:61] op_sel:[0,0,0] op_sel_hi:[1,0,1] neg_lo:[0,1,0] neg_hi:[0,1,0]
    v_pk_fma_f32 v[62:63], v[138:139], v[122:123], v[62:63] op_sel:[0,0,0] op_sel_hi:[1,0,1] neg_lo:[0,1,0] neg_hi:[0,1,0]
    v_pk_mul_f32 v[60:61], v[60:61], v[122:123] op_sel:[0,1] op_sel_hi:[1,1]
    v_pk_mul_f32 v[62:63], v[62:63], v[122:123] op_sel:[0,1] op_sel_hi:[1,1]
    v_cvt_pk_bf16_f32 v106, v60, v61
    v_cvt_pk_bf16_f32 v107, v62, v63
    s_nop 1
    v_permlane16_swap_b32 v104, v106
    v_permlane16_swap_b32 v105, v107
    s_add_u32 s3, s47, 3072
    buffer_store_dwordx4 v[104:107], v154, s[16:19], s3 offen sc1
    ds_write_b128 v152, v[104:107] offset:3072
    v_pk_fma_f32 v[64:65], v[140:141], v[116:117], v[64:65] op_sel:[0,0,0] op_sel_hi:[1,0,1] neg_lo:[0,1,0] neg_hi:[0,1,0]
    v_pk_fma_f32 v[66:67], v[142:143], v[116:117], v[66:67] op_sel:[0,0,0] op_sel_hi:[1,0,1] neg_lo:[0,1,0] neg_hi:[0,1,0]
    v_pk_mul_f32 v[64:65], v[64:65], v[116:117] op_sel:[0,1] op_sel_hi:[1,1]
    v_pk_mul_f32 v[66:67], v[66:67], v[116:117] op_sel:[0,1] op_sel_hi:[1,1]
    v_cvt_pk_bf16_f32 v108, v64, v65
    v_cvt_pk_bf16_f32 v109, v66, v67
    v_pk_fma_f32 v[80:81], v[144:145], v[116:117], v[80:81] op_sel:[0,0,0] op_sel_hi:[1,0,1] neg_lo:[0,1,0] neg_hi:[0,1,0]
    v_pk_fma_f32 v[82:83], v[146:147], v[116:117], v[82:83] op_sel:[0,0,0] op_sel_hi:[1,0,1] neg_lo:[0,1,0] neg_hi:[0,1,0]
    v_pk_mul_f32 v[80:81], v[80:81], v[116:117] op_sel:[0,1] op_sel_hi:[1,1]
    v_pk_mul_f32 v[82:83], v[82:83], v[116:117] op_sel:[0,1] op_sel_hi:[1,1]
    v_cvt_pk_bf16_f32 v110, v80, v81
    v_cvt_pk_bf16_f32 v111, v82, v83
    s_nop 1
    v_permlane16_swap_b32 v108, v110
    v_permlane16_swap_b32 v109, v111
    s_add_u32 s3, s48, 0
    buffer_store_dwordx4 v[108:111], v154, s[16:19], s3 offen sc1
    ds_write_b128 v153, v[108:111] offset:0
    v_pk_fma_f32 v[68:69], v[140:141], v[118:119], v[68:69] op_sel:[0,0,0] op_sel_hi:[1,0,1] neg_lo:[0,1,0] neg_hi:[0,1,0]
    v_pk_fma_f32 v[70:71], v[142:143], v[118:119], v[70:71] op_sel:[0,0,0] op_sel_hi:[1,0,1] neg_lo:[0,1,0] neg_hi:[0,1,0]
    v_pk_mul_f32 v[68:69], v[68:69], v[118:119] op_sel:[0,1] op_sel_hi:[1,1]
    v_pk_mul_f32 v[70:71], v[70:71], v[118:119] op_sel:[0,1] op_sel_hi:[1,1]
    v_cvt_pk_bf16_f32 v160, v68, v69
    v_cvt_pk_bf16_f32 v161, v70, v71
    v_pk_fma_f32 v[84:85], v[144:145], v[118:119], v[84:85] op_sel:[0,0,0] op_sel_hi:[1,0,1] neg_lo:[0,1,0] neg_hi:[0,1,0]
    v_pk_fma_f32 v[86:87], v[146:147], v[118:119], v[86:87] op_sel:[0,0,0] op_sel_hi:[1,0,1] neg_lo:[0,1,0] neg_hi:[0,1,0]
    v_pk_mul_f32 v[84:85], v[84:85], v[118:119] op_sel:[0,1] op_sel_hi:[1,1]
    v_pk_mul_f32 v[86:87], v[86:87], v[118:119] op_sel:[0,1] op_sel_hi:[1,1]
    v_cvt_pk_bf16_f32 v162, v84, v85
    v_cvt_pk_bf16_f32 v163, v86, v87
    s_nop 1
    v_permlane16_swap_b32 v160, v162
    v_permlane16_swap_b32 v161, v163
    s_add_u32 s3, s48, 1024
    buffer_store_dwordx4 v[160:163], v154, s[16:19], s3 offen sc1
    ds_write_b128 v153, v[160:163] offset:1024
    v_pk_fma_f32 v[72:73], v[140:141], v[120:121], v[72:73] op_sel:[0,0,0] op_sel_hi:[1,0,1] neg_lo:[0,1,0] neg_hi:[0,1,0]
    v_pk_fma_f32 v[74:75], v[142:143], v[120:121], v[74:75] op_sel:[0,0,0] op_sel_hi:[1,0,1] neg_lo:[0,1,0] neg_hi:[0,1,0]
    v_pk_mul_f32 v[72:73], v[72:73], v[120:121] op_sel:[0,1] op_sel_hi:[1,1]
    v_pk_mul_f32 v[74:75], v[74:75], v[120:121] op_sel:[0,1] op_sel_hi:[1,1]
    v_cvt_pk_bf16_f32 v104, v72, v73
    v_cvt_pk_bf16_f32 v105, v74, v75
    v_pk_fma_f32 v[88:89], v[144:145], v[120:121], v[88:89] op_sel:[0,0,0] op_sel_hi:[1,0,1] neg_lo:[0,1,0] neg_hi:[0,1,0]
    v_pk_fma_f32 v[90:91], v[146:147], v[120:121], v[90:91] op_sel:[0,0,0] op_sel_hi:[1,0,1] neg_lo:[0,1,0] neg_hi:[0,1,0]
    v_pk_mul_f32 v[88:89], v[88:89], v[120:121] op_sel:[0,1] op_sel_hi:[1,1]
    v_pk_mul_f32 v[90:91], v[90:91], v[120:121] op_sel:[0,1] op_sel_hi:[1,1]
    v_cvt_pk_bf16_f32 v106, v88, v89
    v_cvt_pk_bf16_f32 v107, v90, v91
    s_nop 1
    v_permlane16_swap_b32 v104, v106
    v_permlane16_swap_b32 v105, v107
    s_add_u32 s3, s48, 2048
    buffer_store_dwordx4 v[104:107], v154, s[16:19], s3 offen sc1
    ds_write_b128 v153, v[104:107] offset:2048
    v_pk_fma_f32 v[76:77], v[140:141], v[122:123], v[76:77] op_sel:[0,0,0] op_sel_hi:[1,0,1] neg_lo:[0,1,0] neg_hi:[0,1,0]
    v_pk_fma_f32 v[78:79], v[142:143], v[122:123], v[78:79] op_sel:[0,0,0] op_sel_hi:[1,0,1] neg_lo:[0,1,0] neg_hi:[0,1,0]
    v_pk_mul_f32 v[76:77], v[76:77], v[122:123] op_sel:[0,1] op_sel_hi:[1,1]
    v_pk_mul_f32 v[78:79], v[78:79], v[122:123] op_sel:[0,1] op_sel_hi:[1,1]
    v_cvt_pk_bf16_f32 v108, v76, v77
    v_cvt_pk_bf16_f32 v109, v78, v79
    v_pk_fma_f32 v[92:93], v[144:145], v[122:123], v[92:93] op_sel:[0,0,0] op_sel_hi:[1,0,1] neg_lo:[0,1,0] neg_hi:[0,1,0]
    v_pk_fma_f32 v[94:95], v[146:147], v[122:123], v[94:95] op_sel:[0,0,0] op_sel_hi:[1,0,1] neg_lo:[0,1,0] neg_hi:[0,1,0]
    v_pk_mul_f32 v[92:93], v[92:93], v[122:123] op_sel:[0,1] op_sel_hi:[1,1]
    v_pk_mul_f32 v[94:95], v[94:95], v[122:123] op_sel:[0,1] op_sel_hi:[1,1]
    v_cvt_pk_bf16_f32 v110, v92, v93
    v_cvt_pk_bf16_f32 v111, v94, v95
    s_nop 1
    v_permlane16_swap_b32 v108, v110
    v_permlane16_swap_b32 v109, v111
    s_add_u32 s3, s48, 3072
    buffer_store_dwordx4 v[108:111], v154, s[16:19], s3 offen sc1
    ds_write_b128 v153, v[108:111] offset:3072
    v_pk_fma_f32 v[0:1], v[124:125], v[96:97], v[0:1] op_sel:[0,0,0] op_sel_hi:[1,0,1] neg_lo:[0,1,0] neg_hi:[0,1,0]
    v_pk_fma_f32 v[2:3], v[126:127], v[96:97], v[2:3] op_sel:[0,0,0] op_sel_hi:[1,0,1] neg_lo:[0,1,0] neg_hi:[0,1,0]
    v_pk_mul_f32 v[0:1], v[0:1], v[96:97] op_sel:[0,1] op_sel_hi:[1,1]
    v_pk_mul_f32 v[2:3], v[2:3], v[96:97] op_sel:[0,1] op_sel_hi:[1,1]
    v_cvt_pk_bf16_f32 v160, v0, v1
    v_cvt_pk_bf16_f32 v161, v2, v3
    v_pk_fma_f32 v[16:17], v[128:129], v[96:97], v[16:17] op_sel:[0,0,0] op_sel_hi:[1,0,1] neg_lo:[0,1,0] neg_hi:[0,1,0]
    v_pk_fma_f32 v[18:19], v[130:131], v[96:97], v[18:19] op_sel:[0,0,0] op_sel_hi:[1,0,1] neg_lo:[0,1,0] neg_hi:[0,1,0]
    v_pk_mul_f32 v[16:17], v[16:17], v[96:97] op_sel:[0,1] op_sel_hi:[1,1]
    v_pk_mul_f32 v[18:19], v[18:19], v[96:97] op_sel:[0,1] op_sel_hi:[1,1]
    v_cvt_pk_bf16_f32 v162, v16, v17
    v_cvt_pk_bf16_f32 v163, v18, v19
    s_nop 1
    v_permlane16_swap_b32 v160, v162
    v_permlane16_swap_b32 v161, v163
    ds_write_b128 v155, v[160:163] offset:0
    v_pk_fma_f32 v[4:5], v[124:125], v[98:99], v[4:5] op_sel:[0,0,0] op_sel_hi:[1,0,1] neg_lo:[0,1,0] neg_hi:[0,1,0]
    v_pk_fma_f32 v[6:7], v[126:127], v[98:99], v[6:7] op_sel:[0,0,0] op_sel_hi:[1,0,1] neg_lo:[0,1,0] neg_hi:[0,1,0]
    v_pk_mul_f32 v[4:5], v[4:5], v[98:99] op_sel:[0,1] op_sel_hi:[1,1]
    v_pk_mul_f32 v[6:7], v[6:7], v[98:99] op_sel:[0,1] op_sel_hi:[1,1]
    v_cvt_pk_bf16_f32 v104, v4, v5
    v_cvt_pk_bf16_f32 v105, v6, v7
    v_pk_fma_f32 v[20:21], v[128:129], v[98:99], v[20:21] op_sel:[0,0,0] op_sel_hi:[1,0,1] neg_lo:[0,1,0] neg_hi:[0,1,0]
    v_pk_fma_f32 v[22:23], v[130:131], v[98:99], v[22:23] op_sel:[0,0,0] op_sel_hi:[1,0,1] neg_lo:[0,1,0] neg_hi:[0,1,0]
    v_pk_mul_f32 v[20:21], v[20:21], v[98:99] op_sel:[0,1] op_sel_hi:[1,1]
    v_pk_mul_f32 v[22:23], v[22:23], v[98:99] op_sel:[0,1] op_sel_hi:[1,1]
    v_cvt_pk_bf16_f32 v106, v20, v21
    v_cvt_pk_bf16_f32 v107, v22, v23
    s_nop 1
    v_permlane16_swap_b32 v104, v106
    v_permlane16_swap_b32 v105, v107
    ds_write_b128 v155, v[104:107] offset:1024
    v_pk_fma_f32 v[8:9], v[124:125], v[100:101], v[8:9] op_sel:[0,0,0] op_sel_hi:[1,0,1] neg_lo:[0,1,0] neg_hi:[0,1,0]
    v_pk_fma_f32 v[10:11], v[126:127], v[100:101], v[10:11] op_sel:[0,0,0] op_sel_hi:[1,0,1] neg_lo:[0,1,0] neg_hi:[0,1,0]
    v_pk_mul_f32 v[8:9], v[8:9], v[100:101] op_sel:[0,1] op_sel_hi:[1,1]
    v_pk_mul_f32 v[10:11], v[10:11], v[100:101] op_sel:[0,1] op_sel_hi:[1,1]
    v_cvt_pk_bf16_f32 v108, v8, v9
    v_cvt_pk_bf16_f32 v109, v10, v11
    v_pk_fma_f32 v[24:25], v[128:129], v[100:101], v[24:25] op_sel:[0,0,0] op_sel_hi:[1,0,1] neg_lo:[0,1,0] neg_hi:[0,1,0]
    v_pk_fma_f32 v[26:27], v[130:131], v[100:101], v[26:27] op_sel:[0,0,0] op_sel_hi:[1,0,1] neg_lo:[0,1,0] neg_hi:[0,1,0]
    v_pk_mul_f32 v[24:25], v[24:25], v[100:101] op_sel:[0,1] op_sel_hi:[1,1]
    v_pk_mul_f32 v[26:27], v[26:27], v[100:101] op_sel:[0,1] op_sel_hi:[1,1]
    v_cvt_pk_bf16_f32 v110, v24, v25
    v_cvt_pk_bf16_f32 v111, v26, v27
    s_nop 1
    v_permlane16_swap_b32 v108, v110
    v_permlane16_swap_b32 v109, v111
    ds_write_b128 v155, v[108:111] offset:2048
    v_pk_fma_f32 v[12:13], v[124:125], v[102:103], v[12:13] op_sel:[0,0,0] op_sel_hi:[1,0,1] neg_lo:[0,1,0] neg_hi:[0,1,0]
    v_pk_fma_f32 v[14:15], v[126:127], v[102:103], v[14:15] op_sel:[0,0,0] op_sel_hi:[1,0,1] neg_lo:[0,1,0] neg_hi:[0,1,0]
    v_pk_mul_f32 v[12:13], v[12:13], v[102:103] op_sel:[0,1] op_sel_hi:[1,1]
    v_pk_mul_f32 v[14:15], v[14:15], v[102:103] op_sel:[0,1] op_sel_hi:[1,1]
    v_cvt_pk_bf16_f32 v160, v12, v13
    v_cvt_pk_bf16_f32 v161, v14, v15
    v_pk_fma_f32 v[28:29], v[128:129], v[102:103], v[28:29] op_sel:[0,0,0] op_sel_hi:[1,0,1] neg_lo:[0,1,0] neg_hi:[0,1,0]
    v_pk_fma_f32 v[30:31], v[130:131], v[102:103], v[30:31] op_sel:[0,0,0] op_sel_hi:[1,0,1] neg_lo:[0,1,0] neg_hi:[0,1,0]
    v_pk_mul_f32 v[28:29], v[28:29], v[102:103] op_sel:[0,1] op_sel_hi:[1,1]
    v_pk_mul_f32 v[30:31], v[30:31], v[102:103] op_sel:[0,1] op_sel_hi:[1,1]
    v_cvt_pk_bf16_f32 v162, v28, v29
    v_cvt_pk_bf16_f32 v163, v30, v31
    s_nop 1
    v_permlane16_swap_b32 v160, v162
    v_permlane16_swap_b32 v161, v163
    ds_write_b128 v155, v[160:163] offset:3072
    s_waitcnt vmcnt(0) lgkmcnt(0)
    s_branch L_sequential_preLN__sliding_block__glu_gated_bilinear__prompt_kernel_AX1_3
L_sequential_preLN__sliding_block__glu_gated_bilinear__prompt_kernel_Aload_1:

    s_sub_u32 s43, s40, 4
    v_lshrrev_b32 v30, 3, v0
    v_lshrrev_b32 v31, 4, v0
    v_and_b32 v32, 7, v0
    v_xor_b32 v32, v32, v31
    s_lshl_b32 s3, s41, 7
    s_lshl_b32 s4, s43, 6
    s_add_u32 s3, s3, s4
    v_add_u32 v30, s3, v30
    v_lshlrev_b32 v30, 11, v30
    v_lshl_add_u32 v30, v32, 4, v30
    v_xor_b32 v31, 64, v30

    v_add_u32 v4, 0, v30
    v_add_u32 v5, 15360, v31
    v_add_u32 v6, 30720, v30
    v_add_u32 v7, 46080, v31
    v_add_u32 v8, 65536, v30
    v_add_u32 v9, 80896, v31
    v_add_u32 v10, 96256, v30
    v_add_u32 v11, 111616, v31

    s_lshl_b32 s47, s43, 13
    s_mul_i32 s48, s43, 12288
    s_add_u32 s48, s48, 16384
    s_mov_b32 s44, 0
    s_and_b32 s49, s42, 3
    s_mul_i32 s49, s49, 0
    s_add_u32 s49, s49, s41
    s_and_b32 s49, s49, 15

    s_lshl_b32 s45, s49, 7
    s_add_u32 s4, s44, s47
    s_add_u32 m0, s4, 0
    s_nop 0
    buffer_load_dwordx4 v4, s[8:11], s45 offen offset:0 lds
    buffer_load_dwordx4 v5, s[8:11], s45 offen offset:1024 lds
    buffer_load_dwordx4 v6, s[8:11], s45 offen offset:2048 lds
    buffer_load_dwordx4 v7, s[8:11], s45 offen offset:3072 lds
    s_add_u32 m0, s4, 4096
    s_nop 0
    buffer_load_dwordx4 v8, s[8:11], s45 offen offset:0 lds
    buffer_load_dwordx4 v9, s[8:11], s45 offen offset:1024 lds
    buffer_load_dwordx4 v10, s[8:11], s45 offen offset:2048 lds
    buffer_load_dwordx4 v11, s[8:11], s45 offen offset:3072 lds

    s_mul_i32 s3, s43, 768
    s_add_u32 s3, s3, 0
    v_add_u32 v30, s3, v0
    s_mov_b32 s4, 2731
    v_mul_u32_u24 v31, s4, v30
    v_lshrrev_b32 v31, 16, v31
    v_mul_u32_u24 v32, 24, v31
    v_sub_u32 v32, v30, v32
    v_bfe_u32 v33, v31, 1, 2
    v_lshlrev_b32 v33, 1, v33
    v_xor_b32 v32, v32, v33
    v_and_b32 v33, 4, v31
    v_lshlrev_b32 v33, 1, v33
    v_and_b32 v31, 0x33, v31
    v_or_b32 v31, v31, v33
    v_mul_u32_u24 v31, 6144, v31
    v_lshrrev_b32 v33, 3, v32
    v_lshlrev_b32 v33, 11, v33
    v_add_u32 v31, v31, v33
    v_and_b32 v32, 7, v32
    v_lshl_add_u32 v31, v32, 4, v31
    s_lshl_b32 s3, s42, 7
    v_add_u32 v31, s3, v31

    v_add_u32 v12, 0, v31
    v_add_u32 v15, 21504, v31
    v_add_u32 v18, 96256, v31
    v_add_u32 v21, 121856, v31

    s_mul_i32 s3, s43, 768
    s_add_u32 s3, s3, 64
    v_add_u32 v30, s3, v0
    s_mov_b32 s4, 2731
    v_mul_u32_u24 v31, s4, v30
    v_lshrrev_b32 v31, 16, v31
    v_mul_u32_u24 v32, 24, v31
    v_sub_u32 v32, v30, v32
    v_bfe_u32 v33, v31, 1, 2
    v_lshlrev_b32 v33, 1, v33
    v_xor_b32 v32, v32, v33
    v_and_b32 v33, 4, v31
    v_lshlrev_b32 v33, 1, v33
    v_and_b32 v31, 0x33, v31
    v_or_b32 v31, v31, v33
    v_mul_u32_u24 v31, 6144, v31
    v_lshrrev_b32 v33, 3, v32
    v_lshlrev_b32 v33, 11, v33
    v_add_u32 v31, v31, v33
    v_and_b32 v32, 7, v32
    v_lshl_add_u32 v31, v32, 4, v31
    s_lshl_b32 s3, s42, 7
    v_add_u32 v31, s3, v31

    v_add_u32 v13, 4294966272, v31
    v_add_u32 v16, 24576, v31
    v_add_u32 v19, 95232, v31
    v_add_u32 v22, 120832, v31

    s_mul_i32 s3, s43, 768
    s_add_u32 s3, s3, 128
    v_add_u32 v30, s3, v0
    s_mov_b32 s4, 2731
    v_mul_u32_u24 v31, s4, v30
    v_lshrrev_b32 v31, 16, v31
    v_mul_u32_u24 v32, 24, v31
    v_sub_u32 v32, v30, v32
    v_bfe_u32 v33, v31, 1, 2
    v_lshlrev_b32 v33, 1, v33
    v_xor_b32 v32, v32, v33
    v_and_b32 v33, 4, v31
    v_lshlrev_b32 v33, 1, v33
    v_and_b32 v31, 0x33, v31
    v_or_b32 v31, v31, v33
    v_mul_u32_u24 v31, 6144, v31
    v_lshrrev_b32 v33, 3, v32
    v_lshlrev_b32 v33, 11, v33
    v_add_u32 v31, v31, v33
    v_and_b32 v32, 7, v32
    v_lshl_add_u32 v31, v32, 4, v31
    s_lshl_b32 s3, s42, 7
    v_add_u32 v31, s3, v31

    v_add_u32 v14, 4294965248, v31
    v_add_u32 v17, 23552, v31
    v_add_u32 v20, 98304, v31
    v_add_u32 v23, 119808, v31
    s_mul_i32 s46, s49, 393216
    s_add_u32 s5, s44, s48
    s_add_u32 m0, s5, 0
    s_nop 0
    buffer_load_dwordx4 v12, s[12:15], s46 offen offset:0 lds
    buffer_load_dwordx4 v13, s[12:15], s46 offen offset:1024 lds
    buffer_load_dwordx4 v14, s[12:15], s46 offen offset:2048 lds
    buffer_load_dwordx4 v15, s[12:15], s46 offen offset:3072 lds
    s_add_u32 m0, s5, 4096
    s_nop 0
    buffer_load_dwordx4 v16, s[12:15], s46 offen offset:0 lds
    buffer_load_dwordx4 v17, s[12:15], s46 offen offset:1024 lds
    buffer_load_dwordx4 v18, s[12:15], s46 offen offset:2048 lds
    buffer_load_dwordx4 v19, s[12:15], s46 offen offset:3072 lds
    s_add_u32 m0, s5, 8192
    s_nop 0
    buffer_load_dwordx4 v20, s[12:15], s46 offen offset:0 lds
    buffer_load_dwordx4 v21, s[12:15], s46 offen offset:1024 lds
    buffer_load_dwordx4 v22, s[12:15], s46 offen offset:2048 lds
    buffer_load_dwordx4 v23, s[12:15], s46 offen offset:3072 lds

    s_add_u32 s49, s49, 1
    s_and_b32 s49, s49, 15
    s_add_u32 s44, s44, 40960
    s_cmp_ge_u32 s44, 122880
    s_cselect_b32 s3, 122880, 0
    s_sub_u32 s44, s44, s3

    s_barrier
    s_lshl_b32 s45, s49, 7
    s_add_u32 s4, s44, s47
    s_add_u32 m0, s4, 0
    s_nop 0
    buffer_load_dwordx4 v4, s[8:11], s45 offen offset:0 lds
    buffer_load_dwordx4 v5, s[8:11], s45 offen offset:1024 lds
    buffer_load_dwordx4 v6, s[8:11], s45 offen offset:2048 lds
    buffer_load_dwordx4 v7, s[8:11], s45 offen offset:3072 lds
    s_add_u32 m0, s4, 4096
    s_nop 0
    buffer_load_dwordx4 v8, s[8:11], s45 offen offset:0 lds
    buffer_load_dwordx4 v9, s[8:11], s45 offen offset:1024 lds
    buffer_load_dwordx4 v10, s[8:11], s45 offen offset:2048 lds
    buffer_load_dwordx4 v11, s[8:11], s45 offen offset:3072 lds
    s_mul_i32 s46, s49, 393216
    s_add_u32 s5, s44, s48
    s_add_u32 m0, s5, 0
    s_nop 0
    buffer_load_dwordx4 v12, s[12:15], s46 offen offset:0 lds
    buffer_load_dwordx4 v13, s[12:15], s46 offen offset:1024 lds
    buffer_load_dwordx4 v14, s[12:15], s46 offen offset:2048 lds
    buffer_load_dwordx4 v15, s[12:15], s46 offen offset:3072 lds
    s_add_u32 m0, s5, 4096
    s_nop 0
    buffer_load_dwordx4 v16, s[12:15], s46 offen offset:0 lds
    buffer_load_dwordx4 v17, s[12:15], s46 offen offset:1024 lds
    buffer_load_dwordx4 v18, s[12:15], s46 offen offset:2048 lds
    buffer_load_dwordx4 v19, s[12:15], s46 offen offset:3072 lds
    s_add_u32 m0, s5, 8192
    s_nop 0
    buffer_load_dwordx4 v20, s[12:15], s46 offen offset:0 lds
    buffer_load_dwordx4 v21, s[12:15], s46 offen offset:1024 lds
    buffer_load_dwordx4 v22, s[12:15], s46 offen offset:2048 lds
    buffer_load_dwordx4 v23, s[12:15], s46 offen offset:3072 lds

    s_add_u32 s49, s49, 1
    s_and_b32 s49, s49, 15
    s_add_u32 s44, s44, 40960
    s_cmp_ge_u32 s44, 122880
    s_cselect_b32 s3, 122880, 0
    s_sub_u32 s44, s44, s3

    s_waitcnt vmcnt(20)
    s_barrier
    s_lshl_b32 s45, s49, 7
    s_add_u32 s4, s44, s47
    s_add_u32 m0, s4, 0
    s_nop 0
    buffer_load_dwordx4 v4, s[8:11], s45 offen offset:0 lds
    buffer_load_dwordx4 v5, s[8:11], s45 offen offset:1024 lds
    buffer_load_dwordx4 v6, s[8:11], s45 offen offset:2048 lds
    buffer_load_dwordx4 v7, s[8:11], s45 offen offset:3072 lds
    s_add_u32 m0, s4, 4096
    s_nop 0
    buffer_load_dwordx4 v8, s[8:11], s45 offen offset:0 lds
    buffer_load_dwordx4 v9, s[8:11], s45 offen offset:1024 lds
    buffer_load_dwordx4 v10, s[8:11], s45 offen offset:2048 lds
    buffer_load_dwordx4 v11, s[8:11], s45 offen offset:3072 lds
    s_mul_i32 s46, s49, 393216
    s_add_u32 s5, s44, s48
    s_add_u32 m0, s5, 0
    s_nop 0
    buffer_load_dwordx4 v12, s[12:15], s46 offen offset:0 lds
    buffer_load_dwordx4 v13, s[12:15], s46 offen offset:1024 lds
    buffer_load_dwordx4 v14, s[12:15], s46 offen offset:2048 lds
    buffer_load_dwordx4 v15, s[12:15], s46 offen offset:3072 lds
    s_add_u32 m0, s5, 4096
    s_nop 0
    buffer_load_dwordx4 v16, s[12:15], s46 offen offset:0 lds
    buffer_load_dwordx4 v17, s[12:15], s46 offen offset:1024 lds
    buffer_load_dwordx4 v18, s[12:15], s46 offen offset:2048 lds
    buffer_load_dwordx4 v19, s[12:15], s46 offen offset:3072 lds
    s_add_u32 m0, s5, 8192
    s_nop 0
    buffer_load_dwordx4 v20, s[12:15], s46 offen offset:0 lds
    buffer_load_dwordx4 v21, s[12:15], s46 offen offset:1024 lds
    buffer_load_dwordx4 v22, s[12:15], s46 offen offset:2048 lds
    buffer_load_dwordx4 v23, s[12:15], s46 offen offset:3072 lds

    s_add_u32 s49, s49, 1
    s_and_b32 s49, s49, 15
    s_add_u32 s44, s44, 40960
    s_cmp_ge_u32 s44, 122880
    s_cselect_b32 s3, 122880, 0
    s_sub_u32 s44, s44, s3

    s_mov_b32 s50, 0
L_sequential_preLN__sliding_block__glu_gated_bilinear__prompt_kernel_Alloop_5:
    s_waitcnt vmcnt(20)
    s_barrier
    s_lshl_b32 s45, s49, 7
    s_add_u32 s4, s44, s47
    s_add_u32 m0, s4, 0
    s_nop 0
    buffer_load_dwordx4 v4, s[8:11], s45 offen offset:0 lds
    buffer_load_dwordx4 v5, s[8:11], s45 offen offset:1024 lds
    buffer_load_dwordx4 v6, s[8:11], s45 offen offset:2048 lds
    buffer_load_dwordx4 v7, s[8:11], s45 offen offset:3072 lds
    s_add_u32 m0, s4, 4096
    s_nop 0
    buffer_load_dwordx4 v8, s[8:11], s45 offen offset:0 lds
    buffer_load_dwordx4 v9, s[8:11], s45 offen offset:1024 lds
    buffer_load_dwordx4 v10, s[8:11], s45 offen offset:2048 lds
    buffer_load_dwordx4 v11, s[8:11], s45 offen offset:3072 lds
    s_mul_i32 s46, s49, 393216
    s_add_u32 s5, s44, s48
    s_add_u32 m0, s5, 0
    s_nop 0
    buffer_load_dwordx4 v12, s[12:15], s46 offen offset:0 lds
    buffer_load_dwordx4 v13, s[12:15], s46 offen offset:1024 lds
    buffer_load_dwordx4 v14, s[12:15], s46 offen offset:2048 lds
    buffer_load_dwordx4 v15, s[12:15], s46 offen offset:3072 lds
    s_add_u32 m0, s5, 4096
    s_nop 0
    buffer_load_dwordx4 v16, s[12:15], s46 offen offset:0 lds
    buffer_load_dwordx4 v17, s[12:15], s46 offen offset:1024 lds
    buffer_load_dwordx4 v18, s[12:15], s46 offen offset:2048 lds
    buffer_load_dwordx4 v19, s[12:15], s46 offen offset:3072 lds
    s_add_u32 m0, s5, 8192
    s_nop 0
    buffer_load_dwordx4 v20, s[12:15], s46 offen offset:0 lds
    buffer_load_dwordx4 v21, s[12:15], s46 offen offset:1024 lds
    buffer_load_dwordx4 v22, s[12:15], s46 offen offset:2048 lds
    buffer_load_dwordx4 v23, s[12:15], s46 offen offset:3072 lds

    s_add_u32 s49, s49, 1
    s_and_b32 s49, s49, 15
    s_add_u32 s44, s44, 40960
    s_cmp_ge_u32 s44, 122880
    s_cselect_b32 s3, 122880, 0
    s_sub_u32 s44, s44, s3

    s_add_u32 s50, s50, 1
    s_cmp_lt_u32 s50, 13
    s_cbranch_scc1 L_sequential_preLN__sliding_block__glu_gated_bilinear__prompt_kernel_Alloop_5
    s_waitcnt vmcnt(20)
    s_barrier
    s_waitcnt vmcnt(0)
    s_barrier
    s_waitcnt vmcnt(0)
    s_barrier
    s_branch L_sequential_preLN__sliding_block__glu_gated_bilinear__prompt_kernel_AX1_3
L_sequential_preLN__sliding_block__glu_gated_bilinear__prompt_kernel_Ahelp_2:
    s_barrier
    s_sub_u32 s43, s40, 6

    s_lshl_b32 s3, s2, 3
    s_lshl_b32 s4, s43, 2
    s_add_u32 s44, s3, s4
    v_lshrrev_b32 v30, 4, v0
    v_add_u32 v30, s44, v30
    v_lshlrev_b32 v31, 11, v30
    v_and_b32 v32, 15, v0
    v_lshl_add_u32 v31, v32, 4, v31

    s_lshr_b32 s45, s2, 5
    s_add_u32 s3, s45, 0
    s_and_b32 s3, s3, 7
    s_lshl_b32 s3, s3, 8
    buffer_load_dwordx4 v[64:67], v31, s[8:11], s3 offen
    s_add_u32 s3, s45, 1
    s_and_b32 s3, s3, 7
    s_lshl_b32 s3, s3, 8
    buffer_load_dwordx4 v[68:71], v31, s[8:11], s3 offen
    s_cmp_eq_u32 s2, 0
    s_cbranch_scc0 L_sequential_preLN__sliding_block__glu_gated_bilinear__prompt_kernel_nonon_6
    s_cmp_eq_u32 s43, 0
    s_cbranch_scc0 L_sequential_preLN__sliding_block__glu_gated_bilinear__prompt_kernel_nonon_6

    v_mov_b32 v36, 0
    buffer_load_dword v37, v36, s[28:31], 0 offen sc1
    s_waitcnt vmcnt(0)
    v_readfirstlane_b32 s3, v37
    s_add_u32 s3, s3, 1
    s_cmp_eq_u32 s3, 0
    s_cselect_b32 s62, 1, s3
    v_mov_b32 v37, s62
    s_mov_b64 exec, 1
    buffer_store_dword v37, v36, s[28:31], 0 offen sc1
    s_nop 1
    v_mov_b32 v36, 0
    global_store_dword v36, v37, s[80:81] sc1
    s_mov_b64 exec, -1

L_sequential_preLN__sliding_block__glu_gated_bilinear__prompt_kernel_nonon_6:

    v_lshrrev_b32 v32, 5, v0
    v_lshlrev_b32 v32, 4, v32
    v_bfe_u32 v33, v0, 4, 1
    v_lshl_add_u32 v32, v33, 2, v32
    v_bfe_u32 v33, v0, 2, 2
    v_add_u32 v32, v32, v33
    v_bfe_u32 v33, v32, 1, 2
    v_mul_u32_u24 v32, 384, v32
    v_and_b32 v34, 1, v0
    v_lshl_add_u32 v32, v34, 3, v32
    v_bfe_u32 v34, v0, 1, 1
    v_lshl_add_u32 v32, v34, 4, v32
    v_add_u32 v32, 16384, v32

    s_mul_i32 s3, s43, 6
    s_add_u32 s3, s3, 0
    v_xor_b32 v34, s3, v33
    v_lshl_add_u32 v40, v34, 5, v32

    s_mul_i32 s3, s43, 6
    s_add_u32 s3, s3, 1
    v_xor_b32 v34, s3, v33
    v_lshl_add_u32 v41, v34, 5, v32

    s_mul_i32 s3, s43, 6
    s_add_u32 s3, s3, 2
    v_xor_b32 v34, s3, v33
    v_lshl_add_u32 v42, v34, 5, v32

    s_mul_i32 s3, s43, 6
    s_add_u32 s3, s3, 3
    v_xor_b32 v34, s3, v33
    v_lshl_add_u32 v43, v34, 5, v32

    s_mul_i32 s3, s43, 6
    s_add_u32 s3, s3, 4
    v_xor_b32 v34, s3, v33
    v_lshl_add_u32 v44, v34, 5, v32

    s_mul_i32 s3, s43, 6
    s_add_u32 s3, s3, 5
    v_xor_b32 v34, s3, v33
    v_lshl_add_u32 v45, v34, 5, v32

    v_mov_b32 v48, 0x3f803f80
    v_mov_b32 v49, 0x3f803f80
    v_mov_b32 v50, 0x3f803f80
    v_mov_b32 v51, 0x3f803f80
    s_barrier
    s_add_u32 s3, s45, 2
    s_and_b32 s3, s3, 7
    s_lshl_b32 s3, s3, 8
    buffer_load_dwordx4 v[72:75], v31, s[8:11], s3 offen
    s_add_u32 s3, s45, 3
    s_and_b32 s3, s3, 7
    s_lshl_b32 s3, s3, 8
    buffer_load_dwordx4 v[76:79], v31, s[8:11], s3 offen
    ds_read_b64_tr_b16 a[0:1], v40 offset:0
    ds_read_b64_tr_b16 a[2:3], v40 offset:3072
    ds_read_b64_tr_b16 a[4:5], v41 offset:0
    ds_read_b64_tr_b16 a[6:7], v41 offset:3072
    ds_read_b64_tr_b16 a[8:9], v42 offset:0
    ds_read_b64_tr_b16 a[10:11], v42 offset:3072
    ds_read_b64_tr_b16 a[12:13], v43 offset:0
    ds_read_b64_tr_b16 a[14:15], v43 offset:3072
    ds_read_b64_tr_b16 a[16:17], v44 offset:0
    ds_read_b64_tr_b16 a[18:19], v44 offset:3072
    ds_read_b64_tr_b16 a[20:21], v45 offset:0
    ds_read_b64_tr_b16 a[22:23], v45 offset:3072
    ds_read_b64_tr_b16 a[24:25], v40 offset:12288
    ds_read_b64_tr_b16 a[26:27], v40 offset:15360
    ds_read_b64_tr_b16 a[28:29], v41 offset:12288
    ds_read_b64_tr_b16 a[30:31], v41 offset:15360
    ds_read_b64_tr_b16 a[32:33], v42 offset:12288
    ds_read_b64_tr_b16 a[34:35], v42 offset:15360
    ds_read_b64_tr_b16 a[36:37], v43 offset:12288
    ds_read_b64_tr_b16 a[38:39], v43 offset:15360
    ds_read_b64_tr_b16 a[40:41], v44 offset:12288
    ds_read_b64_tr_b16 a[42:43], v44 offset:15360
    ds_read_b64_tr_b16 a[44:45], v45 offset:12288
    ds_read_b64_tr_b16 a[46:47], v45 offset:15360
    s_waitcnt lgkmcnt(0)
    s_barrier
    v_mfma_f32_16x16x32_bf16 v[104:107], a[0:3], v[48:51], 0
    v_mfma_f32_16x16x32_bf16 v[108:111], a[4:7], v[48:51], 0
    v_mfma_f32_16x16x32_bf16 v[112:115], a[8:11], v[48:51], 0
    v_mfma_f32_16x16x32_bf16 v[116:119], a[12:15], v[48:51], 0
    v_mfma_f32_16x16x32_bf16 v[120:123], a[16:19], v[48:51], 0
    v_mfma_f32_16x16x32_bf16 v[124:127], a[20:23], v[48:51], 0
    v_mfma_f32_16x16x32_bf16 v[104:107], a[24:27], v[48:51], v[104:107]
    v_mfma_f32_16x16x32_bf16 v[108:111], a[28:31], v[48:51], v[108:111]
    v_mfma_f32_16x16x32_bf16 v[112:115], a[32:35], v[48:51], v[112:115]
    v_mfma_f32_16x16x32_bf16 v[116:119], a[36:39], v[48:51], v[116:119]
    v_mfma_f32_16x16x32_bf16 v[120:123], a[40:43], v[48:51], v[120:123]
    v_mfma_f32_16x16x32_bf16 v[124:127], a[44:47], v[48:51], v[124:127]
    s_add_u32 s3, s45, 4
    s_and_b32 s3, s3, 7
    s_lshl_b32 s3, s3, 8
    buffer_load_dwordx4 v[80:83], v31, s[8:11], s3 offen
    s_add_u32 s3, s45, 5
    s_and_b32 s3, s3, 7
    s_lshl_b32 s3, s3, 8
    buffer_load_dwordx4 v[84:87], v31, s[8:11], s3 offen
    v_mov_b32 v36, 0
    global_load_dword v37, v36, s[80:81] sc1
    s_barrier
    s_add_u32 s3, s45, 6
    s_and_b32 s3, s3, 7
    s_lshl_b32 s3, s3, 8
    buffer_load_dwordx4 v[88:91], v31, s[8:11], s3 offen
    s_add_u32 s3, s45, 7
    s_and_b32 s3, s3, 7
    s_lshl_b32 s3, s3, 8
    buffer_load_dwordx4 v[92:95], v31, s[8:11], s3 offen
    s_barrier
    s_barrier
    s_waitcnt vmcnt(0)
    v_mov_b32 v32, 0
    v_mov_b32 v33, 0
    v_mov_b32 v34, 0x3f803f80
    v_dot2_f32_bf16 v32, v64, v34, v32
    v_dot2_f32_bf16 v33, v64, v64, v33
    v_dot2_f32_bf16 v32, v65, v34, v32
    v_dot2_f32_bf16 v33, v65, v65, v33
    v_dot2_f32_bf16 v32, v66, v34, v32
    v_dot2_f32_bf16 v33, v66, v66, v33
    v_dot2_f32_bf16 v32, v67, v34, v32
    v_dot2_f32_bf16 v33, v67, v67, v33
    v_dot2_f32_bf16 v32, v68, v34, v32
    v_dot2_f32_bf16 v33, v68, v68, v33
    v_dot2_f32_bf16 v32, v69, v34, v32
    v_dot2_f32_bf16 v33, v69, v69, v33
    v_dot2_f32_bf16 v32, v70, v34, v32
    v_dot2_f32_bf16 v33, v70, v70, v33
    v_dot2_f32_bf16 v32, v71, v34, v32
    v_dot2_f32_bf16 v33, v71, v71, v33
    v_dot2_f32_bf16 v32, v72, v34, v32
    v_dot2_f32_bf16 v33, v72, v72, v33
    v_dot2_f32_bf16 v32, v73, v34, v32
    v_dot2_f32_bf16 v33, v73, v73, v33
    v_dot2_f32_bf16 v32, v74, v34, v32
    v_dot2_f32_bf16 v33, v74, v74, v33
    v_dot2_f32_bf16 v32, v75, v34, v32
    v_dot2_f32_bf16 v33, v75, v75, v33
    v_dot2_f32_bf16 v32, v76, v34, v32
    v_dot2_f32_bf16 v33, v76, v76, v33
    v_dot2_f32_bf16 v32, v77, v34, v32
    v_dot2_f32_bf16 v33, v77, v77, v33
    v_dot2_f32_bf16 v32, v78, v34, v32
    v_dot2_f32_bf16 v33, v78, v78, v33
    v_dot2_f32_bf16 v32, v79, v34, v32
    v_dot2_f32_bf16 v33, v79, v79, v33
    s_barrier
    v_dot2_f32_bf16 v32, v80, v34, v32
    v_dot2_f32_bf16 v33, v80, v80, v33
    v_dot2_f32_bf16 v32, v81, v34, v32
    v_dot2_f32_bf16 v33, v81, v81, v33
    v_dot2_f32_bf16 v32, v82, v34, v32
    v_dot2_f32_bf16 v33, v82, v82, v33
    v_dot2_f32_bf16 v32, v83, v34, v32
    v_dot2_f32_bf16 v33, v83, v83, v33
    v_dot2_f32_bf16 v32, v84, v34, v32
    v_dot2_f32_bf16 v33, v84, v84, v33
    v_dot2_f32_bf16 v32, v85, v34, v32
    v_dot2_f32_bf16 v33, v85, v85, v33
    v_dot2_f32_bf16 v32, v86, v34, v32
    v_dot2_f32_bf16 v33, v86, v86, v33
    v_dot2_f32_bf16 v32, v87, v34, v32
    v_dot2_f32_bf16 v33, v87, v87, v33
    v_dot2_f32_bf16 v32, v88, v34, v32
    v_dot2_f32_bf16 v33, v88, v88, v33
    v_dot2_f32_bf16 v32, v89, v34, v32
    v_dot2_f32_bf16 v33, v89, v89, v33
    v_dot2_f32_bf16 v32, v90, v34, v32
    v_dot2_f32_bf16 v33, v90, v90, v33
    v_dot2_f32_bf16 v32, v91, v34, v32
    v_dot2_f32_bf16 v33, v91, v91, v33
    v_dot2_f32_bf16 v32, v92, v34, v32
    v_dot2_f32_bf16 v33, v92, v92, v33
    v_dot2_f32_bf16 v32, v93, v34, v32
    v_dot2_f32_bf16 v33, v93, v93, v33
    v_dot2_f32_bf16 v32, v94, v34, v32
    v_dot2_f32_bf16 v33, v94, v94, v33
    v_dot2_f32_bf16 v32, v95, v34, v32
    v_dot2_f32_bf16 v33, v95, v95, v33
    s_barrier
    s_nop 1
    v_add_f32_dpp v32, v32, v32 row_ror:8 row_mask:0xf bank_mask:0xf
    v_add_f32_dpp v33, v33, v33 row_ror:8 row_mask:0xf bank_mask:0xf
    s_nop 1
    v_add_f32_dpp v32, v32, v32 row_ror:4 row_mask:0xf bank_mask:0xf
    v_add_f32_dpp v33, v33, v33 row_ror:4 row_mask:0xf bank_mask:0xf
    s_nop 1
    v_add_f32_dpp v32, v32, v32 row_ror:2 row_mask:0xf bank_mask:0xf
    v_add_f32_dpp v33, v33, v33 row_ror:2 row_mask:0xf bank_mask:0xf
    s_nop 1
    v_add_f32_dpp v32, v32, v32 row_ror:1 row_mask:0xf bank_mask:0xf
    v_add_f32_dpp v33, v33, v33 row_ror:1 row_mask:0xf bank_mask:0xf

    v_mul_f32 v52, 0x3a800000, v32
    v_mul_f32 v33, 0x3a800000, v33
    v_fma_f32 v33, -v52, v52, v33
    v_max_f32 v33, 0, v33
    v_add_f32 v33, 0x3727c5ac, v33
    v_rsq_f32 v53, v33
    s_waitcnt vmcnt(0)
    v_readfirstlane_b32 s62, v37

    s_cmp_lg_u32 s62, 0
    s_cbranch_scc1 L_sequential_preLN__sliding_block__glu_gated_bilinear__prompt_kernel_ngot_7
    s_mov_b32 s63, 0
    v_mov_b32 v34, 0
L_sequential_preLN__sliding_block__glu_gated_bilinear__prompt_kernel_npoll_8:
    global_load_dword v35, v34, s[80:81] sc1
    s_waitcnt vmcnt(0)
    v_readfirstlane_b32 s62, v35
    s_cmp_lg_u32 s62, 0
    s_cbranch_scc1 L_sequential_preLN__sliding_block__glu_gated_bilinear__prompt_kernel_ngot_7
    s_add_u32 s63, s63, 1
    s_cmp_lt_u32 s63, 40000
    s_cbranch_scc1 L_sequential_preLN__sliding_block__glu_gated_bilinear__prompt_kernel_npoll_8
L_sequential_preLN__sliding_block__glu_gated_bilinear__prompt_kernel_ngot_7:

    v_mov_b32 v34, 163824
    v_mov_b32 v35, s62
    ds_write_b32 v34, v35
    s_add_u32 s16, s82, 46137344
    s_addc_u32 s17, s83, 0
    s_mov_b32 s18, 32768
    s_mov_b32 s19, 0x20000
    s_add_u32 s20, s82, 46202880
    s_addc_u32 s21, s83, 0
    s_mov_b32 s22, 196608
    s_mov_b32 s23, 0x20000

    v_mov_b32 v54, s62
    v_mov_b32 v55, s62
    v_lshlrev_b32 v31, 4, v30
    v_and_b32 v32, 15, v0
    v_cmp_eq_u32 vcc, 0, v32
    s_and_saveexec_b64 s[6:7], vcc
    buffer_store_dwordx4 v[52:55], v31, s[16:19], 0 offen sc1
    s_lshl_b32 s3, s42, 4
    s_add_u32 s3, s3, s41
    s_mul_i32 s3, s3, 768
    s_mul_i32 s4, s43, 384
    s_add_u32 s3, s3, s4
    v_lshrrev_b32 v32, 4, v0
    v_lshlrev_b32 v32, 4, v32
    v_add_u32 v32, s3, v32

    buffer_store_dwordx4 v[104:107], v32, s[20:23], 0 offen offset:0 sc1
    buffer_store_dwordx4 v[108:111], v32, s[20:23], 0 offen offset:64 sc1
    buffer_store_dwordx4 v[112:115], v32, s[20:23], 0 offen offset:128 sc1
    buffer_store_dwordx4 v[116:119], v32, s[20:23], 0 offen offset:192 sc1
    buffer_store_dwordx4 v[120:123], v32, s[20:23], 0 offen offset:256 sc1
    buffer_store_dwordx4 v[124:127], v32, s[20:23], 0 offen offset:320 sc1
    s_mov_b64 exec, s[6:7]
    s_waitcnt lgkmcnt(0)
    s_barrier
    s_barrier
    s_waitcnt vmcnt(0)
    s_barrier
    s_cmp_eq_u32 s43, 1
    s_cbranch_scc1 L_sequential_preLN__sliding_block__glu_gated_bilinear__prompt_kernel_Ah7_9
    s_lshl_b32 s3, s42, 12
    s_lshl_b32 s4, s41, 7
    s_add_u32 s3, s3, s4
    s_add_u32 s47, s3, 65536

    v_mov_b32 v34, s47
    v_mov_b32 v35, s62
    s_mov_b64 exec, 1
    buffer_store_dword v35, v34, s[28:31], 0 offen sc1
    s_mov_b64 exec, -1

    s_barrier
    s_barrier
    s_barrier
    s_barrier
    s_barrier
    s_barrier
    s_barrier
    s_branch L_sequential_preLN__sliding_block__glu_gated_bilinear__prompt_kernel_Ahend_10
L_sequential_preLN__sliding_block__glu_gated_bilinear__prompt_kernel_Ah7_9:
    s_barrier
    s_barrier

    s_lshl_b32 s3, s41, 7
    v_add_u32 v30, s3, v0
    v_lshlrev_b32 v30, 4, v30
    s_lshl_b32 s3, s42, 12
    s_add_u32 s47, s3, 65536
    v_lshlrev_b32 v32, 7, v0
    v_add_u32 v32, s47, v32
    s_mov_b64 s[48:49], 0xffff
    v_mov_b32 v73, 0x7fff0000
    v_cndmask_b32 v32, v73, v32, s[48:49]
    s_mov_b32 s63, 0
    buffer_load_dwordx4 v[64:67], v30, s[16:19], 0 offen sc1
    buffer_load_dwordx4 v[68:71], v30, s[16:19], 0 offen offset:1024 sc1
    buffer_load_dword v72, v32, s[28:31], 0 offen sc1

    s_barrier
    s_barrier

L_sequential_preLN__sliding_block__glu_gated_bilinear__prompt_kernel_stre_11:
    s_waitcnt vmcnt(0)
    v_cmp_eq_u32 vcc, s62, v66
    v_cmp_eq_u32 s[6:7], s62, v70
    s_nop 1
    s_and_b64 s[6:7], s[6:7], vcc
    v_cmp_eq_u32 vcc, s62, v72
    s_nop 1
    s_orn2_b64 vcc, vcc, s[48:49]
    s_and_b64 s[6:7], s[6:7], vcc
    s_cmp_eq_u64 s[6:7], -1
    s_cbranch_scc1 L_sequential_preLN__sliding_block__glu_gated_bilinear__prompt_kernel_stok_12
    buffer_load_dwordx4 v[64:67], v30, s[16:19], 0 offen sc1
    buffer_load_dwordx4 v[68:71], v30, s[16:19], 0 offen offset:1024 sc1
    buffer_load_dword v72, v32, s[28:31], 0 offen sc1
    s_add_u32 s63, s63, 1
    s_cmp_lt_u32 s63, 40000
    s_cbranch_scc1 L_sequential_preLN__sliding_block__glu_gated_bilinear__prompt_kernel_stre_11
L_sequential_preLN__sliding_block__glu_gated_bilinear__prompt_kernel_stok_12:
    v_lshlrev_b32 v31, 3, v0
    v_add_u32 v31, 122880, v31
    ds_write_b64 v31, v[64:65]
    ds_write_b64 v31, v[68:69] offset:512
    s_mul_i32 s3, s42, 12288
    v_lshlrev_b32 v31, 4, v0
    v_add_u32 v31, s3, v31
    s_mov_b32 exec_lo, -1
    s_mov_b32 exec_hi, 0xffff

    s_mov_b32 s3, 0
    buffer_load_dwordx4 v[72:75], v31, s[20:23], s3 offen sc1
    s_mov_b32 s3, 768
    buffer_load_dwordx4 v[76:79], v31, s[20:23], s3 offen sc1
    s_mov_b32 s3, 1536
    buffer_load_dwordx4 v[80:83], v31, s[20:23], s3 offen sc1
    s_mov_b32 s3, 2304
    buffer_load_dwordx4 v[84:87], v31, s[20:23], s3 offen sc1
    s_mov_b32 s3, 3072
    buffer_load_dwordx4 v[88:91], v31, s[20:23], s3 offen sc1
    s_mov_b32 s3, 3840
    buffer_load_dwordx4 v[92:95], v31, s[20:23], s3 offen sc1
    s_mov_b32 s3, 4608
    buffer_load_dwordx4 v[96:99], v31, s[20:23], s3 offen sc1
    s_mov_b32 s3, 5376
    buffer_load_dwordx4 v[100:103], v31, s[20:23], s3 offen sc1
    s_mov_b32 s3, 6144
    buffer_load_dwordx4 v[104:107], v31, s[20:23], s3 offen sc1
    s_mov_b32 s3, 6912
    buffer_load_dwordx4 v[108:111], v31, s[20:23], s3 offen sc1
    s_mov_b32 s3, 7680
    buffer_load_dwordx4 v[112:115], v31, s[20:23], s3 offen sc1
    s_mov_b32 s3, 8448
    buffer_load_dwordx4 v[116:119], v31, s[20:23], s3 offen sc1
    s_mov_b32 s3, 9216
    buffer_load_dwordx4 v[120:123], v31, s[20:23], s3 offen sc1
    s_mov_b32 s3, 9984
    buffer_load_dwordx4 v[124:127], v31, s[20:23], s3 offen sc1
    s_mov_b32 s3, 10752
    buffer_load_dwordx4 v[128:131], v31, s[20:23], s3 offen sc1
    s_mov_b32 s3, 11520
    buffer_load_dwordx4 v[132:135], v31, s[20:23], s3 offen sc1
    s_mov_b64 exec, -1
    s_barrier
    s_barrier
    s_waitcnt vmcnt(0)
    v_pk_add_f32 v[72:73], v[72:73], v[76:77]
    v_pk_add_f32 v[74:75], v[74:75], v[78:79]
    v_pk_add_f32 v[72:73], v[72:73], v[80:81]
    v_pk_add_f32 v[74:75], v[74:75], v[82:83]
    v_pk_add_f32 v[72:73], v[72:73], v[84:85]
    v_pk_add_f32 v[74:75], v[74:75], v[86:87]
    v_pk_add_f32 v[72:73], v[72:73], v[88:89]
    v_pk_add_f32 v[74:75], v[74:75], v[90:91]
    v_pk_add_f32 v[72:73], v[72:73], v[92:93]
    v_pk_add_f32 v[74:75], v[74:75], v[94:95]
    v_pk_add_f32 v[72:73], v[72:73], v[96:97]
    v_pk_add_f32 v[74:75], v[74:75], v[98:99]
    v_pk_add_f32 v[72:73], v[72:73], v[100:101]
    v_pk_add_f32 v[74:75], v[74:75], v[102:103]
    v_pk_add_f32 v[72:73], v[72:73], v[104:105]
    v_pk_add_f32 v[74:75], v[74:75], v[106:107]
    v_pk_add_f32 v[72:73], v[72:73], v[108:109]
    v_pk_add_f32 v[74:75], v[74:75], v[110:111]
    v_pk_add_f32 v[72:73], v[72:73], v[112:113]
    v_pk_add_f32 v[74:75], v[74:75], v[114:115]
    v_pk_add_f32 v[72:73], v[72:73], v[116:117]
    v_pk_add_f32 v[74:75], v[74:75], v[118:119]
    v_pk_add_f32 v[72:73], v[72:73], v[120:121]
    v_pk_add_f32 v[74:75], v[74:75], v[122:123]
    v_pk_add_f32 v[72:73], v[72:73], v[124:125]
    v_pk_add_f32 v[74:75], v[74:75], v[126:127]
    v_pk_add_f32 v[72:73], v[72:73], v[128:129]
    v_pk_add_f32 v[74:75], v[74:75], v[130:131]
    v_pk_add_f32 v[72:73], v[72:73], v[132:133]
    v_pk_add_f32 v[74:75], v[74:75], v[134:135]

    v_lshlrev_b32 v31, 4, v0
    v_add_u32 v31, 123904, v31
    s_mov_b32 exec_lo, -1
    s_mov_b32 exec_hi, 0xffff
    ds_write_b128 v31, v[72:75]
    s_mov_b64 exec, -1
    s_waitcnt lgkmcnt(0)

    s_barrier
L_sequential_preLN__sliding_block__glu_gated_bilinear__prompt_kernel_Ahend_10:
L_sequential_preLN__sliding_block__glu_gated_bilinear__prompt_kernel_AX1_3:
    s_setprio 0
    s_barrier
    v_mov_b32 v30, 163824
    ds_read_b32 v30, v30
    s_waitcnt lgkmcnt(0)
    v_readfirstlane_b32 s62, v30
    s_cmp_lt_u32 s40, 4
    s_cbranch_scc1 L_sequential_preLN__sliding_block__glu_gated_bilinear__prompt_kernel_Aset_13
    s_cmp_eq_u32 s40, 6
    s_cbranch_scc0 L_sequential_preLN__sliding_block__glu_gated_bilinear__prompt_kernel_nokvflag_14
    s_lshl_b32 s3, s42, 12
    s_lshl_b32 s4, s41, 7
    s_add_u32 s3, s3, s4
    s_add_u32 s47, s3, 131072

    v_mov_b32 v30, s47
    v_mov_b32 v31, s62
    s_mov_b64 exec, 1
    buffer_store_dword v31, v30, s[28:31], 0 offen sc1
    s_mov_b64 exec, -1

L_sequential_preLN__sliding_block__glu_gated_bilinear__prompt_kernel_nokvflag_14:

    s_sub_u32 s45, s40, 4
    s_and_b32 s5, s45, 1
    s_lshr_b32 s6, s45, 1
    s_lshl_b32 s4, s42, 1
    s_add_u32 s4, s4, s5
    s_add_u32 s4, s4, 32
    s_lshl_b32 s46, s4, 17
    v_lshrrev_b32 v30, 2, v0
    v_lshrrev_b32 v31, 4, v0
    v_sub_u32 v32, 0, v31
    v_and_b32 v32, 3, v32
    v_and_b32 v33, 1, v31
    v_lshlrev_b32 v33, 1, v33
    v_and_b32 v34, 3, v0
    v_xor_b32 v32, v32, v34
    v_xor_b32 v33, v33, v34
    s_lshl_b32 s3, s41, 7
    s_sub_u32 s3, s3, 256
    s_lshl_b32 s7, s6, 7
    s_add_u32 s3, s3, s7
    v_add_u32 v30, s3, v30
    v_lshlrev_b32 v31, 6, v30
    v_add_u32 v31, s46, v31
    v_lshl_add_u32 v32, v32, 4, v31
    v_lshl_add_u32 v33, v33, 4, v31
    v_add_u32 v33, 4194304, v33
    s_mul_i32 s52, s5, 24576
    s_lshl_b32 s7, s6, 13
    s_add_u32 s52, s52, s7
    s_mov_b32 s53, 0x7ff00000

    v_add_u32 v31, 0, v30
    v_cmp_gt_i32 vcc, 0, v31
    v_add_u32 v36, 0, v32
    v_add_u32 v37, 0, v33
    v_mov_b32 v34, s53
    v_cndmask_b32 v40, v36, v34, vcc
    v_cndmask_b32 v48, v37, v34, vcc

    v_add_u32 v31, 16, v30
    v_cmp_gt_i32 vcc, 0, v31
    v_add_u32 v36, 1024, v32
    v_add_u32 v37, 1024, v33
    v_mov_b32 v34, s53
    v_cndmask_b32 v41, v36, v34, vcc
    v_cndmask_b32 v49, v37, v34, vcc

    v_add_u32 v31, 32, v30
    v_cmp_gt_i32 vcc, 0, v31
    v_add_u32 v36, 2048, v32
    v_add_u32 v37, 2048, v33
    v_mov_b32 v34, s53
    v_cndmask_b32 v42, v36, v34, vcc
    v_cndmask_b32 v50, v37, v34, vcc

    v_add_u32 v31, 48, v30
    v_cmp_gt_i32 vcc, 0, v31
    v_add_u32 v36, 3072, v32
    v_add_u32 v37, 3072, v33
    v_mov_b32 v34, s53
    v_cndmask_b32 v43, v36, v34, vcc
    v_cndmask_b32 v51, v37, v34, vcc

    v_add_u32 v31, 64, v30
    v_cmp_gt_i32 vcc, 0, v31
    v_add_u32 v36, 4096, v32
    v_add_u32 v37, 4096, v33
    v_mov_b32 v34, s53
    v_cndmask_b32 v44, v36, v34, vcc
    v_cndmask_b32 v52, v37, v34, vcc

    v_add_u32 v31, 80, v30
    v_cmp_gt_i32 vcc, 0, v31
    v_add_u32 v36, 5120, v32
    v_add_u32 v37, 5120, v33
    v_mov_b32 v34, s53
    v_cndmask_b32 v45, v36, v34, vcc
    v_cndmask_b32 v53, v37, v34, vcc

    v_add_u32 v31, 96, v30
    v_cmp_gt_i32 vcc, 0, v31
    v_add_u32 v36, 6144, v32
    v_add_u32 v37, 6144, v33
    v_mov_b32 v34, s53
    v_cndmask_b32 v46, v36, v34, vcc
    v_cndmask_b32 v54, v37, v34, vcc

    v_add_u32 v31, 112, v30
    v_cmp_gt_i32 vcc, 0, v31
    v_add_u32 v36, 7168, v32
    v_add_u32 v37, 7168, v33
    v_mov_b32 v34, s53
    v_cndmask_b32 v47, v36, v34, vcc
    v_cndmask_b32 v55, v37, v34, vcc

    s_lshl_b32 s48, 3, s41
    s_lshr_b32 s48, s48, 2
    s_mov_b32 s49, 0
    s_lshl_b32 s3, s42, 12
    s_add_u32 s47, s3, 131072

    v_mbcnt_lo_u32_b32 v30, -1, 0
    v_mbcnt_hi_u32_b32 v30, -1, v30

    v_lshlrev_b32 v30, 7, v30
    v_add_u32 v30, s47, v30
    v_mov_b32 v31, 0x7fff0000
    v_cndmask_b32 v30, v31, v30, s[48:49]
    s_mov_b32 s63, 0

    buffer_load_dword v31, v30, s[28:31], 0 offen sc1
L_sequential_preLN__sliding_block__glu_gated_bilinear__prompt_kernel_poll_15:
    buffer_load_dword v32, v30, s[28:31], 0 offen sc1
    s_waitcnt vmcnt(1)
    v_cmp_eq_u32 vcc, s62, v31
    s_nop 1
    s_and_b64 s[6:7], vcc, s[48:49]
    s_cmp_eq_u64 s[6:7], s[48:49]
    s_cbranch_scc1 L_sequential_preLN__sliding_block__glu_gated_bilinear__prompt_kernel_polld_16
    buffer_load_dword v31, v30, s[28:31], 0 offen sc1
    s_waitcnt vmcnt(1)
    v_cmp_eq_u32 vcc, s62, v32
    s_nop 1
    s_and_b64 s[6:7], vcc, s[48:49]
    s_cmp_eq_u64 s[6:7], s[48:49]
    s_cbranch_scc1 L_sequential_preLN__sliding_block__glu_gated_bilinear__prompt_kernel_polld_16
    s_add_u32 s63, s63, 1
    s_cmp_lt_u32 s63, 40000
    s_cbranch_scc1 L_sequential_preLN__sliding_block__glu_gated_bilinear__prompt_kernel_poll_15
L_sequential_preLN__sliding_block__glu_gated_bilinear__prompt_kernel_polld_16:

    s_add_u32 s8, s82, 4194304
    s_addc_u32 s9, s83, 0
    s_mov_b32 s10, 12582912
    s_mov_b32 s11, 0x20000
    s_add_u32 m0, s52, 0
    s_nop 0
    buffer_load_dwordx4 v40, s[8:11], 0 offen sc1 lds
    s_add_u32 m0, s52, 1024
    s_nop 0
    buffer_load_dwordx4 v41, s[8:11], 0 offen sc1 lds
    s_add_u32 m0, s52, 2048
    s_nop 0
    buffer_load_dwordx4 v42, s[8:11], 0 offen sc1 lds
    s_add_u32 m0, s52, 3072
    s_nop 0
    buffer_load_dwordx4 v43, s[8:11], 0 offen sc1 lds
    s_add_u32 m0, s52, 4096
    s_nop 0
    buffer_load_dwordx4 v44, s[8:11], 0 offen sc1 lds
    s_add_u32 m0, s52, 5120
    s_nop 0
    buffer_load_dwordx4 v45, s[8:11], 0 offen sc1 lds
    s_add_u32 m0, s52, 6144
    s_nop 0
    buffer_load_dwordx4 v46, s[8:11], 0 offen sc1 lds
    s_add_u32 m0, s52, 7168
    s_nop 0
    buffer_load_dwordx4 v47, s[8:11], 0 offen sc1 lds
    s_add_u32 m0, s52, 49152
    s_nop 0
    buffer_load_dwordx4 v48, s[8:11], 0 offen sc1 lds
    s_add_u32 m0, s52, 50176
    s_nop 0
    buffer_load_dwordx4 v49, s[8:11], 0 offen sc1 lds
    s_add_u32 m0, s52, 51200
    s_nop 0
    buffer_load_dwordx4 v50, s[8:11], 0 offen sc1 lds
    s_add_u32 m0, s52, 52224
    s_nop 0
    buffer_load_dwordx4 v51, s[8:11], 0 offen sc1 lds
    s_add_u32 m0, s52, 53248
    s_nop 0
    buffer_load_dwordx4 v52, s[8:11], 0 offen sc1 lds
    s_add_u32 m0, s52, 54272
    s_nop 0
    buffer_load_dwordx4 v53, s[8:11], 0 offen sc1 lds
    s_add_u32 m0, s52, 55296
    s_nop 0
    buffer_load_dwordx4 v54, s[8:11], 0 offen sc1 lds
    s_add_u32 m0, s52, 56320
    s_nop 0
    buffer_load_dwordx4 v55, s[8:11], 0 offen sc1 lds
L_sequential_preLN__sliding_block__glu_gated_bilinear__prompt_kernel_Aset_13:
    v_mbcnt_lo_u32_b32 v163, -1, 0
    v_mbcnt_hi_u32_b32 v163, -1, v163

    s_and_b32 s43, s40, 1
    s_lshr_b32 s44, s40, 1
    s_lshl_b32 s3, s41, 7
    s_lshl_b32 s4, s44, 5
    s_add_u32 s50, s3, s4
    v_and_b32 v150, 15, v163
    v_lshrrev_b32 v151, 2, v150
    v_sub_u32 v151, 0, v151
    v_and_b32 v151, 3, v151
    v_lshrrev_b32 v152, 4, v163
    v_xor_b32 v151, v151, v152
    v_lshlrev_b32 v150, 6, v150
    v_lshl_add_u32 v150, v151, 4, v150
    s_mul_i32 s3, s43, 24576
    s_lshl_b32 s4, s44, 11
    s_add_u32 s3, s3, s4
    v_add_u32 v160, s3, v150
    s_lshl_b32 s5, s43, 13
    s_add_u32 s5, s5, s4
    s_add_u32 s5, s5, 124928
    v_add_u32 v153, s5, v150
    ds_read_b128 a[72:75], v153
    ds_read_b128 a[76:79], v153 offset:1024
    v_lshrrev_b32 v150, 2, v163
    v_lshlrev_b32 v150, 6, v150
    v_bfe_u32 v151, v163, 4, 1
    v_lshlrev_b32 v151, 1, v151
    v_bfe_u32 v152, v163, 1, 1
    v_xor_b32 v151, v151, v152
    v_lshl_add_u32 v150, v151, 4, v150
    v_and_b32 v151, 1, v163
    v_lshl_add_u32 v150, v151, 3, v150
    s_add_u32 s3, s3, 49152
    v_add_u32 v161, s3, v150
    v_xor_b32 v162, 32, v161
    v_mov_b32 v154, 0xf149f2ca
    v_and_b32 v150, 15, v163
    s_lshl_b32 s3, s44, 5
    v_add_u32 v150, s3, v150
    v_lshlrev_b32 v150, 4, v150
    v_lshrrev_b32 v151, 4, v163
    v_and_b32 v152, 1, v151
    v_lshrrev_b32 v151, 1, v151
    v_lshl_add_u32 v151, v152, 1, v151
    v_lshl_add_u32 v150, v151, 11, v150
    s_lshl_b32 s3, s42, 1
    s_add_u32 s3, s3, s43
    s_lshl_b32 s3, s3, 13
    s_lshl_b32 s4, s41, 18
    s_add_u32 s3, s3, s4
    v_add_u32 v155, s3, v150
    v_and_b32 v150, 15, v163
    v_lshrrev_b32 v151, 4, v163
    v_lshlrev_b32 v151, 2, v151

    v_add_u32 v152, 0, v151
    v_cmp_gt_u32 s[54:55], v152, v150
    v_add_u32 v152, 1, v151
    v_cmp_gt_u32 s[56:57], v152, v150
    v_add_u32 v152, 2, v151
    v_cmp_gt_u32 s[58:59], v152, v150
    v_add_u32 v152, 3, v151
    v_cmp_gt_u32 s[60:61], v152, v150
    v_mov_b32 v144, 0x3f803f80
    v_mov_b32 v145, 0x3f803f80
    v_mov_b32 v146, 0x3f803f80
    v_mov_b32 v147, 0x3f803f80
    s_sub_u32 s51, 256, s50
    s_lshr_b32 s51, s51, 4
    s_cmp_lt_u32 s40, 4
    s_cbranch_scc1 L_sequential_preLN__sliding_block__glu_gated_bilinear__prompt_kernel_Awk_17
    s_waitcnt vmcnt(8)
L_sequential_preLN__sliding_block__glu_gated_bilinear__prompt_kernel_Awk_17:
    s_barrier
    s_cmp_lt_u32 s41, 2
    s_cbranch_scc1 L_sequential_preLN__sliding_block__glu_gated_bilinear__prompt_kernel_attslow_18
    v_mov_b32 v148, v154
    v_mov_b32 v149, v154
    ds_read_b128 a[0:3], v160 offset:0
    ds_read_b128 a[4:7], v160 offset:1024
    ds_read_b128 a[8:11], v160 offset:2048
    ds_read_b128 a[12:15], v160 offset:3072
    ds_read_b128 a[16:19], v160 offset:4096
    ds_read_b128 a[20:23], v160 offset:5120
    ds_read_b128 a[24:27], v160 offset:6144
    ds_read_b128 a[28:31], v160 offset:7168
    ds_read_b128 a[32:35], v160 offset:8192
    s_waitcnt lgkmcnt(7)
    v_mfma_f32_16x16x32_bf16 v[0:3], a[0:3], a[72:75], 0
    ds_read_b128 a[36:39], v160 offset:9216
    v_mfma_f32_16x16x32_bf16 v[4:7], a[4:7], a[72:75], 0
    v_mfma_f32_16x16x32_bf16 v[20:23], a[4:7], a[76:79], 0
    ds_read_b128 a[40:43], v160 offset:10240
    s_waitcnt lgkmcnt(7)
    v_mfma_f32_16x16x32_bf16 v[8:11], a[8:11], a[72:75], 0
    v_mfma_f32_16x16x32_bf16 v[24:27], a[8:11], a[76:79], 0
    s_nop 1
    v_cndmask_b32 v0, v154, v0, s[54:55]
    v_cndmask_b32 v1, v154, v1, s[56:57]
    v_cndmask_b32 v2, v154, v2, s[58:59]
    v_cndmask_b32 v3, v154, v3, s[60:61]
    v_max3_f32 v148, v148, v0, v1
    v_max3_f32 v148, v148, v2, v3
    ds_read_b128 a[44:47], v160 offset:11264
    v_mfma_f32_16x16x32_bf16 v[12:15], a[12:15], a[72:75], 0
    v_mfma_f32_16x16x32_bf16 v[28:31], a[12:15], a[76:79], 0
    v_max3_f32 v148, v148, v4, v5
    v_max3_f32 v148, v148, v6, v7
    v_cndmask_b32 v20, v154, v20, s[54:55]
    v_cndmask_b32 v21, v154, v21, s[56:57]
    v_cndmask_b32 v22, v154, v22, s[58:59]
    v_cndmask_b32 v23, v154, v23, s[60:61]
    v_max3_f32 v149, v149, v20, v21
    v_max3_f32 v149, v149, v22, v23
    ds_read_b128 a[48:51], v160 offset:12288
    s_waitcnt lgkmcnt(7)
    v_mfma_f32_16x16x32_bf16 v[0:3], a[16:19], a[72:75], 0
    v_mfma_f32_16x16x32_bf16 v[16:19], a[16:19], a[76:79], 0
    v_max3_f32 v148, v148, v8, v9
    v_max3_f32 v148, v148, v10, v11
    v_max3_f32 v149, v149, v24, v25
    v_max3_f32 v149, v149, v26, v27
    ds_read_b128 a[52:55], v160 offset:13312
    v_mfma_f32_16x16x32_bf16 v[4:7], a[20:23], a[72:75], 0
    v_mfma_f32_16x16x32_bf16 v[20:23], a[20:23], a[76:79], 0
    v_max3_f32 v148, v148, v12, v13
    v_max3_f32 v148, v148, v14, v15
    v_max3_f32 v149, v149, v28, v29
    v_max3_f32 v149, v149, v30, v31
    ds_read_b128 a[56:59], v160 offset:14336
    s_waitcnt lgkmcnt(7)
    v_mfma_f32_16x16x32_bf16 v[8:11], a[24:27], a[72:75], 0
    v_mfma_f32_16x16x32_bf16 v[24:27], a[24:27], a[76:79], 0
    v_max3_f32 v148, v148, v0, v1
    v_max3_f32 v148, v148, v2, v3
    v_max3_f32 v149, v149, v16, v17
    v_max3_f32 v149, v149, v18, v19
    ds_read_b128 a[60:63], v160 offset:15360
    v_mfma_f32_16x16x32_bf16 v[12:15], a[28:31], a[72:75], 0
    v_mfma_f32_16x16x32_bf16 v[28:31], a[28:31], a[76:79], 0
    v_max3_f32 v148, v148, v4, v5
    v_max3_f32 v148, v148, v6, v7
    v_max3_f32 v149, v149, v20, v21
    v_max3_f32 v149, v149, v22, v23
    ds_read_b128 a[64:67], v160 offset:16384
    s_waitcnt lgkmcnt(7)
    v_mfma_f32_16x16x32_bf16 v[0:3], a[32:35], a[72:75], 0
    v_mfma_f32_16x16x32_bf16 v[16:19], a[32:35], a[76:79], 0
    v_max3_f32 v148, v148, v8, v9
    v_max3_f32 v148, v148, v10, v11
    v_max3_f32 v149, v149, v24, v25
    v_max3_f32 v149, v149, v26, v27
    ds_read_b128 a[68:71], v160 offset:17408
    v_mfma_f32_16x16x32_bf16 v[4:7], a[36:39], a[72:75], 0
    v_mfma_f32_16x16x32_bf16 v[20:23], a[36:39], a[76:79], 0
    v_max3_f32 v148, v148, v12, v13
    v_max3_f32 v148, v148, v14, v15
    v_max3_f32 v149, v149, v28, v29
    v_max3_f32 v149, v149, v30, v31
    s_waitcnt lgkmcnt(6)
    v_mfma_f32_16x16x32_bf16 v[8:11], a[40:43], a[72:75], 0
    v_mfma_f32_16x16x32_bf16 v[24:27], a[40:43], a[76:79], 0
    v_max3_f32 v148, v148, v0, v1
    v_max3_f32 v148, v148, v2, v3
    v_max3_f32 v149, v149, v16, v17
    v_max3_f32 v149, v149, v18, v19
    v_mfma_f32_16x16x32_bf16 v[12:15], a[44:47], a[72:75], 0
    v_mfma_f32_16x16x32_bf16 v[28:31], a[44:47], a[76:79], 0
    v_max3_f32 v148, v148, v4, v5
    v_max3_f32 v148, v148, v6, v7
    v_max3_f32 v149, v149, v20, v21
    v_max3_f32 v149, v149, v22, v23
    s_waitcnt lgkmcnt(4)
    v_mfma_f32_16x16x32_bf16 v[0:3], a[48:51], a[72:75], 0
    v_mfma_f32_16x16x32_bf16 v[16:19], a[48:51], a[76:79], 0
    v_max3_f32 v148, v148, v8, v9
    v_max3_f32 v148, v148, v10, v11
    v_max3_f32 v149, v149, v24, v25
    v_max3_f32 v149, v149, v26, v27
    v_mfma_f32_16x16x32_bf16 v[4:7], a[52:55], a[72:75], 0
    v_mfma_f32_16x16x32_bf16 v[20:23], a[52:55], a[76:79], 0
    v_max3_f32 v148, v148, v12, v13
    v_max3_f32 v148, v148, v14, v15
    v_max3_f32 v149, v149, v28, v29
    v_max3_f32 v149, v149, v30, v31
    s_waitcnt lgkmcnt(2)
    v_mfma_f32_16x16x32_bf16 v[8:11], a[56:59], a[72:75], 0
    v_mfma_f32_16x16x32_bf16 v[24:27], a[56:59], a[76:79], 0
    v_max3_f32 v148, v148, v0, v1
    v_max3_f32 v148, v148, v2, v3
    v_max3_f32 v149, v149, v16, v17
    v_max3_f32 v149, v149, v18, v19
    v_mfma_f32_16x16x32_bf16 v[12:15], a[60:63], a[72:75], 0
    v_mfma_f32_16x16x32_bf16 v[28:31], a[60:63], a[76:79], 0
    v_max3_f32 v148, v148, v4, v5
    v_max3_f32 v148, v148, v6, v7
    v_max3_f32 v149, v149, v20, v21
    v_max3_f32 v149, v149, v22, v23
    s_waitcnt lgkmcnt(0)
    v_mfma_f32_16x16x32_bf16 v[0:3], a[64:67], a[72:75], 0
    v_mfma_f32_16x16x32_bf16 v[16:19], a[64:67], a[76:79], 0
    v_max3_f32 v148, v148, v8, v9
    v_max3_f32 v148, v148, v10, v11
    v_max3_f32 v149, v149, v24, v25
    v_max3_f32 v149, v149, v26, v27
    v_mfma_f32_16x16x32_bf16 v[20:23], a[68:71], a[76:79], 0
    v_max3_f32 v148, v148, v12, v13
    v_max3_f32 v148, v148, v14, v15
    v_max3_f32 v149, v149, v28, v29
    v_max3_f32 v149, v149, v30, v31
    s_nop 5
    v_cndmask_b32 v0, v0, v154, s[54:55]
    v_cndmask_b32 v1, v1, v154, s[56:57]
    v_cndmask_b32 v2, v2, v154, s[58:59]
    v_cndmask_b32 v3, v3, v154, s[60:61]
    v_max3_f32 v148, v148, v0, v1
    v_max3_f32 v148, v148, v2, v3
    v_max3_f32 v149, v149, v16, v17
    v_max3_f32 v149, v149, v18, v19
    v_cndmask_b32 v20, v20, v154, s[54:55]
    v_cndmask_b32 v21, v21, v154, s[56:57]
    v_cndmask_b32 v22, v22, v154, s[58:59]
    v_cndmask_b32 v23, v23, v154, s[60:61]
    v_max3_f32 v149, v149, v20, v21
    v_max3_f32 v149, v149, v22, v23
    v_mov_b32 v150, v148
    v_mov_b32 v151, v149
    s_nop 1
    v_permlane16_swap_b32 v150, v148
    v_permlane16_swap_b32 v151, v149
    s_nop 1
    v_max_f32 v148, v148, v150
    v_max_f32 v149, v149, v151
    v_mov_b32 v150, v148
    v_mov_b32 v151, v149
    s_nop 1
    v_permlane32_swap_b32 v150, v148
    v_permlane32_swap_b32 v151, v149
    s_nop 1
    v_max_f32 v148, v148, v150
    v_max_f32 v149, v149, v151
    v_sub_f32 v112, 0, v148
    v_sub_f32 v113, 0, v148
    v_sub_f32 v114, 0, v148
    v_sub_f32 v115, 0, v148
    v_sub_f32 v116, 0, v149
    v_sub_f32 v117, 0, v149
    v_sub_f32 v118, 0, v149
    v_sub_f32 v119, 0, v149
    s_cmp_lt_u32 s40, 4
    s_cbranch_scc1 L_sequential_preLN__sliding_block__glu_gated_bilinear__prompt_kernel_Avw_20
    s_waitcnt vmcnt(0)
L_sequential_preLN__sliding_block__glu_gated_bilinear__prompt_kernel_Avw_20:
    s_barrier
    s_cmp_lt_u32 s40, 4
    s_cbranch_scc0 L_sequential_preLN__sliding_block__glu_gated_bilinear__prompt_kernel_notouch_21
    v_mbcnt_lo_u32_b32 v164, -1, 0
    v_mbcnt_hi_u32_b32 v164, -1, v164

    s_lshl_b32 s3, s2, 2
    s_add_u32 s3, s3, s40
    s_lshl_b32 s3, s3, 13
    v_lshlrev_b32 v164, 7, v164
    v_add_u32 v164, s3, v164

    s_mov_b32 s4, s72
    s_mov_b32 s5, s73
    s_mov_b32 s6, 7340032
    s_mov_b32 s7, 0x20000
    buffer_load_dword v165, v164, s[4:7], 0 offen
L_sequential_preLN__sliding_block__glu_gated_bilinear__prompt_kernel_notouch_21:
    v_mfma_f32_16x16x32_bf16 v[0:3], a[0:3], a[72:75], v[112:115]
    v_mfma_f32_16x16x32_bf16 v[4:7], a[4:7], a[72:75], v[112:115]
    v_mfma_f32_16x16x32_bf16 v[28:31], a[4:7], a[76:79], v[116:119]
    s_nop 3
    ds_read_b64_tr_b16 v[48:49], v161 offset:0
    ds_read_b64_tr_b16 v[50:51], v161 offset:1024
    ds_read_b64_tr_b16 v[52:53], v162 offset:0
    ds_read_b64_tr_b16 v[54:55], v162 offset:1024
    s_nop 3
    v_cndmask_b32 v0, v154, v0, s[54:55]
    v_cndmask_b32 v1, v154, v1, s[56:57]
    v_cndmask_b32 v2, v154, v2, s[58:59]
    v_cndmask_b32 v3, v154, v3, s[60:61]
    v_exp_f32 v0, v0
    v_exp_f32 v1, v1
    v_exp_f32 v2, v2
    v_exp_f32 v3, v3
    v_exp_f32 v4, v4
    v_mfma_f32_16x16x32_bf16 v[8:11], a[8:11], a[72:75], v[112:115]
    v_exp_f32 v5, v5
    v_exp_f32 v6, v6
    v_exp_f32 v7, v7
    v_cvt_pk_bf16_f32 v0, v0, v1
    v_cvt_pk_bf16_f32 v1, v2, v3
    v_cvt_pk_bf16_f32 v2, v4, v5
    v_mfma_f32_16x16x32_bf16 v[32:35], a[8:11], a[76:79], v[116:119]
    v_cvt_pk_bf16_f32 v3, v6, v7
    v_cndmask_b32 v28, v154, v28, s[54:55]
    v_cndmask_b32 v29, v154, v29, s[56:57]
    v_cndmask_b32 v30, v154, v30, s[58:59]
    v_cndmask_b32 v31, v154, v31, s[60:61]
    v_exp_f32 v28, v28
    v_exp_f32 v29, v29
    v_mfma_f32_16x16x32_bf16 v[12:15], a[12:15], a[72:75], v[112:115]
    v_exp_f32 v30, v30
    v_exp_f32 v31, v31
    v_mov_b32 v24, 0
    v_mov_b32 v25, 0
    v_cvt_pk_bf16_f32 v26, v28, v29
    v_cvt_pk_bf16_f32 v27, v30, v31
    v_mfma_f32_16x16x32_bf16 v[36:39], a[12:15], a[76:79], v[116:119]
    ds_read_b64_tr_b16 v[56:57], v161 offset:2048
    ds_read_b64_tr_b16 v[58:59], v161 offset:3072
    ds_read_b64_tr_b16 v[60:61], v162 offset:2048
    ds_read_b64_tr_b16 v[62:63], v162 offset:3072
    s_waitcnt lgkmcnt(4)
    v_exp_f32 v8, v8
    v_exp_f32 v9, v9
    v_exp_f32 v10, v10
    v_exp_f32 v11, v11
    v_exp_f32 v12, v12
    v_mfma_f32_16x16x32_bf16 v[120:123], v[48:51], v[0:3], 0
    v_exp_f32 v13, v13
    v_exp_f32 v14, v14
    v_mfma_f32_16x16x32_bf16 v[16:19], a[16:19], a[72:75], v[112:115]
    v_exp_f32 v15, v15
    v_cvt_pk_bf16_f32 v8, v8, v9
    v_mfma_f32_16x16x32_bf16 v[124:127], v[52:55], v[0:3], 0
    v_cvt_pk_bf16_f32 v9, v10, v11
    v_cvt_pk_bf16_f32 v10, v12, v13
    v_mfma_f32_16x16x32_bf16 v[40:43], a[16:19], a[76:79], v[116:119]
    v_cvt_pk_bf16_f32 v11, v14, v15
    v_exp_f32 v32, v32
    v_mfma_f32_16x16x32_bf16 v[136:139], v[144:147], v[0:3], 0
    v_exp_f32 v33, v33
    v_exp_f32 v34, v34
    v_exp_f32 v35, v35
    v_mfma_f32_16x16x32_bf16 v[20:23], a[20:23], a[72:75], v[112:115]
    v_exp_f32 v36, v36
    v_exp_f32 v37, v37
    v_mfma_f32_16x16x32_bf16 v[128:131], v[48:51], v[24:27], 0
    v_exp_f32 v38, v38
    v_exp_f32 v39, v39
    v_mfma_f32_16x16x32_bf16 v[44:47], a[20:23], a[76:79], v[116:119]
    v_cvt_pk_bf16_f32 v32, v32, v33
    v_cvt_pk_bf16_f32 v33, v34, v35
    v_mfma_f32_16x16x32_bf16 v[132:135], v[52:55], v[24:27], 0
    v_cvt_pk_bf16_f32 v34, v36, v37
    v_cvt_pk_bf16_f32 v35, v38, v39
    v_mfma_f32_16x16x32_bf16 v[140:143], v[144:147], v[24:27], 0
    ds_read_b64_tr_b16 v[64:65], v161 offset:4096
    ds_read_b64_tr_b16 v[66:67], v161 offset:5120
    ds_read_b64_tr_b16 v[68:69], v162 offset:4096
    ds_read_b64_tr_b16 v[70:71], v162 offset:5120
    s_waitcnt lgkmcnt(4)
    v_exp_f32 v16, v16
    v_exp_f32 v17, v17
    v_exp_f32 v18, v18
    v_exp_f32 v19, v19
    v_exp_f32 v20, v20
    v_mfma_f32_16x16x32_bf16 v[120:123], v[56:59], v[8:11], v[120:123]
    v_exp_f32 v21, v21
    v_exp_f32 v22, v22
    v_mfma_f32_16x16x32_bf16 v[0:3], a[24:27], a[72:75], v[112:115]
    v_exp_f32 v23, v23
    v_cvt_pk_bf16_f32 v16, v16, v17
    v_mfma_f32_16x16x32_bf16 v[124:127], v[60:63], v[8:11], v[124:127]
    v_cvt_pk_bf16_f32 v17, v18, v19
    v_cvt_pk_bf16_f32 v18, v20, v21
    v_mfma_f32_16x16x32_bf16 v[24:27], a[24:27], a[76:79], v[116:119]
    v_cvt_pk_bf16_f32 v19, v22, v23
    v_exp_f32 v40, v40
    v_mfma_f32_16x16x32_bf16 v[136:139], v[144:147], v[8:11], v[136:139]
    v_exp_f32 v41, v41
    v_exp_f32 v42, v42
    v_exp_f32 v43, v43
    v_mfma_f32_16x16x32_bf16 v[4:7], a[28:31], a[72:75], v[112:115]
    v_exp_f32 v44, v44
    v_exp_f32 v45, v45
    v_mfma_f32_16x16x32_bf16 v[128:131], v[56:59], v[32:35], v[128:131]
    v_exp_f32 v46, v46
    v_exp_f32 v47, v47
    v_mfma_f32_16x16x32_bf16 v[28:31], a[28:31], a[76:79], v[116:119]
    v_cvt_pk_bf16_f32 v40, v40, v41
    v_cvt_pk_bf16_f32 v41, v42, v43
    v_mfma_f32_16x16x32_bf16 v[132:135], v[60:63], v[32:35], v[132:135]
    v_cvt_pk_bf16_f32 v42, v44, v45
    v_cvt_pk_bf16_f32 v43, v46, v47
    v_mfma_f32_16x16x32_bf16 v[140:143], v[144:147], v[32:35], v[140:143]
    ds_read_b64_tr_b16 v[48:49], v161 offset:6144
    ds_read_b64_tr_b16 v[50:51], v161 offset:7168
    ds_read_b64_tr_b16 v[52:53], v162 offset:6144
    ds_read_b64_tr_b16 v[54:55], v162 offset:7168
    s_waitcnt lgkmcnt(4)
    v_exp_f32 v0, v0
    v_exp_f32 v1, v1
    v_exp_f32 v2, v2
    v_exp_f32 v3, v3
    v_exp_f32 v4, v4
    v_mfma_f32_16x16x32_bf16 v[120:123], v[64:67], v[16:19], v[120:123]
    v_exp_f32 v5, v5
    v_exp_f32 v6, v6
    v_mfma_f32_16x16x32_bf16 v[8:11], a[32:35], a[72:75], v[112:115]
    v_exp_f32 v7, v7
    v_cvt_pk_bf16_f32 v0, v0, v1
    v_mfma_f32_16x16x32_bf16 v[124:127], v[68:71], v[16:19], v[124:127]
    v_cvt_pk_bf16_f32 v1, v2, v3
    v_cvt_pk_bf16_f32 v2, v4, v5
    v_mfma_f32_16x16x32_bf16 v[32:35], a[32:35], a[76:79], v[116:119]
    v_cvt_pk_bf16_f32 v3, v6, v7
    v_exp_f32 v24, v24
    v_mfma_f32_16x16x32_bf16 v[136:139], v[144:147], v[16:19], v[136:139]
    v_exp_f32 v25, v25
    v_exp_f32 v26, v26
    v_exp_f32 v27, v27
    v_mfma_f32_16x16x32_bf16 v[12:15], a[36:39], a[72:75], v[112:115]
    v_exp_f32 v28, v28
    v_exp_f32 v29, v29
    v_mfma_f32_16x16x32_bf16 v[128:131], v[64:67], v[40:43], v[128:131]
    v_exp_f32 v30, v30
    v_exp_f32 v31, v31
    v_mfma_f32_16x16x32_bf16 v[36:39], a[36:39], a[76:79], v[116:119]
    v_cvt_pk_bf16_f32 v24, v24, v25
    v_cvt_pk_bf16_f32 v25, v26, v27
    v_mfma_f32_16x16x32_bf16 v[132:135], v[68:71], v[40:43], v[132:135]
    v_cvt_pk_bf16_f32 v26, v28, v29
    v_cvt_pk_bf16_f32 v27, v30, v31
    v_mfma_f32_16x16x32_bf16 v[140:143], v[144:147], v[40:43], v[140:143]
    ds_read_b64_tr_b16 v[56:57], v161 offset:8192
    ds_read_b64_tr_b16 v[58:59], v161 offset:9216
    ds_read_b64_tr_b16 v[60:61], v162 offset:8192
    ds_read_b64_tr_b16 v[62:63], v162 offset:9216
    s_waitcnt lgkmcnt(4)
    v_exp_f32 v8, v8
    v_exp_f32 v9, v9
    v_exp_f32 v10, v10
    v_exp_f32 v11, v11
    v_exp_f32 v12, v12
    v_mfma_f32_16x16x32_bf16 v[120:123], v[48:51], v[0:3], v[120:123]
    v_exp_f32 v13, v13
    v_exp_f32 v14, v14
    v_mfma_f32_16x16x32_bf16 v[16:19], a[40:43], a[72:75], v[112:115]
    v_exp_f32 v15, v15
    v_cvt_pk_bf16_f32 v8, v8, v9
    v_mfma_f32_16x16x32_bf16 v[124:127], v[52:55], v[0:3], v[124:127]
    v_cvt_pk_bf16_f32 v9, v10, v11
    v_cvt_pk_bf16_f32 v10, v12, v13
    v_mfma_f32_16x16x32_bf16 v[40:43], a[40:43], a[76:79], v[116:119]
    v_cvt_pk_bf16_f32 v11, v14, v15
    v_exp_f32 v32, v32
    v_mfma_f32_16x16x32_bf16 v[136:139], v[144:147], v[0:3], v[136:139]
    v_exp_f32 v33, v33
    v_exp_f32 v34, v34
    v_exp_f32 v35, v35
    v_mfma_f32_16x16x32_bf16 v[20:23], a[44:47], a[72:75], v[112:115]
    v_exp_f32 v36, v36
    v_exp_f32 v37, v37
    v_mfma_f32_16x16x32_bf16 v[128:131], v[48:51], v[24:27], v[128:131]
    v_exp_f32 v38, v38
    v_exp_f32 v39, v39
    v_mfma_f32_16x16x32_bf16 v[44:47], a[44:47], a[76:79], v[116:119]
    v_cvt_pk_bf16_f32 v32, v32, v33
    v_cvt_pk_bf16_f32 v33, v34, v35
    v_mfma_f32_16x16x32_bf16 v[132:135], v[52:55], v[24:27], v[132:135]
    v_cvt_pk_bf16_f32 v34, v36, v37
    v_cvt_pk_bf16_f32 v35, v38, v39
    v_mfma_f32_16x16x32_bf16 v[140:143], v[144:147], v[24:27], v[140:143]
    ds_read_b64_tr_b16 v[64:65], v161 offset:10240
    ds_read_b64_tr_b16 v[66:67], v161 offset:11264
    ds_read_b64_tr_b16 v[68:69], v162 offset:10240
    ds_read_b64_tr_b16 v[70:71], v162 offset:11264
    s_waitcnt lgkmcnt(4)
    v_exp_f32 v16, v16
    v_exp_f32 v17, v17
    v_exp_f32 v18, v18
    v_exp_f32 v19, v19
    v_exp_f32 v20, v20
    v_mfma_f32_16x16x32_bf16 v[120:123], v[56:59], v[8:11], v[120:123]
    v_exp_f32 v21, v21
    v_exp_f32 v22, v22
    v_mfma_f32_16x16x32_bf16 v[0:3], a[48:51], a[72:75], v[112:115]
    v_exp_f32 v23, v23
    v_cvt_pk_bf16_f32 v16, v16, v17
    v_mfma_f32_16x16x32_bf16 v[124:127], v[60:63], v[8:11], v[124:127]
    v_cvt_pk_bf16_f32 v17, v18, v19
    v_cvt_pk_bf16_f32 v18, v20, v21
    v_mfma_f32_16x16x32_bf16 v[24:27], a[48:51], a[76:79], v[116:119]
    v_cvt_pk_bf16_f32 v19, v22, v23
    v_exp_f32 v40, v40
    v_mfma_f32_16x16x32_bf16 v[136:139], v[144:147], v[8:11], v[136:139]
    v_exp_f32 v41, v41
    v_exp_f32 v42, v42
    v_exp_f32 v43, v43
    v_mfma_f32_16x16x32_bf16 v[4:7], a[52:55], a[72:75], v[112:115]
    v_exp_f32 v44, v44
    v_exp_f32 v45, v45
    v_mfma_f32_16x16x32_bf16 v[128:131], v[56:59], v[32:35], v[128:131]
    v_exp_f32 v46, v46
    v_exp_f32 v47, v47
    v_mfma_f32_16x16x32_bf16 v[28:31], a[52:55], a[76:79], v[116:119]
    v_cvt_pk_bf16_f32 v40, v40, v41
    v_cvt_pk_bf16_f32 v41, v42, v43
    v_mfma_f32_16x16x32_bf16 v[132:135], v[60:63], v[32:35], v[132:135]
    v_cvt_pk_bf16_f32 v42, v44, v45
    v_cvt_pk_bf16_f32 v43, v46, v47
    v_mfma_f32_16x16x32_bf16 v[140:143], v[144:147], v[32:35], v[140:143]
    ds_read_b64_tr_b16 v[48:49], v161 offset:12288
    ds_read_b64_tr_b16 v[50:51], v161 offset:13312
    ds_read_b64_tr_b16 v[52:53], v162 offset:12288
    ds_read_b64_tr_b16 v[54:55], v162 offset:13312
    s_waitcnt lgkmcnt(4)
    v_exp_f32 v0, v0
    v_exp_f32 v1, v1
    v_exp_f32 v2, v2
    v_exp_f32 v3, v3
    v_exp_f32 v4, v4
    v_mfma_f32_16x16x32_bf16 v[120:123], v[64:67], v[16:19], v[120:123]
    v_exp_f32 v5, v5
    v_exp_f32 v6, v6
    v_mfma_f32_16x16x32_bf16 v[8:11], a[56:59], a[72:75], v[112:115]
    v_exp_f32 v7, v7
    v_cvt_pk_bf16_f32 v0, v0, v1
    v_mfma_f32_16x16x32_bf16 v[124:127], v[68:71], v[16:19], v[124:127]
    v_cvt_pk_bf16_f32 v1, v2, v3
    v_cvt_pk_bf16_f32 v2, v4, v5
    v_mfma_f32_16x16x32_bf16 v[32:35], a[56:59], a[76:79], v[116:119]
    v_cvt_pk_bf16_f32 v3, v6, v7
    v_exp_f32 v24, v24
    v_mfma_f32_16x16x32_bf16 v[136:139], v[144:147], v[16:19], v[136:139]
    v_exp_f32 v25, v25
    v_exp_f32 v26, v26
    v_exp_f32 v27, v27
    v_mfma_f32_16x16x32_bf16 v[12:15], a[60:63], a[72:75], v[112:115]
    v_exp_f32 v28, v28
    v_exp_f32 v29, v29
    v_mfma_f32_16x16x32_bf16 v[128:131], v[64:67], v[40:43], v[128:131]
    v_exp_f32 v30, v30
    v_exp_f32 v31, v31
    v_mfma_f32_16x16x32_bf16 v[36:39], a[60:63], a[76:79], v[116:119]
    v_cvt_pk_bf16_f32 v24, v24, v25
    v_cvt_pk_bf16_f32 v25, v26, v27
    v_mfma_f32_16x16x32_bf16 v[132:135], v[68:71], v[40:43], v[132:135]
    v_cvt_pk_bf16_f32 v26, v28, v29
    v_cvt_pk_bf16_f32 v27, v30, v31
    v_mfma_f32_16x16x32_bf16 v[140:143], v[144:147], v[40:43], v[140:143]
    ds_read_b64_tr_b16 v[56:57], v161 offset:14336
    ds_read_b64_tr_b16 v[58:59], v161 offset:15360
    ds_read_b64_tr_b16 v[60:61], v162 offset:14336
    ds_read_b64_tr_b16 v[62:63], v162 offset:15360
    s_waitcnt lgkmcnt(4)
    v_exp_f32 v8, v8
    v_exp_f32 v9, v9
    v_exp_f32 v10, v10
    v_exp_f32 v11, v11
    v_exp_f32 v12, v12
    v_mfma_f32_16x16x32_bf16 v[120:123], v[48:51], v[0:3], v[120:123]
    v_exp_f32 v13, v13
    v_exp_f32 v14, v14
    v_mfma_f32_16x16x32_bf16 v[16:19], a[64:67], a[72:75], v[112:115]
    v_exp_f32 v15, v15
    v_cvt_pk_bf16_f32 v8, v8, v9
    v_cvt_pk_bf16_f32 v9, v10, v11
    v_mfma_f32_16x16x32_bf16 v[124:127], v[52:55], v[0:3], v[124:127]
    v_cvt_pk_bf16_f32 v10, v12, v13
    v_cvt_pk_bf16_f32 v11, v14, v15
    v_mfma_f32_16x16x32_bf16 v[40:43], a[64:67], a[76:79], v[116:119]
    v_exp_f32 v32, v32
    v_exp_f32 v33, v33
    v_exp_f32 v34, v34
    v_mfma_f32_16x16x32_bf16 v[136:139], v[144:147], v[0:3], v[136:139]
    v_exp_f32 v35, v35
    v_exp_f32 v36, v36
    v_mfma_f32_16x16x32_bf16 v[44:47], a[68:71], a[76:79], v[116:119]
    v_exp_f32 v37, v37
    v_exp_f32 v38, v38
    v_exp_f32 v39, v39
    v_mfma_f32_16x16x32_bf16 v[128:131], v[48:51], v[24:27], v[128:131]
    v_cvt_pk_bf16_f32 v32, v32, v33
    v_cvt_pk_bf16_f32 v33, v34, v35
    v_mfma_f32_16x16x32_bf16 v[132:135], v[52:55], v[24:27], v[132:135]
    v_cvt_pk_bf16_f32 v34, v36, v37
    v_cvt_pk_bf16_f32 v35, v38, v39
    v_mfma_f32_16x16x32_bf16 v[140:143], v[144:147], v[24:27], v[140:143]
    ds_read_b64_tr_b16 v[64:65], v161 offset:16384
    ds_read_b64_tr_b16 v[66:67], v161 offset:17408
    ds_read_b64_tr_b16 v[68:69], v162 offset:16384
    ds_read_b64_tr_b16 v[70:71], v162 offset:17408
    s_waitcnt lgkmcnt(4)
    v_cndmask_b32 v16, v16, v154, s[54:55]
    v_cndmask_b32 v17, v17, v154, s[56:57]
    v_cndmask_b32 v18, v18, v154, s[58:59]
    v_cndmask_b32 v19, v19, v154, s[60:61]
    v_exp_f32 v16, v16
    v_exp_f32 v17, v17
    v_exp_f32 v18, v18
    v_mfma_f32_16x16x32_bf16 v[120:123], v[56:59], v[8:11], v[120:123]
    v_exp_f32 v19, v19
    s_nop 0
    v_cvt_pk_bf16_f32 v16, v16, v17
    v_cvt_pk_bf16_f32 v17, v18, v19
    v_mfma_f32_16x16x32_bf16 v[124:127], v[60:63], v[8:11], v[124:127]
    v_mov_b32 v18, 0
    v_mov_b32 v19, 0
    v_exp_f32 v40, v40
    v_exp_f32 v41, v41
    v_exp_f32 v42, v42
    v_mfma_f32_16x16x32_bf16 v[136:139], v[144:147], v[8:11], v[136:139]
    v_exp_f32 v43, v43
    v_cndmask_b32 v44, v44, v154, s[54:55]
    v_cndmask_b32 v45, v45, v154, s[56:57]
    v_cndmask_b32 v46, v46, v154, s[58:59]
    v_mfma_f32_16x16x32_bf16 v[128:131], v[56:59], v[32:35], v[128:131]
    v_cndmask_b32 v47, v47, v154, s[60:61]
    v_exp_f32 v44, v44
    v_exp_f32 v45, v45
    v_exp_f32 v46, v46
    v_exp_f32 v47, v47
    v_mfma_f32_16x16x32_bf16 v[132:135], v[60:63], v[32:35], v[132:135]
    v_cvt_pk_bf16_f32 v40, v40, v41
    v_cvt_pk_bf16_f32 v41, v42, v43
    v_cvt_pk_bf16_f32 v42, v44, v45
    v_cvt_pk_bf16_f32 v43, v46, v47
    v_mfma_f32_16x16x32_bf16 v[140:143], v[144:147], v[32:35], v[140:143]
    s_waitcnt lgkmcnt(0)
    v_mfma_f32_16x16x32_bf16 v[120:123], v[64:67], v[16:19], v[120:123]
    v_mfma_f32_16x16x32_bf16 v[124:127], v[68:71], v[16:19], v[124:127]
    v_mfma_f32_16x16x32_bf16 v[136:139], v[144:147], v[16:19], v[136:139]
    v_mfma_f32_16x16x32_bf16 v[128:131], v[64:67], v[40:43], v[128:131]
    v_mfma_f32_16x16x32_bf16 v[132:135], v[68:71], v[40:43], v[132:135]
    v_mfma_f32_16x16x32_bf16 v[140:143], v[144:147], v[40:43], v[140:143]
    s_nop 7
    s_branch L_sequential_preLN__sliding_block__glu_gated_bilinear__prompt_kernel_attdone_19
L_sequential_preLN__sliding_block__glu_gated_bilinear__prompt_kernel_attslow_18:
    v_mov_b32 v148, v154
    v_mov_b32 v149, v154
    ds_read_b128 a[0:3], v160 offset:0
    ds_read_b128 a[4:7], v160 offset:1024
    ds_read_b128 a[8:11], v160 offset:2048
    ds_read_b128 a[12:15], v160 offset:3072
    ds_read_b128 a[16:19], v160 offset:4096
    ds_read_b128 a[20:23], v160 offset:5120
    ds_read_b128 a[24:27], v160 offset:6144
    ds_read_b128 a[28:31], v160 offset:7168
    ds_read_b128 a[32:35], v160 offset:8192
    s_waitcnt lgkmcnt(7)
    v_mfma_f32_16x16x32_bf16 v[0:3], a[0:3], a[72:75], 0
    ds_read_b128 a[36:39], v160 offset:9216
    v_mfma_f32_16x16x32_bf16 v[4:7], a[4:7], a[72:75], 0
    v_mfma_f32_16x16x32_bf16 v[20:23], a[4:7], a[76:79], 0
    ds_read_b128 a[40:43], v160 offset:10240
    s_waitcnt lgkmcnt(7)
    v_mfma_f32_16x16x32_bf16 v[8:11], a[8:11], a[72:75], 0
    v_mfma_f32_16x16x32_bf16 v[24:27], a[8:11], a[76:79], 0
    s_nop 1
    v_cndmask_b32 v0, v154, v0, s[54:55]
    v_cndmask_b32 v1, v154, v1, s[56:57]
    v_cndmask_b32 v2, v154, v2, s[58:59]
    v_cndmask_b32 v3, v154, v3, s[60:61]
    s_cmp_le_u32 s51, 0
    s_cbranch_scc1 L_sequential_preLN__sliding_block__glu_gated_bilinear__prompt_kernel_vb_22
    v_mov_b32 v0, v154
    v_mov_b32 v1, v154
    v_mov_b32 v2, v154
    v_mov_b32 v3, v154
L_sequential_preLN__sliding_block__glu_gated_bilinear__prompt_kernel_vb_22:
    v_max3_f32 v148, v148, v0, v1
    v_max3_f32 v148, v148, v2, v3
    ds_read_b128 a[44:47], v160 offset:11264
    v_mfma_f32_16x16x32_bf16 v[12:15], a[12:15], a[72:75], 0
    v_mfma_f32_16x16x32_bf16 v[28:31], a[12:15], a[76:79], 0
    s_cmp_le_u32 s51, 1
    s_cbranch_scc1 L_sequential_preLN__sliding_block__glu_gated_bilinear__prompt_kernel_vb_23
    v_mov_b32 v4, v154
    v_mov_b32 v5, v154
    v_mov_b32 v6, v154
    v_mov_b32 v7, v154
L_sequential_preLN__sliding_block__glu_gated_bilinear__prompt_kernel_vb_23:
    v_max3_f32 v148, v148, v4, v5
    v_max3_f32 v148, v148, v6, v7
    v_cndmask_b32 v20, v154, v20, s[54:55]
    v_cndmask_b32 v21, v154, v21, s[56:57]
    v_cndmask_b32 v22, v154, v22, s[58:59]
    v_cndmask_b32 v23, v154, v23, s[60:61]
    s_cmp_le_u32 s51, 1
    s_cbranch_scc1 L_sequential_preLN__sliding_block__glu_gated_bilinear__prompt_kernel_vb_24
    v_mov_b32 v20, v154
    v_mov_b32 v21, v154
    v_mov_b32 v22, v154
    v_mov_b32 v23, v154
L_sequential_preLN__sliding_block__glu_gated_bilinear__prompt_kernel_vb_24:
    v_max3_f32 v149, v149, v20, v21
    v_max3_f32 v149, v149, v22, v23
    ds_read_b128 a[48:51], v160 offset:12288
    s_waitcnt lgkmcnt(7)
    v_mfma_f32_16x16x32_bf16 v[0:3], a[16:19], a[72:75], 0
    v_mfma_f32_16x16x32_bf16 v[16:19], a[16:19], a[76:79], 0
    s_cmp_le_u32 s51, 2
    s_cbranch_scc1 L_sequential_preLN__sliding_block__glu_gated_bilinear__prompt_kernel_vb_25
    v_mov_b32 v8, v154
    v_mov_b32 v9, v154
    v_mov_b32 v10, v154
    v_mov_b32 v11, v154
L_sequential_preLN__sliding_block__glu_gated_bilinear__prompt_kernel_vb_25:
    v_max3_f32 v148, v148, v8, v9
    v_max3_f32 v148, v148, v10, v11
    s_cmp_le_u32 s51, 2
    s_cbranch_scc1 L_sequential_preLN__sliding_block__glu_gated_bilinear__prompt_kernel_vb_26
    v_mov_b32 v24, v154
    v_mov_b32 v25, v154
    v_mov_b32 v26, v154
    v_mov_b32 v27, v154
L_sequential_preLN__sliding_block__glu_gated_bilinear__prompt_kernel_vb_26:
    v_max3_f32 v149, v149, v24, v25
    v_max3_f32 v149, v149, v26, v27
    ds_read_b128 a[52:55], v160 offset:13312
    v_mfma_f32_16x16x32_bf16 v[4:7], a[20:23], a[72:75], 0
    v_mfma_f32_16x16x32_bf16 v[20:23], a[20:23], a[76:79], 0
    s_cmp_le_u32 s51, 3
    s_cbranch_scc1 L_sequential_preLN__sliding_block__glu_gated_bilinear__prompt_kernel_vb_27
    v_mov_b32 v12, v154
    v_mov_b32 v13, v154
    v_mov_b32 v14, v154
    v_mov_b32 v15, v154
L_sequential_preLN__sliding_block__glu_gated_bilinear__prompt_kernel_vb_27:
    v_max3_f32 v148, v148, v12, v13
    v_max3_f32 v148, v148, v14, v15
    s_cmp_le_u32 s51, 3
    s_cbranch_scc1 L_sequential_preLN__sliding_block__glu_gated_bilinear__prompt_kernel_vb_28
    v_mov_b32 v28, v154
    v_mov_b32 v29, v154
    v_mov_b32 v30, v154
    v_mov_b32 v31, v154
L_sequential_preLN__sliding_block__glu_gated_bilinear__prompt_kernel_vb_28:
    v_max3_f32 v149, v149, v28, v29
    v_max3_f32 v149, v149, v30, v31
    ds_read_b128 a[56:59], v160 offset:14336
    s_waitcnt lgkmcnt(7)
    v_mfma_f32_16x16x32_bf16 v[8:11], a[24:27], a[72:75], 0
    v_mfma_f32_16x16x32_bf16 v[24:27], a[24:27], a[76:79], 0
    s_cmp_le_u32 s51, 4
    s_cbranch_scc1 L_sequential_preLN__sliding_block__glu_gated_bilinear__prompt_kernel_vb_29
    v_mov_b32 v0, v154
    v_mov_b32 v1, v154
    v_mov_b32 v2, v154
    v_mov_b32 v3, v154
L_sequential_preLN__sliding_block__glu_gated_bilinear__prompt_kernel_vb_29:
    v_max3_f32 v148, v148, v0, v1
    v_max3_f32 v148, v148, v2, v3
    s_cmp_le_u32 s51, 4
    s_cbranch_scc1 L_sequential_preLN__sliding_block__glu_gated_bilinear__prompt_kernel_vb_30
    v_mov_b32 v16, v154
    v_mov_b32 v17, v154
    v_mov_b32 v18, v154
    v_mov_b32 v19, v154
L_sequential_preLN__sliding_block__glu_gated_bilinear__prompt_kernel_vb_30:
    v_max3_f32 v149, v149, v16, v17
    v_max3_f32 v149, v149, v18, v19
    ds_read_b128 a[60:63], v160 offset:15360
    v_mfma_f32_16x16x32_bf16 v[12:15], a[28:31], a[72:75], 0
    v_mfma_f32_16x16x32_bf16 v[28:31], a[28:31], a[76:79], 0
    s_cmp_le_u32 s51, 5
    s_cbranch_scc1 L_sequential_preLN__sliding_block__glu_gated_bilinear__prompt_kernel_vb_31
    v_mov_b32 v4, v154
    v_mov_b32 v5, v154
    v_mov_b32 v6, v154
    v_mov_b32 v7, v154
L_sequential_preLN__sliding_block__glu_gated_bilinear__prompt_kernel_vb_31:
    v_max3_f32 v148, v148, v4, v5
    v_max3_f32 v148, v148, v6, v7
    s_cmp_le_u32 s51, 5
    s_cbranch_scc1 L_sequential_preLN__sliding_block__glu_gated_bilinear__prompt_kernel_vb_32
    v_mov_b32 v20, v154
    v_mov_b32 v21, v154
    v_mov_b32 v22, v154
    v_mov_b32 v23, v154
L_sequential_preLN__sliding_block__glu_gated_bilinear__prompt_kernel_vb_32:
    v_max3_f32 v149, v149, v20, v21
    v_max3_f32 v149, v149, v22, v23
    ds_read_b128 a[64:67], v160 offset:16384
    s_waitcnt lgkmcnt(7)
    v_mfma_f32_16x16x32_bf16 v[0:3], a[32:35], a[72:75], 0
    v_mfma_f32_16x16x32_bf16 v[16:19], a[32:35], a[76:79], 0
    s_cmp_le_u32 s51, 6
    s_cbranch_scc1 L_sequential_preLN__sliding_block__glu_gated_bilinear__prompt_kernel_vb_33
    v_mov_b32 v8, v154
    v_mov_b32 v9, v154
    v_mov_b32 v10, v154
    v_mov_b32 v11, v154
L_sequential_preLN__sliding_block__glu_gated_bilinear__prompt_kernel_vb_33:
    v_max3_f32 v148, v148, v8, v9
    v_max3_f32 v148, v148, v10, v11
    s_cmp_le_u32 s51, 6
    s_cbranch_scc1 L_sequential_preLN__sliding_block__glu_gated_bilinear__prompt_kernel_vb_34
    v_mov_b32 v24, v154
    v_mov_b32 v25, v154
    v_mov_b32 v26, v154
    v_mov_b32 v27, v154
L_sequential_preLN__sliding_block__glu_gated_bilinear__prompt_kernel_vb_34:
    v_max3_f32 v149, v149, v24, v25
    v_max3_f32 v149, v149, v26, v27
    ds_read_b128 a[68:71], v160 offset:17408
    v_mfma_f32_16x16x32_bf16 v[4:7], a[36:39], a[72:75], 0
    v_mfma_f32_16x16x32_bf16 v[20:23], a[36:39], a[76:79], 0
    s_cmp_le_u32 s51, 7
    s_cbranch_scc1 L_sequential_preLN__sliding_block__glu_gated_bilinear__prompt_kernel_vb_35
    v_mov_b32 v12, v154
    v_mov_b32 v13, v154
    v_mov_b32 v14, v154
    v_mov_b32 v15, v154
L_sequential_preLN__sliding_block__glu_gated_bilinear__prompt_kernel_vb_35:
    v_max3_f32 v148, v148, v12, v13
    v_max3_f32 v148, v148, v14, v15
    s_cmp_le_u32 s51, 7
    s_cbranch_scc1 L_sequential_preLN__sliding_block__glu_gated_bilinear__prompt_kernel_vb_36
    v_mov_b32 v28, v154
    v_mov_b32 v29, v154
    v_mov_b32 v30, v154
    v_mov_b32 v31, v154
L_sequential_preLN__sliding_block__glu_gated_bilinear__prompt_kernel_vb_36:
    v_max3_f32 v149, v149, v28, v29
    v_max3_f32 v149, v149, v30, v31
    s_waitcnt lgkmcnt(6)
    v_mfma_f32_16x16x32_bf16 v[8:11], a[40:43], a[72:75], 0
    v_mfma_f32_16x16x32_bf16 v[24:27], a[40:43], a[76:79], 0
    s_cmp_le_u32 s51, 8
    s_cbranch_scc1 L_sequential_preLN__sliding_block__glu_gated_bilinear__prompt_kernel_vb_37
    v_mov_b32 v0, v154
    v_mov_b32 v1, v154
    v_mov_b32 v2, v154
    v_mov_b32 v3, v154
L_sequential_preLN__sliding_block__glu_gated_bilinear__prompt_kernel_vb_37:
    v_max3_f32 v148, v148, v0, v1
    v_max3_f32 v148, v148, v2, v3
    s_cmp_le_u32 s51, 8
    s_cbranch_scc1 L_sequential_preLN__sliding_block__glu_gated_bilinear__prompt_kernel_vb_38
    v_mov_b32 v16, v154
    v_mov_b32 v17, v154
    v_mov_b32 v18, v154
    v_mov_b32 v19, v154
L_sequential_preLN__sliding_block__glu_gated_bilinear__prompt_kernel_vb_38:
    v_max3_f32 v149, v149, v16, v17
    v_max3_f32 v149, v149, v18, v19
    v_mfma_f32_16x16x32_bf16 v[12:15], a[44:47], a[72:75], 0
    v_mfma_f32_16x16x32_bf16 v[28:31], a[44:47], a[76:79], 0
    s_cmp_le_u32 s51, 9
    s_cbranch_scc1 L_sequential_preLN__sliding_block__glu_gated_bilinear__prompt_kernel_vb_39
    v_mov_b32 v4, v154
    v_mov_b32 v5, v154
    v_mov_b32 v6, v154
    v_mov_b32 v7, v154
L_sequential_preLN__sliding_block__glu_gated_bilinear__prompt_kernel_vb_39:
    v_max3_f32 v148, v148, v4, v5
    v_max3_f32 v148, v148, v6, v7
    s_cmp_le_u32 s51, 9
    s_cbranch_scc1 L_sequential_preLN__sliding_block__glu_gated_bilinear__prompt_kernel_vb_40
    v_mov_b32 v20, v154
    v_mov_b32 v21, v154
    v_mov_b32 v22, v154
    v_mov_b32 v23, v154
L_sequential_preLN__sliding_block__glu_gated_bilinear__prompt_kernel_vb_40:
    v_max3_f32 v149, v149, v20, v21
    v_max3_f32 v149, v149, v22, v23
    s_waitcnt lgkmcnt(4)
    v_mfma_f32_16x16x32_bf16 v[0:3], a[48:51], a[72:75], 0
    v_mfma_f32_16x16x32_bf16 v[16:19], a[48:51], a[76:79], 0
    s_cmp_le_u32 s51, 10
    s_cbranch_scc1 L_sequential_preLN__sliding_block__glu_gated_bilinear__prompt_kernel_vb_41
    v_mov_b32 v8, v154
    v_mov_b32 v9, v154
    v_mov_b32 v10, v154
    v_mov_b32 v11, v154
L_sequential_preLN__sliding_block__glu_gated_bilinear__prompt_kernel_vb_41:
    v_max3_f32 v148, v148, v8, v9
    v_max3_f32 v148, v148, v10, v11
    s_cmp_le_u32 s51, 10
    s_cbranch_scc1 L_sequential_preLN__sliding_block__glu_gated_bilinear__prompt_kernel_vb_42
    v_mov_b32 v24, v154
    v_mov_b32 v25, v154
    v_mov_b32 v26, v154
    v_mov_b32 v27, v154
L_sequential_preLN__sliding_block__glu_gated_bilinear__prompt_kernel_vb_42:
    v_max3_f32 v149, v149, v24, v25
    v_max3_f32 v149, v149, v26, v27
    v_mfma_f32_16x16x32_bf16 v[4:7], a[52:55], a[72:75], 0
    v_mfma_f32_16x16x32_bf16 v[20:23], a[52:55], a[76:79], 0
    s_cmp_le_u32 s51, 11
    s_cbranch_scc1 L_sequential_preLN__sliding_block__glu_gated_bilinear__prompt_kernel_vb_43
    v_mov_b32 v12, v154
    v_mov_b32 v13, v154
    v_mov_b32 v14, v154
    v_mov_b32 v15, v154
L_sequential_preLN__sliding_block__glu_gated_bilinear__prompt_kernel_vb_43:
    v_max3_f32 v148, v148, v12, v13
    v_max3_f32 v148, v148, v14, v15
    s_cmp_le_u32 s51, 11
    s_cbranch_scc1 L_sequential_preLN__sliding_block__glu_gated_bilinear__prompt_kernel_vb_44
    v_mov_b32 v28, v154
    v_mov_b32 v29, v154
    v_mov_b32 v30, v154
    v_mov_b32 v31, v154
L_sequential_preLN__sliding_block__glu_gated_bilinear__prompt_kernel_vb_44:
    v_max3_f32 v149, v149, v28, v29
    v_max3_f32 v149, v149, v30, v31
    s_waitcnt lgkmcnt(2)
    v_mfma_f32_16x16x32_bf16 v[8:11], a[56:59], a[72:75], 0
    v_mfma_f32_16x16x32_bf16 v[24:27], a[56:59], a[76:79], 0
    s_cmp_le_u32 s51, 12
    s_cbranch_scc1 L_sequential_preLN__sliding_block__glu_gated_bilinear__prompt_kernel_vb_45
    v_mov_b32 v0, v154
    v_mov_b32 v1, v154
    v_mov_b32 v2, v154
    v_mov_b32 v3, v154
L_sequential_preLN__sliding_block__glu_gated_bilinear__prompt_kernel_vb_45:
    v_max3_f32 v148, v148, v0, v1
    v_max3_f32 v148, v148, v2, v3
    s_cmp_le_u32 s51, 12
    s_cbranch_scc1 L_sequential_preLN__sliding_block__glu_gated_bilinear__prompt_kernel_vb_46
    v_mov_b32 v16, v154
    v_mov_b32 v17, v154
    v_mov_b32 v18, v154
    v_mov_b32 v19, v154
L_sequential_preLN__sliding_block__glu_gated_bilinear__prompt_kernel_vb_46:
    v_max3_f32 v149, v149, v16, v17
    v_max3_f32 v149, v149, v18, v19
    v_mfma_f32_16x16x32_bf16 v[12:15], a[60:63], a[72:75], 0
    v_mfma_f32_16x16x32_bf16 v[28:31], a[60:63], a[76:79], 0
    s_cmp_le_u32 s51, 13
    s_cbranch_scc1 L_sequential_preLN__sliding_block__glu_gated_bilinear__prompt_kernel_vb_47
    v_mov_b32 v4, v154
    v_mov_b32 v5, v154
    v_mov_b32 v6, v154
    v_mov_b32 v7, v154
L_sequential_preLN__sliding_block__glu_gated_bilinear__prompt_kernel_vb_47:
    v_max3_f32 v148, v148, v4, v5
    v_max3_f32 v148, v148, v6, v7
    s_cmp_le_u32 s51, 13
    s_cbranch_scc1 L_sequential_preLN__sliding_block__glu_gated_bilinear__prompt_kernel_vb_48
    v_mov_b32 v20, v154
    v_mov_b32 v21, v154
    v_mov_b32 v22, v154
    v_mov_b32 v23, v154
L_sequential_preLN__sliding_block__glu_gated_bilinear__prompt_kernel_vb_48:
    v_max3_f32 v149, v149, v20, v21
    v_max3_f32 v149, v149, v22, v23
    s_waitcnt lgkmcnt(0)
    v_mfma_f32_16x16x32_bf16 v[0:3], a[64:67], a[72:75], 0
    v_mfma_f32_16x16x32_bf16 v[16:19], a[64:67], a[76:79], 0
    s_cmp_le_u32 s51, 14
    s_cbranch_scc1 L_sequential_preLN__sliding_block__glu_gated_bilinear__prompt_kernel_vb_49
    v_mov_b32 v8, v154
    v_mov_b32 v9, v154
    v_mov_b32 v10, v154
    v_mov_b32 v11, v154
L_sequential_preLN__sliding_block__glu_gated_bilinear__prompt_kernel_vb_49:
    v_max3_f32 v148, v148, v8, v9
    v_max3_f32 v148, v148, v10, v11
    s_cmp_le_u32 s51, 14
    s_cbranch_scc1 L_sequential_preLN__sliding_block__glu_gated_bilinear__prompt_kernel_vb_50
    v_mov_b32 v24, v154
    v_mov_b32 v25, v154
    v_mov_b32 v26, v154
    v_mov_b32 v27, v154
L_sequential_preLN__sliding_block__glu_gated_bilinear__prompt_kernel_vb_50:
    v_max3_f32 v149, v149, v24, v25
    v_max3_f32 v149, v149, v26, v27
    v_mfma_f32_16x16x32_bf16 v[20:23], a[68:71], a[76:79], 0
    s_cmp_le_u32 s51, 15
    s_cbranch_scc1 L_sequential_preLN__sliding_block__glu_gated_bilinear__prompt_kernel_vb_51
    v_mov_b32 v12, v154
    v_mov_b32 v13, v154
    v_mov_b32 v14, v154
    v_mov_b32 v15, v154
L_sequential_preLN__sliding_block__glu_gated_bilinear__prompt_kernel_vb_51:
    v_max3_f32 v148, v148, v12, v13
    v_max3_f32 v148, v148, v14, v15
    s_cmp_le_u32 s51, 15
    s_cbranch_scc1 L_sequential_preLN__sliding_block__glu_gated_bilinear__prompt_kernel_vb_52
    v_mov_b32 v28, v154
    v_mov_b32 v29, v154
    v_mov_b32 v30, v154
    v_mov_b32 v31, v154
L_sequential_preLN__sliding_block__glu_gated_bilinear__prompt_kernel_vb_52:
    v_max3_f32 v149, v149, v28, v29
    v_max3_f32 v149, v149, v30, v31
    s_nop 5
    v_cndmask_b32 v0, v0, v154, s[54:55]
    v_cndmask_b32 v1, v1, v154, s[56:57]
    v_cndmask_b32 v2, v2, v154, s[58:59]
    v_cndmask_b32 v3, v3, v154, s[60:61]
    v_max3_f32 v148, v148, v0, v1
    v_max3_f32 v148, v148, v2, v3
    v_max3_f32 v149, v149, v16, v17
    v_max3_f32 v149, v149, v18, v19
    v_cndmask_b32 v20, v20, v154, s[54:55]
    v_cndmask_b32 v21, v21, v154, s[56:57]
    v_cndmask_b32 v22, v22, v154, s[58:59]
    v_cndmask_b32 v23, v23, v154, s[60:61]
    v_max3_f32 v149, v149, v20, v21
    v_max3_f32 v149, v149, v22, v23
    v_mov_b32 v150, v148
    v_mov_b32 v151, v149
    s_nop 1
    v_permlane16_swap_b32 v150, v148
    v_permlane16_swap_b32 v151, v149
    s_nop 1
    v_max_f32 v148, v148, v150
    v_max_f32 v149, v149, v151
    v_mov_b32 v150, v148
    v_mov_b32 v151, v149
    s_nop 1
    v_permlane32_swap_b32 v150, v148
    v_permlane32_swap_b32 v151, v149
    s_nop 1
    v_max_f32 v148, v148, v150
    v_max_f32 v149, v149, v151
    v_sub_f32 v112, 0, v148
    v_sub_f32 v113, 0, v148
    v_sub_f32 v114, 0, v148
    v_sub_f32 v115, 0, v148
    v_sub_f32 v116, 0, v149
    v_sub_f32 v117, 0, v149
    v_sub_f32 v118, 0, v149
    v_sub_f32 v119, 0, v149
    s_cmp_lt_u32 s40, 4
    s_cbranch_scc1 L_sequential_preLN__sliding_block__glu_gated_bilinear__prompt_kernel_Avw_53
    s_waitcnt vmcnt(0)
L_sequential_preLN__sliding_block__glu_gated_bilinear__prompt_kernel_Avw_53:
    s_barrier
    s_cmp_lt_u32 s40, 4
    s_cbranch_scc0 L_sequential_preLN__sliding_block__glu_gated_bilinear__prompt_kernel_notouch_54
    v_mbcnt_lo_u32_b32 v164, -1, 0
    v_mbcnt_hi_u32_b32 v164, -1, v164

    s_lshl_b32 s3, s2, 2
    s_add_u32 s3, s3, s40
    s_lshl_b32 s3, s3, 13
    v_lshlrev_b32 v164, 7, v164
    v_add_u32 v164, s3, v164

    s_mov_b32 s4, s72
    s_mov_b32 s5, s73
    s_mov_b32 s6, 7340032
    s_mov_b32 s7, 0x20000
    buffer_load_dword v165, v164, s[4:7], 0 offen
L_sequential_preLN__sliding_block__glu_gated_bilinear__prompt_kernel_notouch_54:
    v_mfma_f32_16x16x32_bf16 v[0:3], a[0:3], a[72:75], v[112:115]
    v_mfma_f32_16x16x32_bf16 v[4:7], a[4:7], a[72:75], v[112:115]
    v_mfma_f32_16x16x32_bf16 v[28:31], a[4:7], a[76:79], v[116:119]
    s_nop 3
    ds_read_b64_tr_b16 v[48:49], v161 offset:0
    ds_read_b64_tr_b16 v[50:51], v161 offset:1024
    ds_read_b64_tr_b16 v[52:53], v162 offset:0
    ds_read_b64_tr_b16 v[54:55], v162 offset:1024
    s_nop 3
    v_cndmask_b32 v0, v154, v0, s[54:55]
    v_cndmask_b32 v1, v154, v1, s[56:57]
    v_cndmask_b32 v2, v154, v2, s[58:59]
    v_cndmask_b32 v3, v154, v3, s[60:61]
    s_cmp_le_u32 s51, 0
    s_cbranch_scc1 L_sequential_preLN__sliding_block__glu_gated_bilinear__prompt_kernel_vb_55
    v_mov_b32 v0, v154
    v_mov_b32 v1, v154
    v_mov_b32 v2, v154
    v_mov_b32 v3, v154
L_sequential_preLN__sliding_block__glu_gated_bilinear__prompt_kernel_vb_55:
    v_exp_f32 v0, v0
    v_exp_f32 v1, v1
    v_exp_f32 v2, v2
    v_exp_f32 v3, v3
    s_cmp_le_u32 s51, 1
    s_cbranch_scc1 L_sequential_preLN__sliding_block__glu_gated_bilinear__prompt_kernel_vb_56
    v_mov_b32 v4, v154
    v_mov_b32 v5, v154
    v_mov_b32 v6, v154
    v_mov_b32 v7, v154
L_sequential_preLN__sliding_block__glu_gated_bilinear__prompt_kernel_vb_56:
    v_mfma_f32_16x16x32_bf16 v[8:11], a[8:11], a[72:75], v[112:115]
    v_exp_f32 v4, v4
    v_exp_f32 v5, v5
    v_exp_f32 v6, v6
    v_exp_f32 v7, v7
    v_cvt_pk_bf16_f32 v0, v0, v1
    v_cvt_pk_bf16_f32 v1, v2, v3
    v_cvt_pk_bf16_f32 v2, v4, v5
    v_mfma_f32_16x16x32_bf16 v[32:35], a[8:11], a[76:79], v[116:119]
    v_cvt_pk_bf16_f32 v3, v6, v7
    v_cndmask_b32 v28, v154, v28, s[54:55]
    v_cndmask_b32 v29, v154, v29, s[56:57]
    v_cndmask_b32 v30, v154, v30, s[58:59]
    v_cndmask_b32 v31, v154, v31, s[60:61]
    s_cmp_le_u32 s51, 1
    s_cbranch_scc1 L_sequential_preLN__sliding_block__glu_gated_bilinear__prompt_kernel_vb_57
    v_mov_b32 v28, v154
    v_mov_b32 v29, v154
    v_mov_b32 v30, v154
    v_mov_b32 v31, v154
L_sequential_preLN__sliding_block__glu_gated_bilinear__prompt_kernel_vb_57:
    v_exp_f32 v28, v28
    v_mfma_f32_16x16x32_bf16 v[12:15], a[12:15], a[72:75], v[112:115]
    v_exp_f32 v29, v29
    v_exp_f32 v30, v30
    v_exp_f32 v31, v31
    v_mov_b32 v24, 0
    v_mov_b32 v25, 0
    v_cvt_pk_bf16_f32 v26, v28, v29
    v_cvt_pk_bf16_f32 v27, v30, v31
    v_mfma_f32_16x16x32_bf16 v[36:39], a[12:15], a[76:79], v[116:119]
    ds_read_b64_tr_b16 v[56:57], v161 offset:2048
    ds_read_b64_tr_b16 v[58:59], v161 offset:3072
    ds_read_b64_tr_b16 v[60:61], v162 offset:2048
    ds_read_b64_tr_b16 v[62:63], v162 offset:3072
    s_waitcnt lgkmcnt(4)
    s_cmp_le_u32 s51, 2
    s_cbranch_scc1 L_sequential_preLN__sliding_block__glu_gated_bilinear__prompt_kernel_vb_58
    v_mov_b32 v8, v154
    v_mov_b32 v9, v154
    v_mov_b32 v10, v154
    v_mov_b32 v11, v154
L_sequential_preLN__sliding_block__glu_gated_bilinear__prompt_kernel_vb_58:
    v_exp_f32 v8, v8
    v_exp_f32 v9, v9
    v_exp_f32 v10, v10
    v_exp_f32 v11, v11
    v_mfma_f32_16x16x32_bf16 v[120:123], v[48:51], v[0:3], 0
    s_cmp_le_u32 s51, 3
    s_cbranch_scc1 L_sequential_preLN__sliding_block__glu_gated_bilinear__prompt_kernel_vb_59
    v_mov_b32 v12, v154
    v_mov_b32 v13, v154
    v_mov_b32 v14, v154
    v_mov_b32 v15, v154
L_sequential_preLN__sliding_block__glu_gated_bilinear__prompt_kernel_vb_59:
    v_exp_f32 v12, v12
    v_exp_f32 v13, v13
    v_mfma_f32_16x16x32_bf16 v[16:19], a[16:19], a[72:75], v[112:115]
    v_exp_f32 v14, v14
    v_exp_f32 v15, v15
    v_mfma_f32_16x16x32_bf16 v[124:127], v[52:55], v[0:3], 0
    v_cvt_pk_bf16_f32 v8, v8, v9
    v_cvt_pk_bf16_f32 v9, v10, v11
    v_cvt_pk_bf16_f32 v10, v12, v13
    v_mfma_f32_16x16x32_bf16 v[40:43], a[16:19], a[76:79], v[116:119]
    v_cvt_pk_bf16_f32 v11, v14, v15
    s_cmp_le_u32 s51, 2
    s_cbranch_scc1 L_sequential_preLN__sliding_block__glu_gated_bilinear__prompt_kernel_vb_60
    v_mov_b32 v32, v154
    v_mov_b32 v33, v154
    v_mov_b32 v34, v154
    v_mov_b32 v35, v154
L_sequential_preLN__sliding_block__glu_gated_bilinear__prompt_kernel_vb_60:
    v_mfma_f32_16x16x32_bf16 v[136:139], v[144:147], v[0:3], 0
    v_exp_f32 v32, v32
    v_exp_f32 v33, v33
    v_exp_f32 v34, v34
    v_mfma_f32_16x16x32_bf16 v[20:23], a[20:23], a[72:75], v[112:115]
    v_exp_f32 v35, v35
    s_cmp_le_u32 s51, 3
    s_cbranch_scc1 L_sequential_preLN__sliding_block__glu_gated_bilinear__prompt_kernel_vb_61
    v_mov_b32 v36, v154
    v_mov_b32 v37, v154
    v_mov_b32 v38, v154
    v_mov_b32 v39, v154
L_sequential_preLN__sliding_block__glu_gated_bilinear__prompt_kernel_vb_61:
    v_exp_f32 v36, v36
    v_mfma_f32_16x16x32_bf16 v[128:131], v[48:51], v[24:27], 0
    v_exp_f32 v37, v37
    v_exp_f32 v38, v38
    v_mfma_f32_16x16x32_bf16 v[44:47], a[20:23], a[76:79], v[116:119]
    v_exp_f32 v39, v39
    v_cvt_pk_bf16_f32 v32, v32, v33
    v_cvt_pk_bf16_f32 v33, v34, v35
    v_mfma_f32_16x16x32_bf16 v[132:135], v[52:55], v[24:27], 0
    v_cvt_pk_bf16_f32 v34, v36, v37
    v_cvt_pk_bf16_f32 v35, v38, v39
    v_mfma_f32_16x16x32_bf16 v[140:143], v[144:147], v[24:27], 0
    ds_read_b64_tr_b16 v[64:65], v161 offset:4096
    ds_read_b64_tr_b16 v[66:67], v161 offset:5120
    ds_read_b64_tr_b16 v[68:69], v162 offset:4096
    ds_read_b64_tr_b16 v[70:71], v162 offset:5120
    s_waitcnt lgkmcnt(4)
    s_cmp_le_u32 s51, 4
    s_cbranch_scc1 L_sequential_preLN__sliding_block__glu_gated_bilinear__prompt_kernel_vb_62
    v_mov_b32 v16, v154
    v_mov_b32 v17, v154
    v_mov_b32 v18, v154
    v_mov_b32 v19, v154
L_sequential_preLN__sliding_block__glu_gated_bilinear__prompt_kernel_vb_62:
    v_exp_f32 v16, v16
    v_exp_f32 v17, v17
    v_exp_f32 v18, v18
    v_exp_f32 v19, v19
    v_mfma_f32_16x16x32_bf16 v[120:123], v[56:59], v[8:11], v[120:123]
    s_cmp_le_u32 s51, 5
    s_cbranch_scc1 L_sequential_preLN__sliding_block__glu_gated_bilinear__prompt_kernel_vb_63
    v_mov_b32 v20, v154
    v_mov_b32 v21, v154
    v_mov_b32 v22, v154
    v_mov_b32 v23, v154
L_sequential_preLN__sliding_block__glu_gated_bilinear__prompt_kernel_vb_63:
    v_exp_f32 v20, v20
    v_exp_f32 v21, v21
    v_mfma_f32_16x16x32_bf16 v[0:3], a[24:27], a[72:75], v[112:115]
    v_exp_f32 v22, v22
    v_exp_f32 v23, v23
    v_mfma_f32_16x16x32_bf16 v[124:127], v[60:63], v[8:11], v[124:127]
    v_cvt_pk_bf16_f32 v16, v16, v17
    v_cvt_pk_bf16_f32 v17, v18, v19
    v_cvt_pk_bf16_f32 v18, v20, v21
    v_mfma_f32_16x16x32_bf16 v[24:27], a[24:27], a[76:79], v[116:119]
    v_cvt_pk_bf16_f32 v19, v22, v23
    s_cmp_le_u32 s51, 4
    s_cbranch_scc1 L_sequential_preLN__sliding_block__glu_gated_bilinear__prompt_kernel_vb_64
    v_mov_b32 v40, v154
    v_mov_b32 v41, v154
    v_mov_b32 v42, v154
    v_mov_b32 v43, v154
L_sequential_preLN__sliding_block__glu_gated_bilinear__prompt_kernel_vb_64:
    v_mfma_f32_16x16x32_bf16 v[136:139], v[144:147], v[8:11], v[136:139]
    v_exp_f32 v40, v40
    v_exp_f32 v41, v41
    v_exp_f32 v42, v42
    v_mfma_f32_16x16x32_bf16 v[4:7], a[28:31], a[72:75], v[112:115]
    v_exp_f32 v43, v43
    s_cmp_le_u32 s51, 5
    s_cbranch_scc1 L_sequential_preLN__sliding_block__glu_gated_bilinear__prompt_kernel_vb_65
    v_mov_b32 v44, v154
    v_mov_b32 v45, v154
    v_mov_b32 v46, v154
    v_mov_b32 v47, v154
L_sequential_preLN__sliding_block__glu_gated_bilinear__prompt_kernel_vb_65:
    v_exp_f32 v44, v44
    v_mfma_f32_16x16x32_bf16 v[128:131], v[56:59], v[32:35], v[128:131]
    v_exp_f32 v45, v45
    v_exp_f32 v46, v46
    v_mfma_f32_16x16x32_bf16 v[28:31], a[28:31], a[76:79], v[116:119]
    v_exp_f32 v47, v47
    v_cvt_pk_bf16_f32 v40, v40, v41
    v_cvt_pk_bf16_f32 v41, v42, v43
    v_mfma_f32_16x16x32_bf16 v[132:135], v[60:63], v[32:35], v[132:135]
    v_cvt_pk_bf16_f32 v42, v44, v45
    v_cvt_pk_bf16_f32 v43, v46, v47
    v_mfma_f32_16x16x32_bf16 v[140:143], v[144:147], v[32:35], v[140:143]
    ds_read_b64_tr_b16 v[48:49], v161 offset:6144
    ds_read_b64_tr_b16 v[50:51], v161 offset:7168
    ds_read_b64_tr_b16 v[52:53], v162 offset:6144
    ds_read_b64_tr_b16 v[54:55], v162 offset:7168
    s_waitcnt lgkmcnt(4)
    s_cmp_le_u32 s51, 6
    s_cbranch_scc1 L_sequential_preLN__sliding_block__glu_gated_bilinear__prompt_kernel_vb_66
    v_mov_b32 v0, v154
    v_mov_b32 v1, v154
    v_mov_b32 v2, v154
    v_mov_b32 v3, v154
L_sequential_preLN__sliding_block__glu_gated_bilinear__prompt_kernel_vb_66:
    v_exp_f32 v0, v0
    v_exp_f32 v1, v1
    v_exp_f32 v2, v2
    v_exp_f32 v3, v3
    v_mfma_f32_16x16x32_bf16 v[120:123], v[64:67], v[16:19], v[120:123]
    s_cmp_le_u32 s51, 7
    s_cbranch_scc1 L_sequential_preLN__sliding_block__glu_gated_bilinear__prompt_kernel_vb_67
    v_mov_b32 v4, v154
    v_mov_b32 v5, v154
    v_mov_b32 v6, v154
    v_mov_b32 v7, v154
L_sequential_preLN__sliding_block__glu_gated_bilinear__prompt_kernel_vb_67:
    v_exp_f32 v4, v4
    v_exp_f32 v5, v5
    v_mfma_f32_16x16x32_bf16 v[8:11], a[32:35], a[72:75], v[112:115]
    v_exp_f32 v6, v6
    v_exp_f32 v7, v7
    v_mfma_f32_16x16x32_bf16 v[124:127], v[68:71], v[16:19], v[124:127]
    v_cvt_pk_bf16_f32 v0, v0, v1
    v_cvt_pk_bf16_f32 v1, v2, v3
    v_cvt_pk_bf16_f32 v2, v4, v5
    v_mfma_f32_16x16x32_bf16 v[32:35], a[32:35], a[76:79], v[116:119]
    v_cvt_pk_bf16_f32 v3, v6, v7
    s_cmp_le_u32 s51, 6
    s_cbranch_scc1 L_sequential_preLN__sliding_block__glu_gated_bilinear__prompt_kernel_vb_68
    v_mov_b32 v24, v154
    v_mov_b32 v25, v154
    v_mov_b32 v26, v154
    v_mov_b32 v27, v154
L_sequential_preLN__sliding_block__glu_gated_bilinear__prompt_kernel_vb_68:
    v_mfma_f32_16x16x32_bf16 v[136:139], v[144:147], v[16:19], v[136:139]
    v_exp_f32 v24, v24
    v_exp_f32 v25, v25
    v_exp_f32 v26, v26
    v_mfma_f32_16x16x32_bf16 v[12:15], a[36:39], a[72:75], v[112:115]
    v_exp_f32 v27, v27
    s_cmp_le_u32 s51, 7
    s_cbranch_scc1 L_sequential_preLN__sliding_block__glu_gated_bilinear__prompt_kernel_vb_69
    v_mov_b32 v28, v154
    v_mov_b32 v29, v154
    v_mov_b32 v30, v154
    v_mov_b32 v31, v154
L_sequential_preLN__sliding_block__glu_gated_bilinear__prompt_kernel_vb_69:
    v_exp_f32 v28, v28
    v_mfma_f32_16x16x32_bf16 v[128:131], v[64:67], v[40:43], v[128:131]
    v_exp_f32 v29, v29
    v_exp_f32 v30, v30
    v_mfma_f32_16x16x32_bf16 v[36:39], a[36:39], a[76:79], v[116:119]
    v_exp_f32 v31, v31
    v_cvt_pk_bf16_f32 v24, v24, v25
    v_cvt_pk_bf16_f32 v25, v26, v27
    v_mfma_f32_16x16x32_bf16 v[132:135], v[68:71], v[40:43], v[132:135]
    v_cvt_pk_bf16_f32 v26, v28, v29
    v_cvt_pk_bf16_f32 v27, v30, v31
    v_mfma_f32_16x16x32_bf16 v[140:143], v[144:147], v[40:43], v[140:143]
    ds_read_b64_tr_b16 v[56:57], v161 offset:8192
    ds_read_b64_tr_b16 v[58:59], v161 offset:9216
    ds_read_b64_tr_b16 v[60:61], v162 offset:8192
    ds_read_b64_tr_b16 v[62:63], v162 offset:9216
    s_waitcnt lgkmcnt(4)
    s_cmp_le_u32 s51, 8
    s_cbranch_scc1 L_sequential_preLN__sliding_block__glu_gated_bilinear__prompt_kernel_vb_70
    v_mov_b32 v8, v154
    v_mov_b32 v9, v154
    v_mov_b32 v10, v154
    v_mov_b32 v11, v154
L_sequential_preLN__sliding_block__glu_gated_bilinear__prompt_kernel_vb_70:
    v_exp_f32 v8, v8
    v_exp_f32 v9, v9
    v_exp_f32 v10, v10
    v_exp_f32 v11, v11
    v_mfma_f32_16x16x32_bf16 v[120:123], v[48:51], v[0:3], v[120:123]
    s_cmp_le_u32 s51, 9
    s_cbranch_scc1 L_sequential_preLN__sliding_block__glu_gated_bilinear__prompt_kernel_vb_71
    v_mov_b32 v12, v154
    v_mov_b32 v13, v154
    v_mov_b32 v14, v154
    v_mov_b32 v15, v154
L_sequential_preLN__sliding_block__glu_gated_bilinear__prompt_kernel_vb_71:
    v_exp_f32 v12, v12
    v_exp_f32 v13, v13
    v_mfma_f32_16x16x32_bf16 v[16:19], a[40:43], a[72:75], v[112:115]
    v_exp_f32 v14, v14
    v_exp_f32 v15, v15
    v_mfma_f32_16x16x32_bf16 v[124:127], v[52:55], v[0:3], v[124:127]
    v_cvt_pk_bf16_f32 v8, v8, v9
    v_cvt_pk_bf16_f32 v9, v10, v11
    v_cvt_pk_bf16_f32 v10, v12, v13
    v_mfma_f32_16x16x32_bf16 v[40:43], a[40:43], a[76:79], v[116:119]
    v_cvt_pk_bf16_f32 v11, v14, v15
    s_cmp_le_u32 s51, 8
    s_cbranch_scc1 L_sequential_preLN__sliding_block__glu_gated_bilinear__prompt_kernel_vb_72
    v_mov_b32 v32, v154
    v_mov_b32 v33, v154
    v_mov_b32 v34, v154
    v_mov_b32 v35, v154
L_sequential_preLN__sliding_block__glu_gated_bilinear__prompt_kernel_vb_72:
    v_mfma_f32_16x16x32_bf16 v[136:139], v[144:147], v[0:3], v[136:139]
    v_exp_f32 v32, v32
    v_exp_f32 v33, v33
    v_exp_f32 v34, v34
    v_mfma_f32_16x16x32_bf16 v[20:23], a[44:47], a[72:75], v[112:115]
    v_exp_f32 v35, v35
    s_cmp_le_u32 s51, 9
    s_cbranch_scc1 L_sequential_preLN__sliding_block__glu_gated_bilinear__prompt_kernel_vb_73
    v_mov_b32 v36, v154
    v_mov_b32 v37, v154
    v_mov_b32 v38, v154
    v_mov_b32 v39, v154
L_sequential_preLN__sliding_block__glu_gated_bilinear__prompt_kernel_vb_73:
    v_exp_f32 v36, v36
    v_mfma_f32_16x16x32_bf16 v[128:131], v[48:51], v[24:27], v[128:131]
    v_exp_f32 v37, v37
    v_exp_f32 v38, v38
    v_mfma_f32_16x16x32_bf16 v[44:47], a[44:47], a[76:79], v[116:119]
    v_exp_f32 v39, v39
    v_cvt_pk_bf16_f32 v32, v32, v33
    v_cvt_pk_bf16_f32 v33, v34, v35
    v_mfma_f32_16x16x32_bf16 v[132:135], v[52:55], v[24:27], v[132:135]
    v_cvt_pk_bf16_f32 v34, v36, v37
    v_cvt_pk_bf16_f32 v35, v38, v39
    v_mfma_f32_16x16x32_bf16 v[140:143], v[144:147], v[24:27], v[140:143]
    ds_read_b64_tr_b16 v[64:65], v161 offset:10240
    ds_read_b64_tr_b16 v[66:67], v161 offset:11264
    ds_read_b64_tr_b16 v[68:69], v162 offset:10240
    ds_read_b64_tr_b16 v[70:71], v162 offset:11264
    s_waitcnt lgkmcnt(4)
    s_cmp_le_u32 s51, 10
    s_cbranch_scc1 L_sequential_preLN__sliding_block__glu_gated_bilinear__prompt_kernel_vb_74
    v_mov_b32 v16, v154
    v_mov_b32 v17, v154
    v_mov_b32 v18, v154
    v_mov_b32 v19, v154
L_sequential_preLN__sliding_block__glu_gated_bilinear__prompt_kernel_vb_74:
    v_exp_f32 v16, v16
    v_exp_f32 v17, v17
    v_exp_f32 v18, v18
    v_exp_f32 v19, v19
    v_mfma_f32_16x16x32_bf16 v[120:123], v[56:59], v[8:11], v[120:123]
    s_cmp_le_u32 s51, 11
    s_cbranch_scc1 L_sequential_preLN__sliding_block__glu_gated_bilinear__prompt_kernel_vb_75
    v_mov_b32 v20, v154
    v_mov_b32 v21, v154
    v_mov_b32 v22, v154
    v_mov_b32 v23, v154
L_sequential_preLN__sliding_block__glu_gated_bilinear__prompt_kernel_vb_75:
    v_exp_f32 v20, v20
    v_exp_f32 v21, v21
    v_mfma_f32_16x16x32_bf16 v[0:3], a[48:51], a[72:75], v[112:115]
    v_exp_f32 v22, v22
    v_exp_f32 v23, v23
    v_mfma_f32_16x16x32_bf16 v[124:127], v[60:63], v[8:11], v[124:127]
    v_cvt_pk_bf16_f32 v16, v16, v17
    v_cvt_pk_bf16_f32 v17, v18, v19
    v_cvt_pk_bf16_f32 v18, v20, v21
    v_mfma_f32_16x16x32_bf16 v[24:27], a[48:51], a[76:79], v[116:119]
    v_cvt_pk_bf16_f32 v19, v22, v23
    s_cmp_le_u32 s51, 10
    s_cbranch_scc1 L_sequential_preLN__sliding_block__glu_gated_bilinear__prompt_kernel_vb_76
    v_mov_b32 v40, v154
    v_mov_b32 v41, v154
    v_mov_b32 v42, v154
    v_mov_b32 v43, v154
L_sequential_preLN__sliding_block__glu_gated_bilinear__prompt_kernel_vb_76:
    v_mfma_f32_16x16x32_bf16 v[136:139], v[144:147], v[8:11], v[136:139]
    v_exp_f32 v40, v40
    v_exp_f32 v41, v41
    v_exp_f32 v42, v42
    v_mfma_f32_16x16x32_bf16 v[4:7], a[52:55], a[72:75], v[112:115]
    v_exp_f32 v43, v43
    s_cmp_le_u32 s51, 11
    s_cbranch_scc1 L_sequential_preLN__sliding_block__glu_gated_bilinear__prompt_kernel_vb_77
    v_mov_b32 v44, v154
    v_mov_b32 v45, v154
    v_mov_b32 v46, v154
    v_mov_b32 v47, v154
L_sequential_preLN__sliding_block__glu_gated_bilinear__prompt_kernel_vb_77:
    v_exp_f32 v44, v44
    v_mfma_f32_16x16x32_bf16 v[128:131], v[56:59], v[32:35], v[128:131]
    v_exp_f32 v45, v45
    v_exp_f32 v46, v46
    v_mfma_f32_16x16x32_bf16 v[28:31], a[52:55], a[76:79], v[116:119]
    v_exp_f32 v47, v47
    v_cvt_pk_bf16_f32 v40, v40, v41
    v_cvt_pk_bf16_f32 v41, v42, v43
    v_mfma_f32_16x16x32_bf16 v[132:135], v[60:63], v[32:35], v[132:135]
    v_cvt_pk_bf16_f32 v42, v44, v45
    v_cvt_pk_bf16_f32 v43, v46, v47
    v_mfma_f32_16x16x32_bf16 v[140:143], v[144:147], v[32:35], v[140:143]
    ds_read_b64_tr_b16 v[48:49], v161 offset:12288
    ds_read_b64_tr_b16 v[50:51], v161 offset:13312
    ds_read_b64_tr_b16 v[52:53], v162 offset:12288
    ds_read_b64_tr_b16 v[54:55], v162 offset:13312
    s_waitcnt lgkmcnt(4)
    s_cmp_le_u32 s51, 12
    s_cbranch_scc1 L_sequential_preLN__sliding_block__glu_gated_bilinear__prompt_kernel_vb_78
    v_mov_b32 v0, v154
    v_mov_b32 v1, v154
    v_mov_b32 v2, v154
    v_mov_b32 v3, v154
L_sequential_preLN__sliding_block__glu_gated_bilinear__prompt_kernel_vb_78:
    v_exp_f32 v0, v0
    v_exp_f32 v1, v1
    v_exp_f32 v2, v2
    v_exp_f32 v3, v3
    v_mfma_f32_16x16x32_bf16 v[120:123], v[64:67], v[16:19], v[120:123]
    s_cmp_le_u32 s51, 13
    s_cbranch_scc1 L_sequential_preLN__sliding_block__glu_gated_bilinear__prompt_kernel_vb_79
    v_mov_b32 v4, v154
    v_mov_b32 v5, v154
    v_mov_b32 v6, v154
    v_mov_b32 v7, v154
L_sequential_preLN__sliding_block__glu_gated_bilinear__prompt_kernel_vb_79:
    v_exp_f32 v4, v4
    v_exp_f32 v5, v5
    v_mfma_f32_16x16x32_bf16 v[8:11], a[56:59], a[72:75], v[112:115]
    v_exp_f32 v6, v6
    v_exp_f32 v7, v7
    v_mfma_f32_16x16x32_bf16 v[124:127], v[68:71], v[16:19], v[124:127]
    v_cvt_pk_bf16_f32 v0, v0, v1
    v_cvt_pk_bf16_f32 v1, v2, v3
    v_cvt_pk_bf16_f32 v2, v4, v5
    v_mfma_f32_16x16x32_bf16 v[32:35], a[56:59], a[76:79], v[116:119]
    v_cvt_pk_bf16_f32 v3, v6, v7
    s_cmp_le_u32 s51, 12
    s_cbranch_scc1 L_sequential_preLN__sliding_block__glu_gated_bilinear__prompt_kernel_vb_80
    v_mov_b32 v24, v154
    v_mov_b32 v25, v154
    v_mov_b32 v26, v154
    v_mov_b32 v27, v154
L_sequential_preLN__sliding_block__glu_gated_bilinear__prompt_kernel_vb_80:
    v_mfma_f32_16x16x32_bf16 v[136:139], v[144:147], v[16:19], v[136:139]
    v_exp_f32 v24, v24
    v_exp_f32 v25, v25
    v_exp_f32 v26, v26
    v_mfma_f32_16x16x32_bf16 v[12:15], a[60:63], a[72:75], v[112:115]
    v_exp_f32 v27, v27
    s_cmp_le_u32 s51, 13
    s_cbranch_scc1 L_sequential_preLN__sliding_block__glu_gated_bilinear__prompt_kernel_vb_81
    v_mov_b32 v28, v154
    v_mov_b32 v29, v154
    v_mov_b32 v30, v154
    v_mov_b32 v31, v154
L_sequential_preLN__sliding_block__glu_gated_bilinear__prompt_kernel_vb_81:
    v_exp_f32 v28, v28
    v_mfma_f32_16x16x32_bf16 v[128:131], v[64:67], v[40:43], v[128:131]
    v_exp_f32 v29, v29
    v_exp_f32 v30, v30
    v_mfma_f32_16x16x32_bf16 v[36:39], a[60:63], a[76:79], v[116:119]
    v_exp_f32 v31, v31
    v_cvt_pk_bf16_f32 v24, v24, v25
    v_cvt_pk_bf16_f32 v25, v26, v27
    v_mfma_f32_16x16x32_bf16 v[132:135], v[68:71], v[40:43], v[132:135]
    v_cvt_pk_bf16_f32 v26, v28, v29
    v_cvt_pk_bf16_f32 v27, v30, v31
    v_mfma_f32_16x16x32_bf16 v[140:143], v[144:147], v[40:43], v[140:143]
    ds_read_b64_tr_b16 v[56:57], v161 offset:14336
    ds_read_b64_tr_b16 v[58:59], v161 offset:15360
    ds_read_b64_tr_b16 v[60:61], v162 offset:14336
    ds_read_b64_tr_b16 v[62:63], v162 offset:15360
    s_waitcnt lgkmcnt(4)
    s_cmp_le_u32 s51, 14
    s_cbranch_scc1 L_sequential_preLN__sliding_block__glu_gated_bilinear__prompt_kernel_vb_82
    v_mov_b32 v8, v154
    v_mov_b32 v9, v154
    v_mov_b32 v10, v154
    v_mov_b32 v11, v154
L_sequential_preLN__sliding_block__glu_gated_bilinear__prompt_kernel_vb_82:
    v_exp_f32 v8, v8
    v_exp_f32 v9, v9
    v_exp_f32 v10, v10
    v_exp_f32 v11, v11
    v_mfma_f32_16x16x32_bf16 v[120:123], v[48:51], v[0:3], v[120:123]
    s_cmp_le_u32 s51, 15
    s_cbranch_scc1 L_sequential_preLN__sliding_block__glu_gated_bilinear__prompt_kernel_vb_83
    v_mov_b32 v12, v154
    v_mov_b32 v13, v154
    v_mov_b32 v14, v154
    v_mov_b32 v15, v154
L_sequential_preLN__sliding_block__glu_gated_bilinear__prompt_kernel_vb_83:
    v_exp_f32 v12, v12
    v_exp_f32 v13, v13
    v_mfma_f32_16x16x32_bf16 v[16:19], a[64:67], a[72:75], v[112:115]
    v_exp_f32 v14, v14
    v_exp_f32 v15, v15
    v_cvt_pk_bf16_f32 v8, v8, v9
    v_mfma_f32_16x16x32_bf16 v[124:127], v[52:55], v[0:3], v[124:127]
    v_cvt_pk_bf16_f32 v9, v10, v11
    v_cvt_pk_bf16_f32 v10, v12, v13
    v_cvt_pk_bf16_f32 v11, v14, v15
    v_mfma_f32_16x16x32_bf16 v[40:43], a[64:67], a[76:79], v[116:119]
    s_cmp_le_u32 s51, 14
    s_cbranch_scc1 L_sequential_preLN__sliding_block__glu_gated_bilinear__prompt_kernel_vb_84
    v_mov_b32 v32, v154
    v_mov_b32 v33, v154
    v_mov_b32 v34, v154
    v_mov_b32 v35, v154
L_sequential_preLN__sliding_block__glu_gated_bilinear__prompt_kernel_vb_84:
    v_exp_f32 v32, v32
    v_exp_f32 v33, v33
    v_mfma_f32_16x16x32_bf16 v[136:139], v[144:147], v[0:3], v[136:139]
    v_exp_f32 v34, v34
    v_exp_f32 v35, v35
    s_cmp_le_u32 s51, 15
    s_cbranch_scc1 L_sequential_preLN__sliding_block__glu_gated_bilinear__prompt_kernel_vb_85
    v_mov_b32 v36, v154
    v_mov_b32 v37, v154
    v_mov_b32 v38, v154
    v_mov_b32 v39, v154
L_sequential_preLN__sliding_block__glu_gated_bilinear__prompt_kernel_vb_85:
    v_mfma_f32_16x16x32_bf16 v[44:47], a[68:71], a[76:79], v[116:119]
    v_exp_f32 v36, v36
    v_exp_f32 v37, v37
    v_exp_f32 v38, v38
    v_mfma_f32_16x16x32_bf16 v[128:131], v[48:51], v[24:27], v[128:131]
    v_exp_f32 v39, v39
    v_cvt_pk_bf16_f32 v32, v32, v33
    v_cvt_pk_bf16_f32 v33, v34, v35
    v_mfma_f32_16x16x32_bf16 v[132:135], v[52:55], v[24:27], v[132:135]
    v_cvt_pk_bf16_f32 v34, v36, v37
    v_cvt_pk_bf16_f32 v35, v38, v39
    v_mfma_f32_16x16x32_bf16 v[140:143], v[144:147], v[24:27], v[140:143]
    ds_read_b64_tr_b16 v[64:65], v161 offset:16384
    ds_read_b64_tr_b16 v[66:67], v161 offset:17408
    ds_read_b64_tr_b16 v[68:69], v162 offset:16384
    ds_read_b64_tr_b16 v[70:71], v162 offset:17408
    s_waitcnt lgkmcnt(4)
    v_cndmask_b32 v16, v16, v154, s[54:55]
    v_cndmask_b32 v17, v17, v154, s[56:57]
    v_cndmask_b32 v18, v18, v154, s[58:59]
    v_cndmask_b32 v19, v19, v154, s[60:61]
    v_exp_f32 v16, v16
    v_exp_f32 v17, v17
    v_exp_f32 v18, v18
    v_mfma_f32_16x16x32_bf16 v[120:123], v[56:59], v[8:11], v[120:123]
    v_exp_f32 v19, v19
    s_nop 0
    v_cvt_pk_bf16_f32 v16, v16, v17
    v_cvt_pk_bf16_f32 v17, v18, v19
    v_mfma_f32_16x16x32_bf16 v[124:127], v[60:63], v[8:11], v[124:127]
    v_mov_b32 v18, 0
    v_mov_b32 v19, 0
    v_exp_f32 v40, v40
    v_exp_f32 v41, v41
    v_exp_f32 v42, v42
    v_mfma_f32_16x16x32_bf16 v[136:139], v[144:147], v[8:11], v[136:139]
    v_exp_f32 v43, v43
    v_cndmask_b32 v44, v44, v154, s[54:55]
    v_cndmask_b32 v45, v45, v154, s[56:57]
    v_cndmask_b32 v46, v46, v154, s[58:59]
    v_mfma_f32_16x16x32_bf16 v[128:131], v[56:59], v[32:35], v[128:131]
    v_cndmask_b32 v47, v47, v154, s[60:61]
    v_exp_f32 v44, v44
    v_exp_f32 v45, v45
    v_exp_f32 v46, v46
    v_exp_f32 v47, v47
    v_mfma_f32_16x16x32_bf16 v[132:135], v[60:63], v[32:35], v[132:135]
    v_cvt_pk_bf16_f32 v40, v40, v41
    v_cvt_pk_bf16_f32 v41, v42, v43
    v_cvt_pk_bf16_f32 v42, v44, v45
    v_cvt_pk_bf16_f32 v43, v46, v47
    v_mfma_f32_16x16x32_bf16 v[140:143], v[144:147], v[32:35], v[140:143]
    s_waitcnt lgkmcnt(0)
    v_mfma_f32_16x16x32_bf16 v[120:123], v[64:67], v[16:19], v[120:123]
    v_mfma_f32_16x16x32_bf16 v[124:127], v[68:71], v[16:19], v[124:127]
    v_mfma_f32_16x16x32_bf16 v[136:139], v[144:147], v[16:19], v[136:139]
    v_mfma_f32_16x16x32_bf16 v[128:131], v[64:67], v[40:43], v[128:131]
    v_mfma_f32_16x16x32_bf16 v[132:135], v[68:71], v[40:43], v[132:135]
    v_mfma_f32_16x16x32_bf16 v[140:143], v[144:147], v[40:43], v[140:143]
    s_nop 7
L_sequential_preLN__sliding_block__glu_gated_bilinear__prompt_kernel_attdone_19:
    s_add_u32 s12, s82, 16777216
    s_addc_u32 s13, s83, 0
    s_mov_b32 s14, 4194304
    s_mov_b32 s15, 0x20000
    v_rcp_f32 v136, v136
    v_rcp_f32 v140, v140
    s_nop 0
    v_mul_f32 v120, v120, v136
    v_mul_f32 v121, v121, v136
    v_mul_f32 v122, v122, v136
    v_mul_f32 v123, v123, v136
    v_cvt_pk_bf16_f32 v0, v120, v121
    v_cvt_pk_bf16_f32 v1, v122, v123
    v_mul_f32 v124, v124, v136
    v_mul_f32 v125, v125, v136
    v_mul_f32 v126, v126, v136
    v_mul_f32 v127, v127, v136
    v_cvt_pk_bf16_f32 v2, v124, v125
    v_cvt_pk_bf16_f32 v3, v126, v127
    s_nop 1
    v_permlane16_swap_b32 v0, v2
    v_permlane16_swap_b32 v1, v3
    buffer_store_dwordx4 v[0:3], v155, s[12:15], 0 offen offset:0 sc1
    v_mul_f32 v128, v128, v140
    v_mul_f32 v129, v129, v140
    v_mul_f32 v130, v130, v140
    v_mul_f32 v131, v131, v140
    v_cvt_pk_bf16_f32 v4, v128, v129
    v_cvt_pk_bf16_f32 v5, v130, v131
    v_mul_f32 v132, v132, v140
    v_mul_f32 v133, v133, v140
    v_mul_f32 v134, v134, v140
    v_mul_f32 v135, v135, v140
    v_cvt_pk_bf16_f32 v6, v132, v133
    v_cvt_pk_bf16_f32 v7, v134, v135
    s_nop 1
    v_permlane16_swap_b32 v4, v6
    v_permlane16_swap_b32 v5, v7
    buffer_store_dwordx4 v[4:7], v155, s[12:15], 0 offen offset:256 sc1
    s_waitcnt vmcnt(0)
    s_barrier
    s_cmp_eq_u32 s40, 6
    s_cbranch_scc0 L_sequential_preLN__sliding_block__glu_gated_bilinear__prompt_kernel_nopub_86
    s_lshl_b32 s3, s41, 12
    s_lshl_b32 s4, s42, 7
    s_add_u32 s3, s3, s4
    s_add_u32 s47, s3, 196608

    v_mov_b32 v30, s47
    v_mov_b32 v31, s62
    s_mov_b64 exec, 1
    buffer_store_dword v31, v30, s[28:31], 0 offen sc1
    s_mov_b64 exec, -1

L_sequential_preLN__sliding_block__glu_gated_bilinear__prompt_kernel_nopub_86:

    s_and_b32 s3, s2, 7
    s_lshr_b32 s4, s2, 3
    s_and_b32 s5, s3, 3
    s_lshl_b32 s5, s5, 2
    s_and_b32 s6, s4, 3
    s_add_u32 s41, s5, s6
    s_lshr_b32 s5, s3, 2
    s_lshl_b32 s5, s5, 3
    s_lshr_b32 s6, s4, 2
    s_add_u32 s42, s5, s6

    s_add_u32 s8, s82, 16777216
    s_addc_u32 s9, s83, 0
    s_mov_b32 s10, 4194304
    s_mov_b32 s11, 0x20000
    s_mov_b32 s12, s68
    s_mov_b32 s13, s69
    s_mov_b32 s14, 2097152
    s_mov_b32 s15, 0x20000
    s_cmp_ge_u32 s40, 4
    s_cbranch_scc1 L_sequential_preLN__sliding_block__glu_gated_bilinear__prompt_kernel_Bload_87
    v_mbcnt_lo_u32_b32 v56, -1, 0
    v_mbcnt_hi_u32_b32 v56, -1, v56

    v_and_b32 v52, 15, v56
    v_lshrrev_b32 v53, 4, v56
    s_lshl_b32 s3, s40, 5
    v_add_u32 v52, s3, v52
    v_lshlrev_b32 v52, 4, v52
    v_lshl_add_u32 v32, v53, 11, v52
    v_add_u32 v33, 8192, v32
    v_lshrrev_b32 v52, 5, v56
    v_lshlrev_b32 v52, 4, v52
    v_bfe_u32 v53, v56, 4, 1
    v_lshl_add_u32 v52, v53, 2, v52
    v_bfe_u32 v53, v56, 2, 2
    v_add_u32 v52, v52, v53
    v_bfe_u32 v53, v52, 1, 2
    v_lshlrev_b32 v52, 7, v52
    v_and_b32 v54, 1, v56
    v_lshl_add_u32 v52, v54, 3, v52
    v_bfe_u32 v54, v56, 1, 1
    v_lshl_add_u32 v52, v54, 4, v52
    v_add_u32 v52, 16384, v52

    v_xor_b32 v54, 0, v53
    v_lshl_add_u32 v40, v54, 5, v52
    v_xor_b32 v54, 1, v53
    v_lshl_add_u32 v41, v54, 5, v52
    v_xor_b32 v54, 2, v53
    v_lshl_add_u32 v42, v54, 5, v52
    v_xor_b32 v54, 3, v53
    v_lshl_add_u32 v43, v54, 5, v52
    v_add_u32 v34, 49152, v32
    v_add_u32 v35, 49152, v33
    v_add_u32 v44, 49152, v40
    v_add_u32 v45, 49152, v41
    v_add_u32 v46, 49152, v42
    v_add_u32 v47, 49152, v43
    v_add_u32 v36, 98304, v32
    v_add_u32 v37, 98304, v33
    v_add_u32 v48, 98304, v40
    v_add_u32 v49, 98304, v41
    v_add_u32 v50, 98304, v42
    v_add_u32 v51, 98304, v43
    s_mov_b32 s16, s64
    s_mov_b32 s17, s65
    s_mov_b32 s18, 4194304
    s_mov_b32 s19, 0x20000
    s_add_u32 s20, s82, 20971520
    s_addc_u32 s21, s83, 0
    s_mov_b32 s22, 4194304
    s_mov_b32 s23, 0x20000

    v_and_b32 v52, 15, v56
    s_lshl_b32 s3, s41, 7
    s_lshl_b32 s4, s40, 5
    s_add_u32 s3, s3, s4
    v_add_u32 v52, s3, v52
    v_lshlrev_b32 v52, 11, v52
    v_lshrrev_b32 v53, 4, v56
    v_and_b32 v54, 1, v53
    v_lshrrev_b32 v53, 1, v53
    v_lshl_add_u32 v52, v54, 5, v52
    v_lshl_add_u32 v52, v53, 4, v52
    s_lshl_b32 s3, s42, 7
    v_add_u32 v57, s3, v52

    v_and_b32 v52, 15, v56
    s_lshl_b32 s3, s40, 5
    v_add_u32 v52, s3, v52
    v_lshlrev_b32 v52, 4, v52
    v_lshrrev_b32 v53, 4, v56
    v_and_b32 v54, 1, v53
    v_lshrrev_b32 v53, 1, v53
    v_lshl_add_u32 v53, v54, 1, v53
    v_lshl_add_u32 v52, v53, 11, v52
    s_lshl_b32 s3, s42, 14
    s_lshl_b32 s4, s41, 18
    s_add_u32 s3, s3, s4
    v_add_u32 v58, s3, v52

    s_mov_b32 s3, 0
    buffer_load_dwordx4 v[64:67], v57, s[16:19], s3 offen offset:0
    s_mov_b32 s3, 0
    buffer_load_dwordx4 v[68:71], v57, s[16:19], s3 offen offset:64
    s_mov_b32 s3, 32768
    buffer_load_dwordx4 v[72:75], v57, s[16:19], s3 offen offset:0
    s_mov_b32 s3, 32768
    buffer_load_dwordx4 v[76:79], v57, s[16:19], s3 offen offset:64
    v_mov_b32 v0, 0
    v_mov_b32 v1, 0
    v_mov_b32 v2, 0
    v_mov_b32 v3, 0
    v_mov_b32 v4, 0
    v_mov_b32 v5, 0
    v_mov_b32 v6, 0
    v_mov_b32 v7, 0
    v_mov_b32 v8, 0
    v_mov_b32 v9, 0
    v_mov_b32 v10, 0
    v_mov_b32 v11, 0
    v_mov_b32 v12, 0
    v_mov_b32 v13, 0
    v_mov_b32 v14, 0
    v_mov_b32 v15, 0
    v_mov_b32 v16, 0
    v_mov_b32 v17, 0
    v_mov_b32 v18, 0
    v_mov_b32 v19, 0
    v_mov_b32 v20, 0
    v_mov_b32 v21, 0
    v_mov_b32 v22, 0
    v_mov_b32 v23, 0
    v_mov_b32 v24, 0
    v_mov_b32 v25, 0
    v_mov_b32 v26, 0
    v_mov_b32 v27, 0
    v_mov_b32 v28, 0
    v_mov_b32 v29, 0
    v_mov_b32 v30, 0
    v_mov_b32 v31, 0
    s_mov_b32 s46, 0
    s_barrier
    s_barrier
    ds_read_b128 a[0:3], v32 offset:0
    ds_read_b128 a[4:7], v32 offset:256
    ds_read_b64_tr_b16 a[16:17], v40 offset:0
    ds_read_b64_tr_b16 a[18:19], v40 offset:1024
    ds_read_b64_tr_b16 a[20:21], v41 offset:0
    ds_read_b64_tr_b16 a[22:23], v41 offset:1024
    ds_read_b64_tr_b16 a[24:25], v42 offset:0
    ds_read_b64_tr_b16 a[26:27], v42 offset:1024
    ds_read_b64_tr_b16 a[28:29], v43 offset:0
    ds_read_b64_tr_b16 a[30:31], v43 offset:1024
    s_waitcnt lgkmcnt(0)
L_sequential_preLN__sliding_block__glu_gated_bilinear__prompt_kernel_Bcloop_90:
    v_mfma_f32_16x16x32_bf16 v[0:3], a[16:19], a[0:3], v[0:3]
    ds_read_b128 a[8:11], v33 offset:0
    ds_read_b128 a[12:15], v33 offset:256
    v_mfma_f32_16x16x32_bf16 v[4:7], a[16:19], a[4:7], v[4:7]
    ds_read_b64_tr_b16 a[32:33], v40 offset:4096
    ds_read_b64_tr_b16 a[34:35], v40 offset:5120
    v_mfma_f32_16x16x32_bf16 v[12:15], a[20:23], a[4:7], v[12:15]
    ds_read_b64_tr_b16 a[36:37], v41 offset:4096
    ds_read_b64_tr_b16 a[38:39], v41 offset:5120
    v_mfma_f32_16x16x32_bf16 v[8:11], a[20:23], a[0:3], v[8:11]
    ds_read_b64_tr_b16 a[40:41], v42 offset:4096
    ds_read_b64_tr_b16 a[42:43], v42 offset:5120
    v_mfma_f32_16x16x32_bf16 v[16:19], a[24:27], a[0:3], v[16:19]
    ds_read_b64_tr_b16 a[44:45], v43 offset:4096
    ds_read_b64_tr_b16 a[46:47], v43 offset:5120
    v_mfma_f32_16x16x32_bf16 v[20:23], a[24:27], a[4:7], v[20:23]
    v_mfma_f32_16x16x32_bf16 v[28:31], a[28:31], a[4:7], v[28:31]
    v_mfma_f32_16x16x32_bf16 v[24:27], a[28:31], a[0:3], v[24:27]
    s_waitcnt lgkmcnt(0)
    s_barrier
    v_mfma_f32_16x16x32_bf16 v[0:3], a[32:35], a[8:11], v[0:3]
    ds_read_b128 a[0:3], v32 offset:24576
    ds_read_b128 a[4:7], v32 offset:24832
    v_mfma_f32_16x16x32_bf16 v[4:7], a[32:35], a[12:15], v[4:7]
    ds_read_b64_tr_b16 a[16:17], v40 offset:24576
    ds_read_b64_tr_b16 a[18:19], v40 offset:25600
    v_mfma_f32_16x16x32_bf16 v[12:15], a[36:39], a[12:15], v[12:15]
    ds_read_b64_tr_b16 a[20:21], v41 offset:24576
    ds_read_b64_tr_b16 a[22:23], v41 offset:25600
    v_mfma_f32_16x16x32_bf16 v[8:11], a[36:39], a[8:11], v[8:11]
    ds_read_b64_tr_b16 a[24:25], v42 offset:24576
    ds_read_b64_tr_b16 a[26:27], v42 offset:25600
    v_mfma_f32_16x16x32_bf16 v[16:19], a[40:43], a[8:11], v[16:19]
    ds_read_b64_tr_b16 a[28:29], v43 offset:24576
    ds_read_b64_tr_b16 a[30:31], v43 offset:25600
    v_mfma_f32_16x16x32_bf16 v[20:23], a[40:43], a[12:15], v[20:23]
    v_mfma_f32_16x16x32_bf16 v[28:31], a[44:47], a[12:15], v[28:31]
    v_mfma_f32_16x16x32_bf16 v[24:27], a[44:47], a[8:11], v[24:27]
    s_waitcnt lgkmcnt(0)
    v_mfma_f32_16x16x32_bf16 v[0:3], a[16:19], a[0:3], v[0:3]
    ds_read_b128 a[8:11], v33 offset:24576
    ds_read_b128 a[12:15], v33 offset:24832
    v_mfma_f32_16x16x32_bf16 v[4:7], a[16:19], a[4:7], v[4:7]
    ds_read_b64_tr_b16 a[32:33], v40 offset:28672
    ds_read_b64_tr_b16 a[34:35], v40 offset:29696
    v_mfma_f32_16x16x32_bf16 v[12:15], a[20:23], a[4:7], v[12:15]
    ds_read_b64_tr_b16 a[36:37], v41 offset:28672
    ds_read_b64_tr_b16 a[38:39], v41 offset:29696
    v_mfma_f32_16x16x32_bf16 v[8:11], a[20:23], a[0:3], v[8:11]
    ds_read_b64_tr_b16 a[40:41], v42 offset:28672
    ds_read_b64_tr_b16 a[42:43], v42 offset:29696
    v_mfma_f32_16x16x32_bf16 v[16:19], a[24:27], a[0:3], v[16:19]
    ds_read_b64_tr_b16 a[44:45], v43 offset:28672
    ds_read_b64_tr_b16 a[46:47], v43 offset:29696
    v_mfma_f32_16x16x32_bf16 v[20:23], a[24:27], a[4:7], v[20:23]
    v_mfma_f32_16x16x32_bf16 v[28:31], a[28:31], a[4:7], v[28:31]
    v_mfma_f32_16x16x32_bf16 v[24:27], a[28:31], a[0:3], v[24:27]
    s_waitcnt lgkmcnt(0)
    s_barrier
    v_mfma_f32_16x16x32_bf16 v[0:3], a[32:35], a[8:11], v[0:3]
    ds_read_b128 a[0:3], v34 offset:0
    ds_read_b128 a[4:7], v34 offset:256
    v_mfma_f32_16x16x32_bf16 v[4:7], a[32:35], a[12:15], v[4:7]
    ds_read_b64_tr_b16 a[16:17], v44 offset:0
    ds_read_b64_tr_b16 a[18:19], v44 offset:1024
    v_mfma_f32_16x16x32_bf16 v[12:15], a[36:39], a[12:15], v[12:15]
    ds_read_b64_tr_b16 a[20:21], v45 offset:0
    ds_read_b64_tr_b16 a[22:23], v45 offset:1024
    v_mfma_f32_16x16x32_bf16 v[8:11], a[36:39], a[8:11], v[8:11]
    ds_read_b64_tr_b16 a[24:25], v46 offset:0
    ds_read_b64_tr_b16 a[26:27], v46 offset:1024
    v_mfma_f32_16x16x32_bf16 v[16:19], a[40:43], a[8:11], v[16:19]
    ds_read_b64_tr_b16 a[28:29], v47 offset:0
    ds_read_b64_tr_b16 a[30:31], v47 offset:1024
    v_mfma_f32_16x16x32_bf16 v[20:23], a[40:43], a[12:15], v[20:23]
    v_mfma_f32_16x16x32_bf16 v[28:31], a[44:47], a[12:15], v[28:31]
    v_mfma_f32_16x16x32_bf16 v[24:27], a[44:47], a[8:11], v[24:27]
    s_waitcnt lgkmcnt(0)
    v_mfma_f32_16x16x32_bf16 v[0:3], a[16:19], a[0:3], v[0:3]
    ds_read_b128 a[8:11], v35 offset:0
    ds_read_b128 a[12:15], v35 offset:256
    v_mfma_f32_16x16x32_bf16 v[4:7], a[16:19], a[4:7], v[4:7]
    ds_read_b64_tr_b16 a[32:33], v44 offset:4096
    ds_read_b64_tr_b16 a[34:35], v44 offset:5120
    v_mfma_f32_16x16x32_bf16 v[12:15], a[20:23], a[4:7], v[12:15]
    ds_read_b64_tr_b16 a[36:37], v45 offset:4096
    ds_read_b64_tr_b16 a[38:39], v45 offset:5120
    v_mfma_f32_16x16x32_bf16 v[8:11], a[20:23], a[0:3], v[8:11]
    ds_read_b64_tr_b16 a[40:41], v46 offset:4096
    ds_read_b64_tr_b16 a[42:43], v46 offset:5120
    v_mfma_f32_16x16x32_bf16 v[16:19], a[24:27], a[0:3], v[16:19]
    ds_read_b64_tr_b16 a[44:45], v47 offset:4096
    ds_read_b64_tr_b16 a[46:47], v47 offset:5120
    v_mfma_f32_16x16x32_bf16 v[20:23], a[24:27], a[4:7], v[20:23]
    v_mfma_f32_16x16x32_bf16 v[28:31], a[28:31], a[4:7], v[28:31]
    v_mfma_f32_16x16x32_bf16 v[24:27], a[28:31], a[0:3], v[24:27]
    s_waitcnt lgkmcnt(0)
    s_barrier
    v_mfma_f32_16x16x32_bf16 v[0:3], a[32:35], a[8:11], v[0:3]
    ds_read_b128 a[0:3], v34 offset:24576
    ds_read_b128 a[4:7], v34 offset:24832
    v_mfma_f32_16x16x32_bf16 v[4:7], a[32:35], a[12:15], v[4:7]
    ds_read_b64_tr_b16 a[16:17], v44 offset:24576
    ds_read_b64_tr_b16 a[18:19], v44 offset:25600
    v_mfma_f32_16x16x32_bf16 v[12:15], a[36:39], a[12:15], v[12:15]
    ds_read_b64_tr_b16 a[20:21], v45 offset:24576
    ds_read_b64_tr_b16 a[22:23], v45 offset:25600
    v_mfma_f32_16x16x32_bf16 v[8:11], a[36:39], a[8:11], v[8:11]
    ds_read_b64_tr_b16 a[24:25], v46 offset:24576
    ds_read_b64_tr_b16 a[26:27], v46 offset:25600
    v_mfma_f32_16x16x32_bf16 v[16:19], a[40:43], a[8:11], v[16:19]
    ds_read_b64_tr_b16 a[28:29], v47 offset:24576
    ds_read_b64_tr_b16 a[30:31], v47 offset:25600
    v_mfma_f32_16x16x32_bf16 v[20:23], a[40:43], a[12:15], v[20:23]
    v_mfma_f32_16x16x32_bf16 v[28:31], a[44:47], a[12:15], v[28:31]
    v_mfma_f32_16x16x32_bf16 v[24:27], a[44:47], a[8:11], v[24:27]
    s_waitcnt lgkmcnt(0)
    v_mfma_f32_16x16x32_bf16 v[0:3], a[16:19], a[0:3], v[0:3]
    ds_read_b128 a[8:11], v35 offset:24576
    ds_read_b128 a[12:15], v35 offset:24832
    v_mfma_f32_16x16x32_bf16 v[4:7], a[16:19], a[4:7], v[4:7]
    ds_read_b64_tr_b16 a[32:33], v44 offset:28672
    ds_read_b64_tr_b16 a[34:35], v44 offset:29696
    v_mfma_f32_16x16x32_bf16 v[12:15], a[20:23], a[4:7], v[12:15]
    ds_read_b64_tr_b16 a[36:37], v45 offset:28672
    ds_read_b64_tr_b16 a[38:39], v45 offset:29696
    v_mfma_f32_16x16x32_bf16 v[8:11], a[20:23], a[0:3], v[8:11]
    ds_read_b64_tr_b16 a[40:41], v46 offset:28672
    ds_read_b64_tr_b16 a[42:43], v46 offset:29696
    v_mfma_f32_16x16x32_bf16 v[16:19], a[24:27], a[0:3], v[16:19]
    ds_read_b64_tr_b16 a[44:45], v47 offset:28672
    ds_read_b64_tr_b16 a[46:47], v47 offset:29696
    v_mfma_f32_16x16x32_bf16 v[20:23], a[24:27], a[4:7], v[20:23]
    v_mfma_f32_16x16x32_bf16 v[28:31], a[28:31], a[4:7], v[28:31]
    v_mfma_f32_16x16x32_bf16 v[24:27], a[28:31], a[0:3], v[24:27]
    s_waitcnt lgkmcnt(0)
    s_barrier
    v_mfma_f32_16x16x32_bf16 v[0:3], a[32:35], a[8:11], v[0:3]
    ds_read_b128 a[0:3], v36 offset:0
    ds_read_b128 a[4:7], v36 offset:256
    v_mfma_f32_16x16x32_bf16 v[4:7], a[32:35], a[12:15], v[4:7]
    ds_read_b64_tr_b16 a[16:17], v48 offset:0
    ds_read_b64_tr_b16 a[18:19], v48 offset:1024
    v_mfma_f32_16x16x32_bf16 v[12:15], a[36:39], a[12:15], v[12:15]
    ds_read_b64_tr_b16 a[20:21], v49 offset:0
    ds_read_b64_tr_b16 a[22:23], v49 offset:1024
    v_mfma_f32_16x16x32_bf16 v[8:11], a[36:39], a[8:11], v[8:11]
    ds_read_b64_tr_b16 a[24:25], v50 offset:0
    ds_read_b64_tr_b16 a[26:27], v50 offset:1024
    v_mfma_f32_16x16x32_bf16 v[16:19], a[40:43], a[8:11], v[16:19]
    ds_read_b64_tr_b16 a[28:29], v51 offset:0
    ds_read_b64_tr_b16 a[30:31], v51 offset:1024
    v_mfma_f32_16x16x32_bf16 v[20:23], a[40:43], a[12:15], v[20:23]
    v_mfma_f32_16x16x32_bf16 v[28:31], a[44:47], a[12:15], v[28:31]
    v_mfma_f32_16x16x32_bf16 v[24:27], a[44:47], a[8:11], v[24:27]
    s_waitcnt lgkmcnt(0)
    v_mfma_f32_16x16x32_bf16 v[0:3], a[16:19], a[0:3], v[0:3]
    ds_read_b128 a[8:11], v37 offset:0
    ds_read_b128 a[12:15], v37 offset:256
    v_mfma_f32_16x16x32_bf16 v[4:7], a[16:19], a[4:7], v[4:7]
    ds_read_b64_tr_b16 a[32:33], v48 offset:4096
    ds_read_b64_tr_b16 a[34:35], v48 offset:5120
    v_mfma_f32_16x16x32_bf16 v[12:15], a[20:23], a[4:7], v[12:15]
    ds_read_b64_tr_b16 a[36:37], v49 offset:4096
    ds_read_b64_tr_b16 a[38:39], v49 offset:5120
    v_mfma_f32_16x16x32_bf16 v[8:11], a[20:23], a[0:3], v[8:11]
    ds_read_b64_tr_b16 a[40:41], v50 offset:4096
    ds_read_b64_tr_b16 a[42:43], v50 offset:5120
    v_mfma_f32_16x16x32_bf16 v[16:19], a[24:27], a[0:3], v[16:19]
    ds_read_b64_tr_b16 a[44:45], v51 offset:4096
    ds_read_b64_tr_b16 a[46:47], v51 offset:5120
    v_mfma_f32_16x16x32_bf16 v[20:23], a[24:27], a[4:7], v[20:23]
    v_mfma_f32_16x16x32_bf16 v[28:31], a[28:31], a[4:7], v[28:31]
    v_mfma_f32_16x16x32_bf16 v[24:27], a[28:31], a[0:3], v[24:27]
    s_waitcnt lgkmcnt(0)
    s_barrier
    v_mfma_f32_16x16x32_bf16 v[0:3], a[32:35], a[8:11], v[0:3]
    ds_read_b128 a[0:3], v32 offset:0
    ds_read_b128 a[4:7], v32 offset:256
    v_mfma_f32_16x16x32_bf16 v[4:7], a[32:35], a[12:15], v[4:7]
    ds_read_b64_tr_b16 a[16:17], v40 offset:0
    ds_read_b64_tr_b16 a[18:19], v40 offset:1024
    v_mfma_f32_16x16x32_bf16 v[12:15], a[36:39], a[12:15], v[12:15]
    ds_read_b64_tr_b16 a[20:21], v41 offset:0
    ds_read_b64_tr_b16 a[22:23], v41 offset:1024
    v_mfma_f32_16x16x32_bf16 v[8:11], a[36:39], a[8:11], v[8:11]
    ds_read_b64_tr_b16 a[24:25], v42 offset:0
    ds_read_b64_tr_b16 a[26:27], v42 offset:1024
    v_mfma_f32_16x16x32_bf16 v[16:19], a[40:43], a[8:11], v[16:19]
    ds_read_b64_tr_b16 a[28:29], v43 offset:0
    ds_read_b64_tr_b16 a[30:31], v43 offset:1024
    v_mfma_f32_16x16x32_bf16 v[20:23], a[40:43], a[12:15], v[20:23]
    v_mfma_f32_16x16x32_bf16 v[28:31], a[44:47], a[12:15], v[28:31]
    s_add_u32 s46, s46, 1
    s_cmp_lt_u32 s46, 3
    v_mfma_f32_16x16x32_bf16 v[24:27], a[44:47], a[8:11], v[24:27]
    s_waitcnt lgkmcnt(0)
    s_cbranch_scc1 L_sequential_preLN__sliding_block__glu_gated_bilinear__prompt_kernel_Bcloop_90
    v_mfma_f32_16x16x32_bf16 v[0:3], a[16:19], a[0:3], v[0:3]
    ds_read_b128 a[8:11], v33 offset:0
    ds_read_b128 a[12:15], v33 offset:256
    v_mfma_f32_16x16x32_bf16 v[4:7], a[16:19], a[4:7], v[4:7]
    ds_read_b64_tr_b16 a[32:33], v40 offset:4096
    ds_read_b64_tr_b16 a[34:35], v40 offset:5120
    v_mfma_f32_16x16x32_bf16 v[12:15], a[20:23], a[4:7], v[12:15]
    ds_read_b64_tr_b16 a[36:37], v41 offset:4096
    ds_read_b64_tr_b16 a[38:39], v41 offset:5120
    v_mfma_f32_16x16x32_bf16 v[8:11], a[20:23], a[0:3], v[8:11]
    ds_read_b64_tr_b16 a[40:41], v42 offset:4096
    ds_read_b64_tr_b16 a[42:43], v42 offset:5120
    v_mfma_f32_16x16x32_bf16 v[16:19], a[24:27], a[0:3], v[16:19]
    ds_read_b64_tr_b16 a[44:45], v43 offset:4096
    ds_read_b64_tr_b16 a[46:47], v43 offset:5120
    v_mfma_f32_16x16x32_bf16 v[20:23], a[24:27], a[4:7], v[20:23]
    v_mfma_f32_16x16x32_bf16 v[28:31], a[28:31], a[4:7], v[28:31]
    v_mfma_f32_16x16x32_bf16 v[24:27], a[28:31], a[0:3], v[24:27]
    s_waitcnt lgkmcnt(0)
    s_barrier
    v_mfma_f32_16x16x32_bf16 v[0:3], a[32:35], a[8:11], v[0:3]
    v_mfma_f32_16x16x32_bf16 v[4:7], a[32:35], a[12:15], v[4:7]
    v_mfma_f32_16x16x32_bf16 v[12:15], a[36:39], a[12:15], v[12:15]
    v_mfma_f32_16x16x32_bf16 v[8:11], a[36:39], a[8:11], v[8:11]
    v_mfma_f32_16x16x32_bf16 v[16:19], a[40:43], a[8:11], v[16:19]
    v_mfma_f32_16x16x32_bf16 v[20:23], a[40:43], a[12:15], v[20:23]
    v_mfma_f32_16x16x32_bf16 v[28:31], a[44:47], a[12:15], v[28:31]
    v_mfma_f32_16x16x32_bf16 v[24:27], a[44:47], a[8:11], v[24:27]
    s_waitcnt vmcnt(0)
    s_nop 7
    v_mov_b32 v84, 0
    v_mov_b32 v86, 0
    v_permlane16_swap_b32 v0, v8
    v_permlane16_swap_b32 v1, v9
    v_permlane16_swap_b32 v2, v10
    v_permlane16_swap_b32 v3, v11
    v_lshlrev_b32 v52, 16, v64
    v_and_b32 v53, 0xffff0000, v64
    v_lshlrev_b32 v54, 16, v65
    v_and_b32 v55, 0xffff0000, v65
    v_add_f32 v0, v0, v52
    v_add_f32 v1, v1, v53
    v_add_f32 v2, v2, v54
    v_add_f32 v3, v3, v55
    v_lshlrev_b32 v52, 16, v66
    v_and_b32 v53, 0xffff0000, v66
    v_lshlrev_b32 v54, 16, v67
    v_and_b32 v55, 0xffff0000, v67
    v_add_f32 v8, v8, v52
    v_add_f32 v9, v9, v53
    v_add_f32 v10, v10, v54
    v_add_f32 v11, v11, v55
    v_add_f32 v84, v84, v0
    v_fmac_f32 v86, v0, v0
    v_add_f32 v84, v84, v1
    v_fmac_f32 v86, v1, v1
    v_add_f32 v84, v84, v2
    v_fmac_f32 v86, v2, v2
    v_add_f32 v84, v84, v3
    v_fmac_f32 v86, v3, v3
    v_add_f32 v84, v84, v8
    v_fmac_f32 v86, v8, v8
    v_add_f32 v84, v84, v9
    v_fmac_f32 v86, v9, v9
    v_add_f32 v84, v84, v10
    v_fmac_f32 v86, v10, v10
    v_add_f32 v84, v84, v11
    v_fmac_f32 v86, v11, v11
    v_cvt_pk_bf16_f32 v64, v0, v1
    v_cvt_pk_bf16_f32 v65, v2, v3
    v_cvt_pk_bf16_f32 v66, v8, v9
    v_cvt_pk_bf16_f32 v67, v10, v11
    s_mov_b32 s3, 0
    buffer_store_dwordx4 v[64:67], v58, s[20:23], s3 offen offset:0 sc1
    v_permlane16_swap_b32 v16, v24
    v_permlane16_swap_b32 v17, v25
    v_permlane16_swap_b32 v18, v26
    v_permlane16_swap_b32 v19, v27
    v_lshlrev_b32 v52, 16, v68
    v_and_b32 v53, 0xffff0000, v68
    v_lshlrev_b32 v54, 16, v69
    v_and_b32 v55, 0xffff0000, v69
    v_add_f32 v16, v16, v52
    v_add_f32 v17, v17, v53
    v_add_f32 v18, v18, v54
    v_add_f32 v19, v19, v55
    v_lshlrev_b32 v52, 16, v70
    v_and_b32 v53, 0xffff0000, v70
    v_lshlrev_b32 v54, 16, v71
    v_and_b32 v55, 0xffff0000, v71
    v_add_f32 v24, v24, v52
    v_add_f32 v25, v25, v53
    v_add_f32 v26, v26, v54
    v_add_f32 v27, v27, v55
    v_add_f32 v84, v84, v16
    v_fmac_f32 v86, v16, v16
    v_add_f32 v84, v84, v17
    v_fmac_f32 v86, v17, v17
    v_add_f32 v84, v84, v18
    v_fmac_f32 v86, v18, v18
    v_add_f32 v84, v84, v19
    v_fmac_f32 v86, v19, v19
    v_add_f32 v84, v84, v24
    v_fmac_f32 v86, v24, v24
    v_add_f32 v84, v84, v25
    v_fmac_f32 v86, v25, v25
    v_add_f32 v84, v84, v26
    v_fmac_f32 v86, v26, v26
    v_add_f32 v84, v84, v27
    v_fmac_f32 v86, v27, v27
    v_cvt_pk_bf16_f32 v68, v16, v17
    v_cvt_pk_bf16_f32 v69, v18, v19
    v_cvt_pk_bf16_f32 v70, v24, v25
    v_cvt_pk_bf16_f32 v71, v26, v27
    s_mov_b32 s3, 8192
    buffer_store_dwordx4 v[68:71], v58, s[20:23], s3 offen offset:0 sc1
    v_mov_b32 v85, 0
    v_mov_b32 v87, 0
    v_permlane16_swap_b32 v4, v12
    v_permlane16_swap_b32 v5, v13
    v_permlane16_swap_b32 v6, v14
    v_permlane16_swap_b32 v7, v15
    v_lshlrev_b32 v52, 16, v72
    v_and_b32 v53, 0xffff0000, v72
    v_lshlrev_b32 v54, 16, v73
    v_and_b32 v55, 0xffff0000, v73
    v_add_f32 v4, v4, v52
    v_add_f32 v5, v5, v53
    v_add_f32 v6, v6, v54
    v_add_f32 v7, v7, v55
    v_lshlrev_b32 v52, 16, v74
    v_and_b32 v53, 0xffff0000, v74
    v_lshlrev_b32 v54, 16, v75
    v_and_b32 v55, 0xffff0000, v75
    v_add_f32 v12, v12, v52
    v_add_f32 v13, v13, v53
    v_add_f32 v14, v14, v54
    v_add_f32 v15, v15, v55
    v_add_f32 v85, v85, v4
    v_fmac_f32 v87, v4, v4
    v_add_f32 v85, v85, v5
    v_fmac_f32 v87, v5, v5
    v_add_f32 v85, v85, v6
    v_fmac_f32 v87, v6, v6
    v_add_f32 v85, v85, v7
    v_fmac_f32 v87, v7, v7
    v_add_f32 v85, v85, v12
    v_fmac_f32 v87, v12, v12
    v_add_f32 v85, v85, v13
    v_fmac_f32 v87, v13, v13
    v_add_f32 v85, v85, v14
    v_fmac_f32 v87, v14, v14
    v_add_f32 v85, v85, v15
    v_fmac_f32 v87, v15, v15
    v_cvt_pk_bf16_f32 v72, v4, v5
    v_cvt_pk_bf16_f32 v73, v6, v7
    v_cvt_pk_bf16_f32 v74, v12, v13
    v_cvt_pk_bf16_f32 v75, v14, v15
    s_mov_b32 s3, 0
    buffer_store_dwordx4 v[72:75], v58, s[20:23], s3 offen offset:256 sc1
    v_permlane16_swap_b32 v20, v28
    v_permlane16_swap_b32 v21, v29
    v_permlane16_swap_b32 v22, v30
    v_permlane16_swap_b32 v23, v31
    v_lshlrev_b32 v52, 16, v76
    v_and_b32 v53, 0xffff0000, v76
    v_lshlrev_b32 v54, 16, v77
    v_and_b32 v55, 0xffff0000, v77
    v_add_f32 v20, v20, v52
    v_add_f32 v21, v21, v53
    v_add_f32 v22, v22, v54
    v_add_f32 v23, v23, v55
    v_lshlrev_b32 v52, 16, v78
    v_and_b32 v53, 0xffff0000, v78
    v_lshlrev_b32 v54, 16, v79
    v_and_b32 v55, 0xffff0000, v79
    v_add_f32 v28, v28, v52
    v_add_f32 v29, v29, v53
    v_add_f32 v30, v30, v54
    v_add_f32 v31, v31, v55
    v_add_f32 v85, v85, v20
    v_fmac_f32 v87, v20, v20
    v_add_f32 v85, v85, v21
    v_fmac_f32 v87, v21, v21
    v_add_f32 v85, v85, v22
    v_fmac_f32 v87, v22, v22
    v_add_f32 v85, v85, v23
    v_fmac_f32 v87, v23, v23
    v_add_f32 v85, v85, v28
    v_fmac_f32 v87, v28, v28
    v_add_f32 v85, v85, v29
    v_fmac_f32 v87, v29, v29
    v_add_f32 v85, v85, v30
    v_fmac_f32 v87, v30, v30
    v_add_f32 v85, v85, v31
    v_fmac_f32 v87, v31, v31
    v_cvt_pk_bf16_f32 v76, v20, v21
    v_cvt_pk_bf16_f32 v77, v22, v23
    v_cvt_pk_bf16_f32 v78, v28, v29
    v_cvt_pk_bf16_f32 v79, v30, v31
    s_mov_b32 s3, 8192
    buffer_store_dwordx4 v[76:79], v58, s[20:23], s3 offen offset:256 sc1
    v_mov_b32 v52, v84
    s_nop 1
    v_permlane16_swap_b32 v52, v84
    s_nop 1
    v_add_f32 v84, v84, v52
    v_mov_b32 v52, v84
    s_nop 1
    v_permlane32_swap_b32 v52, v84
    s_nop 1
    v_add_f32 v84, v84, v52
    v_mov_b32 v52, v85
    s_nop 1
    v_permlane16_swap_b32 v52, v85
    s_nop 1
    v_add_f32 v85, v85, v52
    v_mov_b32 v52, v85
    s_nop 1
    v_permlane32_swap_b32 v52, v85
    s_nop 1
    v_add_f32 v85, v85, v52
    v_mov_b32 v52, v86
    s_nop 1
    v_permlane16_swap_b32 v52, v86
    s_nop 1
    v_add_f32 v86, v86, v52
    v_mov_b32 v52, v86
    s_nop 1
    v_permlane32_swap_b32 v52, v86
    s_nop 1
    v_add_f32 v86, v86, v52
    v_mov_b32 v52, v87
    s_nop 1
    v_permlane16_swap_b32 v52, v87
    s_nop 1
    v_add_f32 v87, v87, v52
    v_mov_b32 v52, v87
    s_nop 1
    v_permlane32_swap_b32 v52, v87
    s_nop 1
    v_add_f32 v87, v87, v52
    s_add_u32 s24, s82, 46465024
    s_addc_u32 s25, s83, 0
    s_mov_b32 s26, 262144
    s_mov_b32 s27, 0x20000

    v_and_b32 v52, 31, v56
    s_lshl_b32 s3, s41, 7
    s_lshl_b32 s4, s40, 5
    s_add_u32 s3, s3, s4
    v_add_u32 v52, s3, v52
    v_lshlrev_b32 v52, 3, v52
    s_lshl_b32 s3, s42, 14
    v_add_u32 v52, s3, v52
    v_cmp_gt_u32 vcc, 16, v56
    s_nop 1
    v_cndmask_b32 v88, v85, v84, vcc
    v_cndmask_b32 v89, v87, v86, vcc
    s_mov_b32 exec_lo, -1
    s_mov_b32 exec_hi, 0
    buffer_store_dwordx2 v[88:89], v52, s[24:27], 0 offen sc1
    s_mov_b64 exec, -1

    s_waitcnt vmcnt(0)
    s_branch L_sequential_preLN__sliding_block__glu_gated_bilinear__prompt_kernel_Bend_89
L_sequential_preLN__sliding_block__glu_gated_bilinear__prompt_kernel_Bload_87:
    v_mbcnt_lo_u32_b32 v3, -1, 0
    v_mbcnt_hi_u32_b32 v3, -1, v3

    s_sub_u32 s43, s40, 4
    v_lshrrev_b32 v30, 3, v3
    v_and_b32 v32, 7, v3
    v_bfe_u32 v33, v30, 1, 2
    v_lshlrev_b32 v33, 1, v33
    v_xor_b32 v32, v32, v33
    v_and_b32 v33, 4, v30
    v_lshlrev_b32 v33, 1, v33
    v_and_b32 v31, 3, v30
    v_or_b32 v31, v31, v33
    s_lshl_b32 s3, s43, 4
    v_add_u32 v31, s3, v31
    v_lshlrev_b32 v31, 11, v31
    v_lshl_add_u32 v31, v32, 4, v31
    s_lshl_b32 s3, s42, 7
    v_add_u32 v31, s3, v31

    v_add_u32 v12, 0, v31
    v_add_u32 v13, 7168, v31
    s_mul_i32 s51, s42, 1
    s_add_u32 s51, s51, s41
    s_and_b32 s51, s51, 15

    s_lshl_b32 s47, s43, 12
    s_lshl_b32 s48, s43, 11
    s_add_u32 s48, s48, 16384

    s_mov_b32 s44, 0
    s_mov_b32 s49, s51
    s_lshl_b32 s46, s49, 17
    s_add_u32 m0, s44, s48
    s_nop 0
    buffer_load_dwordx4 v12, s[12:15], s46 offen offset:0 lds
    buffer_load_dwordx4 v13, s[12:15], s46 offen offset:1024 lds

    s_add_u32 s49, s49, 1
    s_cmp_ge_u32 s49, 16
    s_cselect_b32 s49, 0, s49
    s_add_u32 s44, s44, 24576
    s_cmp_ge_u32 s44, 122880
    s_cselect_b32 s44, 0, s44

    s_lshl_b32 s46, s49, 17
    s_add_u32 m0, s44, s48
    s_nop 0
    buffer_load_dwordx4 v12, s[12:15], s46 offen offset:0 lds
    buffer_load_dwordx4 v13, s[12:15], s46 offen offset:1024 lds

    s_add_u32 s49, s49, 1
    s_cmp_ge_u32 s49, 16
    s_cselect_b32 s49, 0, s49
    s_add_u32 s44, s44, 24576
    s_cmp_ge_u32 s44, 122880
    s_cselect_b32 s44, 0, s44

    s_lshl_b32 s46, s49, 17
    s_add_u32 m0, s44, s48
    s_nop 0
    buffer_load_dwordx4 v12, s[12:15], s46 offen offset:0 lds
    buffer_load_dwordx4 v13, s[12:15], s46 offen offset:1024 lds

    s_add_u32 s49, s49, 1
    s_cmp_ge_u32 s49, 16
    s_cselect_b32 s49, 0, s49
    s_add_u32 s44, s44, 24576
    s_cmp_ge_u32 s44, 122880
    s_cselect_b32 s44, 0, s44

    s_lshl_b32 s46, s49, 17
    s_add_u32 m0, s44, s48
    s_nop 0
    buffer_load_dwordx4 v12, s[12:15], s46 offen offset:0 lds
    buffer_load_dwordx4 v13, s[12:15], s46 offen offset:1024 lds

    s_add_u32 s49, s49, 1
    s_cmp_ge_u32 s49, 16
    s_cselect_b32 s49, 0, s49
    s_add_u32 s44, s44, 24576
    s_cmp_ge_u32 s44, 122880
    s_cselect_b32 s44, 0, s44

    s_lshl_b32 s46, s49, 17
    s_add_u32 m0, s44, s48
    s_nop 0
    buffer_load_dwordx4 v12, s[12:15], s46 offen offset:0 lds
    buffer_load_dwordx4 v13, s[12:15], s46 offen offset:1024 lds

    s_add_u32 s49, s49, 1
    s_cmp_ge_u32 s49, 16
    s_cselect_b32 s49, 0, s49
    s_add_u32 s44, s44, 24576
    s_cmp_ge_u32 s44, 122880
    s_cselect_b32 s44, 0, s44

    s_lshl_b32 s3, s41, 18
    s_lshl_b32 s4, s43, 12
    s_add_u32 s3, s3, s4
    v_lshl_add_u32 v4, v3, 4, s3
    v_add_u32 v5, 4096, v4

    s_cmp_eq_u32 s40, 7
    s_cbranch_scc0 L_sequential_preLN__sliding_block__glu_gated_bilinear__prompt_kernel_Bnp4_91
    s_lshl_b32 s3, s41, 12
    s_add_u32 s52, s3, 196608
    s_mov_b64 s[54:55], 0xffff
    v_mbcnt_lo_u32_b32 v30, -1, 0
    v_mbcnt_hi_u32_b32 v30, -1, v30

    v_lshlrev_b32 v30, 7, v30
    v_add_u32 v30, s52, v30
    v_mov_b32 v31, 0x7fff0000
    v_cndmask_b32 v30, v31, v30, s[54:55]
    s_mov_b32 s63, 0

    buffer_load_dword v31, v30, s[28:31], 0 offen sc1
L_sequential_preLN__sliding_block__glu_gated_bilinear__prompt_kernel_poll_92:
    buffer_load_dword v32, v30, s[28:31], 0 offen sc1
    s_waitcnt vmcnt(1)
    v_cmp_eq_u32 vcc, s62, v31
    s_nop 1
    s_and_b64 s[6:7], vcc, s[54:55]
    s_cmp_eq_u64 s[6:7], s[54:55]
    s_cbranch_scc1 L_sequential_preLN__sliding_block__glu_gated_bilinear__prompt_kernel_polld_93
    buffer_load_dword v31, v30, s[28:31], 0 offen sc1
    s_waitcnt vmcnt(1)
    v_cmp_eq_u32 vcc, s62, v32
    s_nop 1
    s_and_b64 s[6:7], vcc, s[54:55]
    s_cmp_eq_u64 s[6:7], s[54:55]
    s_cbranch_scc1 L_sequential_preLN__sliding_block__glu_gated_bilinear__prompt_kernel_polld_93
    s_add_u32 s63, s63, 1
    s_cmp_lt_u32 s63, 40000
    s_cbranch_scc1 L_sequential_preLN__sliding_block__glu_gated_bilinear__prompt_kernel_poll_92
L_sequential_preLN__sliding_block__glu_gated_bilinear__prompt_kernel_polld_93:

L_sequential_preLN__sliding_block__glu_gated_bilinear__prompt_kernel_Bnp4_91:
    s_mov_b32 s44, 0
    s_mov_b32 s49, s51
    s_barrier
    s_lshl_b32 s45, s49, 14
    s_add_u32 s4, s44, s47
    s_add_u32 m0, s4, 0
    s_nop 0
    buffer_load_dwordx4 v4, s[8:11], s45 offen offset:0 sc1 lds
    buffer_load_dwordx4 v4, s[8:11], s45 offen offset:1024 sc1 lds
    buffer_load_dwordx4 v4, s[8:11], s45 offen offset:2048 sc1 lds
    buffer_load_dwordx4 v4, s[8:11], s45 offen offset:3072 sc1 lds

    s_add_u32 s49, s49, 1
    s_cmp_ge_u32 s49, 16
    s_cselect_b32 s49, 0, s49
    s_add_u32 s44, s44, 24576
    s_cmp_ge_u32 s44, 122880
    s_cselect_b32 s44, 0, s44

    s_waitcnt vmcnt(0)
    s_barrier
    s_lshl_b32 s45, s49, 14
    s_add_u32 s4, s44, s47
    s_add_u32 m0, s4, 0
    s_nop 0
    buffer_load_dwordx4 v4, s[8:11], s45 offen offset:0 sc1 lds
    buffer_load_dwordx4 v4, s[8:11], s45 offen offset:1024 sc1 lds
    buffer_load_dwordx4 v4, s[8:11], s45 offen offset:2048 sc1 lds
    buffer_load_dwordx4 v4, s[8:11], s45 offen offset:3072 sc1 lds

    s_add_u32 s49, s49, 1
    s_cmp_ge_u32 s49, 16
    s_cselect_b32 s49, 0, s49
    s_add_u32 s44, s44, 24576
    s_cmp_ge_u32 s44, 122880
    s_cselect_b32 s44, 0, s44

    s_lshl_b32 s45, s49, 14
    s_add_u32 s4, s44, s47
    s_add_u32 m0, s4, 0
    s_nop 0
    buffer_load_dwordx4 v4, s[8:11], s45 offen offset:0 sc1 lds
    buffer_load_dwordx4 v4, s[8:11], s45 offen offset:1024 sc1 lds
    buffer_load_dwordx4 v4, s[8:11], s45 offen offset:2048 sc1 lds
    buffer_load_dwordx4 v4, s[8:11], s45 offen offset:3072 sc1 lds

    s_add_u32 s49, s49, 1
    s_cmp_ge_u32 s49, 16
    s_cselect_b32 s49, 0, s49
    s_add_u32 s44, s44, 24576
    s_cmp_ge_u32 s44, 122880
    s_cselect_b32 s44, 0, s44

    s_lshl_b32 s45, s49, 14
    s_add_u32 s4, s44, s47
    s_add_u32 m0, s4, 0
    s_nop 0
    buffer_load_dwordx4 v4, s[8:11], s45 offen offset:0 sc1 lds
    buffer_load_dwordx4 v4, s[8:11], s45 offen offset:1024 sc1 lds
    buffer_load_dwordx4 v4, s[8:11], s45 offen offset:2048 sc1 lds
    buffer_load_dwordx4 v4, s[8:11], s45 offen offset:3072 sc1 lds

    s_add_u32 s49, s49, 1
    s_cmp_ge_u32 s49, 16
    s_cselect_b32 s49, 0, s49
    s_add_u32 s44, s44, 24576
    s_cmp_ge_u32 s44, 122880
    s_cselect_b32 s44, 0, s44

    s_lshl_b32 s45, s49, 14
    s_add_u32 s4, s44, s47
    s_add_u32 m0, s4, 0
    s_nop 0
    buffer_load_dwordx4 v4, s[8:11], s45 offen offset:0 sc1 lds
    buffer_load_dwordx4 v4, s[8:11], s45 offen offset:1024 sc1 lds
    buffer_load_dwordx4 v4, s[8:11], s45 offen offset:2048 sc1 lds
    buffer_load_dwordx4 v4, s[8:11], s45 offen offset:3072 sc1 lds

    s_add_u32 s49, s49, 1
    s_cmp_ge_u32 s49, 16
    s_cselect_b32 s49, 0, s49
    s_add_u32 s44, s44, 24576
    s_cmp_ge_u32 s44, 122880
    s_cselect_b32 s44, 0, s44

    s_waitcnt vmcnt(12)
    s_barrier
    s_lshl_b32 s45, s49, 14
    s_add_u32 s4, s44, s47
    s_add_u32 m0, s4, 0
    s_nop 0
    buffer_load_dwordx4 v4, s[8:11], s45 offen offset:0 sc1 lds
    buffer_load_dwordx4 v4, s[8:11], s45 offen offset:1024 sc1 lds
    buffer_load_dwordx4 v4, s[8:11], s45 offen offset:2048 sc1 lds
    buffer_load_dwordx4 v4, s[8:11], s45 offen offset:3072 sc1 lds
    s_lshl_b32 s46, s49, 17
    s_add_u32 m0, s44, s48
    s_nop 0
    buffer_load_dwordx4 v12, s[12:15], s46 offen offset:0 lds
    buffer_load_dwordx4 v13, s[12:15], s46 offen offset:1024 lds

    s_add_u32 s49, s49, 1
    s_cmp_ge_u32 s49, 16
    s_cselect_b32 s49, 0, s49
    s_add_u32 s44, s44, 24576
    s_cmp_ge_u32 s44, 122880
    s_cselect_b32 s44, 0, s44

    s_waitcnt vmcnt(14)
    s_barrier
    s_lshl_b32 s45, s49, 14
    s_add_u32 s4, s44, s47
    s_add_u32 m0, s4, 0
    s_nop 0
    buffer_load_dwordx4 v4, s[8:11], s45 offen offset:0 sc1 lds
    buffer_load_dwordx4 v4, s[8:11], s45 offen offset:1024 sc1 lds
    buffer_load_dwordx4 v4, s[8:11], s45 offen offset:2048 sc1 lds
    buffer_load_dwordx4 v4, s[8:11], s45 offen offset:3072 sc1 lds
    s_lshl_b32 s46, s49, 17
    s_add_u32 m0, s44, s48
    s_nop 0
    buffer_load_dwordx4 v12, s[12:15], s46 offen offset:0 lds
    buffer_load_dwordx4 v13, s[12:15], s46 offen offset:1024 lds

    s_add_u32 s49, s49, 1
    s_cmp_ge_u32 s49, 16
    s_cselect_b32 s49, 0, s49
    s_add_u32 s44, s44, 24576
    s_cmp_ge_u32 s44, 122880
    s_cselect_b32 s44, 0, s44

    s_waitcnt vmcnt(16)
    s_barrier
    s_lshl_b32 s45, s49, 14
    s_add_u32 s4, s44, s47
    s_add_u32 m0, s4, 0
    s_nop 0
    buffer_load_dwordx4 v4, s[8:11], s45 offen offset:0 sc1 lds
    buffer_load_dwordx4 v4, s[8:11], s45 offen offset:1024 sc1 lds
    buffer_load_dwordx4 v4, s[8:11], s45 offen offset:2048 sc1 lds
    buffer_load_dwordx4 v4, s[8:11], s45 offen offset:3072 sc1 lds
    s_lshl_b32 s46, s49, 17
    s_add_u32 m0, s44, s48
    s_nop 0
    buffer_load_dwordx4 v12, s[12:15], s46 offen offset:0 lds
    buffer_load_dwordx4 v13, s[12:15], s46 offen offset:1024 lds

    s_add_u32 s49, s49, 1
    s_cmp_ge_u32 s49, 16
    s_cselect_b32 s49, 0, s49
    s_add_u32 s44, s44, 24576
    s_cmp_ge_u32 s44, 122880
    s_cselect_b32 s44, 0, s44

    s_waitcnt vmcnt(18)
    s_barrier
    s_lshl_b32 s45, s49, 14
    s_add_u32 s4, s44, s47
    s_add_u32 m0, s4, 0
    s_nop 0
    buffer_load_dwordx4 v4, s[8:11], s45 offen offset:0 sc1 lds
    buffer_load_dwordx4 v4, s[8:11], s45 offen offset:1024 sc1 lds
    buffer_load_dwordx4 v4, s[8:11], s45 offen offset:2048 sc1 lds
    buffer_load_dwordx4 v4, s[8:11], s45 offen offset:3072 sc1 lds
    s_lshl_b32 s46, s49, 17
    s_add_u32 m0, s44, s48
    s_nop 0
    buffer_load_dwordx4 v12, s[12:15], s46 offen offset:0 lds
    buffer_load_dwordx4 v13, s[12:15], s46 offen offset:1024 lds

    s_add_u32 s49, s49, 1
    s_cmp_ge_u32 s49, 16
    s_cselect_b32 s49, 0, s49
    s_add_u32 s44, s44, 24576
    s_cmp_ge_u32 s44, 122880
    s_cselect_b32 s44, 0, s44

    s_mov_b32 s50, 4
L_sequential_preLN__sliding_block__glu_gated_bilinear__prompt_kernel_Blloop_94:
    s_waitcnt vmcnt(18)
    s_barrier
    s_lshl_b32 s45, s49, 14
    s_add_u32 s4, s44, s47
    s_add_u32 m0, s4, 0
    s_nop 0
    buffer_load_dwordx4 v4, s[8:11], s45 offen offset:0 sc1 lds
    buffer_load_dwordx4 v4, s[8:11], s45 offen offset:1024 sc1 lds
    buffer_load_dwordx4 v4, s[8:11], s45 offen offset:2048 sc1 lds
    buffer_load_dwordx4 v4, s[8:11], s45 offen offset:3072 sc1 lds
    s_lshl_b32 s46, s49, 17
    s_add_u32 m0, s44, s48
    s_nop 0
    buffer_load_dwordx4 v12, s[12:15], s46 offen offset:0 lds
    buffer_load_dwordx4 v13, s[12:15], s46 offen offset:1024 lds

    s_add_u32 s49, s49, 1
    s_cmp_ge_u32 s49, 16
    s_cselect_b32 s49, 0, s49
    s_add_u32 s44, s44, 24576
    s_cmp_ge_u32 s44, 122880
    s_cselect_b32 s44, 0, s44

    s_add_u32 s50, s50, 1
    s_cmp_lt_u32 s50, 11
    s_cbranch_scc1 L_sequential_preLN__sliding_block__glu_gated_bilinear__prompt_kernel_Blloop_94
    s_waitcnt vmcnt(18)
    s_barrier
    s_waitcnt vmcnt(12)
    s_barrier
    s_waitcnt vmcnt(6)
    s_barrier
    s_waitcnt vmcnt(0)
    s_barrier
    s_waitcnt vmcnt(0)
    s_barrier
    s_branch L_sequential_preLN__sliding_block__glu_gated_bilinear__prompt_kernel_Bend_89
L_sequential_preLN__sliding_block__glu_gated_bilinear__prompt_kernel_Bhelp_88:
    s_cmp_eq_u32 s40, 7
    s_cbranch_scc0 L_sequential_preLN__sliding_block__glu_gated_bilinear__prompt_kernel_Bnopoll_95
    s_lshl_b32 s3, s41, 12
    s_add_u32 s47, s3, 196608
    s_mov_b64 s[48:49], 0xffff
    v_mbcnt_lo_u32_b32 v30, -1, 0
    v_mbcnt_hi_u32_b32 v30, -1, v30

    v_lshlrev_b32 v30, 7, v30
    v_add_u32 v30, s47, v30
    v_mov_b32 v31, 0x7fff0000
    v_cndmask_b32 v30, v31, v30, s[48:49]
    s_mov_b32 s63, 0

    buffer_load_dword v31, v30, s[28:31], 0 offen sc1
L_sequential_preLN__sliding_block__glu_gated_bilinear__prompt_kernel_poll_96:
    buffer_load_dword v32, v30, s[28:31], 0 offen sc1
    s_waitcnt vmcnt(1)
    v_cmp_eq_u32 vcc, s62, v31
    s_nop 1
    s_and_b64 s[6:7], vcc, s[48:49]
    s_cmp_eq_u64 s[6:7], s[48:49]
    s_cbranch_scc1 L_sequential_preLN__sliding_block__glu_gated_bilinear__prompt_kernel_polld_97
    buffer_load_dword v31, v30, s[28:31], 0 offen sc1
    s_waitcnt vmcnt(1)
    v_cmp_eq_u32 vcc, s62, v32
    s_nop 1
    s_and_b64 s[6:7], vcc, s[48:49]
    s_cmp_eq_u64 s[6:7], s[48:49]
    s_cbranch_scc1 L_sequential_preLN__sliding_block__glu_gated_bilinear__prompt_kernel_polld_97
    s_add_u32 s63, s63, 1
    s_cmp_lt_u32 s63, 40000
    s_cbranch_scc1 L_sequential_preLN__sliding_block__glu_gated_bilinear__prompt_kernel_poll_96
L_sequential_preLN__sliding_block__glu_gated_bilinear__prompt_kernel_polld_97:

L_sequential_preLN__sliding_block__glu_gated_bilinear__prompt_kernel_Bnopoll_95:
    s_mov_b32 s50, 0
L_sequential_preLN__sliding_block__glu_gated_bilinear__prompt_kernel_Bhloop_98:
    s_barrier
    s_add_u32 s50, s50, 1
    s_cmp_lt_u32 s50, 18
    s_cbranch_scc1 L_sequential_preLN__sliding_block__glu_gated_bilinear__prompt_kernel_Bhloop_98
L_sequential_preLN__sliding_block__glu_gated_bilinear__prompt_kernel_Bend_89:
    s_barrier
    s_cmp_eq_u32 s40, 6
    s_cbranch_scc0 L_sequential_preLN__sliding_block__glu_gated_bilinear__prompt_kernel_nopub_99
    s_lshr_b32 s3, s41, 1
    s_lshl_b32 s3, s3, 12
    s_and_b32 s4, s41, 1
    s_lshl_b32 s4, s4, 4
    s_add_u32 s4, s4, s42
    s_lshl_b32 s4, s4, 7
    s_add_u32 s3, s3, s4
    s_add_u32 s47, s3, 262144

    v_mov_b32 v30, s47
    v_mov_b32 v31, s62
    s_mov_b64 exec, 1
    buffer_store_dword v31, v30, s[28:31], 0 offen sc1
    s_mov_b64 exec, -1

L_sequential_preLN__sliding_block__glu_gated_bilinear__prompt_kernel_nopub_99:
    v_mbcnt_lo_u32_b32 v164, -1, 0
    v_mbcnt_hi_u32_b32 v164, -1, v164

    s_and_b32 s3, s2, 7
    s_lshr_b32 s4, s2, 3
    s_and_b32 s5, s3, 1
    s_lshl_b32 s5, s5, 2
    s_and_b32 s6, s4, 3
    s_add_u32 s43, s5, s6
    s_lshr_b32 s6, s3, 1
    s_lshl_b32 s6, s6, 3
    s_lshr_b32 s7, s4, 2
    s_add_u32 s44, s6, s7
    s_lshl_b32 s45, s43, 8
    s_mul_i32 s46, s44, 112
    s_lshr_b32 s47, s40, 1
    s_and_b32 s48, s40, 1

    s_add_u32 s8, s82, 20971520
    s_addc_u32 s9, s83, 0
    s_mov_b32 s10, 4194304
    s_mov_b32 s11, 0x20000
    s_mov_b32 s12, s72
    s_mov_b32 s13, s73
    s_mov_b32 s14, 7340032
    s_mov_b32 s15, 0x20000
    s_mov_b32 s16, s74
    s_mov_b32 s17, s75
    s_mov_b32 s18, 7340032
    s_mov_b32 s19, 0x20000

    s_cmp_ge_u32 s40, 6
    s_cselect_b32 s20, s74, s72
    s_cselect_b32 s21, s75, s73
    s_mov_b32 s22, 7340032
    s_mov_b32 s23, 0x20000

    s_lshl_b32 s4, s46, 1
    s_mov_b32 s5, 4682

    s_add_u32 s3, s40, 0
    s_cmp_ge_u32 s3, 14
    s_cselect_b32 s6, 14, 0
    s_cselect_b32 s7, 14352, 0
    s_sub_u32 s3, s3, s6
    s_lshl_b32 s6, s3, 10
    s_add_u32 s53, s6, s7
    s_lshl_b32 s3, s3, 6
    v_add_u32 v124, s3, v164
    v_mul_u32_u24 v125, s5, v124
    v_lshrrev_b32 v125, 16, v125
    v_mul_u32_u24 v126, 14, v125
    v_sub_u32 v126, v124, v126
    v_and_b32 v127, 4, v125
    v_lshlrev_b32 v127, 1, v127
    v_and_b32 v124, 8, v125
    v_lshrrev_b32 v124, 1, v124
    v_or_b32 v127, v127, v124
    v_and_b32 v125, 0x33, v125
    v_or_b32 v125, v125, v127
    v_mul_u32_u24 v125, 7168, v125
    v_lshl_add_u32 v125, v126, 4, v125
    v_add_u32 v116, s4, v125

    s_add_u32 s3, s40, 8
    s_cmp_ge_u32 s3, 14
    s_cselect_b32 s6, 14, 0
    s_cselect_b32 s7, 14352, 0
    s_sub_u32 s3, s3, s6
    s_lshl_b32 s6, s3, 10
    s_add_u32 s54, s6, s7
    s_lshl_b32 s3, s3, 6
    v_add_u32 v124, s3, v164
    v_mul_u32_u24 v125, s5, v124
    v_lshrrev_b32 v125, 16, v125
    v_mul_u32_u24 v126, 14, v125
    v_sub_u32 v126, v124, v126
    v_and_b32 v127, 4, v125
    v_lshlrev_b32 v127, 1, v127
    v_and_b32 v124, 8, v125
    v_lshrrev_b32 v124, 1, v124
    v_or_b32 v127, v127, v124
    v_and_b32 v125, 0x33, v125
    v_or_b32 v125, v125, v127
    v_mul_u32_u24 v125, 7168, v125
    v_lshl_add_u32 v125, v126, 4, v125
    v_add_u32 v117, s4, v125

    s_add_u32 s3, s40, 16
    s_cmp_ge_u32 s3, 14
    s_cselect_b32 s6, 14, 0
    s_cselect_b32 s7, 14352, 0
    s_sub_u32 s3, s3, s6
    s_lshl_b32 s6, s3, 10
    s_add_u32 s55, s6, s7
    s_lshl_b32 s3, s3, 6
    v_add_u32 v124, s3, v164
    v_mul_u32_u24 v125, s5, v124
    v_lshrrev_b32 v125, 16, v125
    v_mul_u32_u24 v126, 14, v125
    v_sub_u32 v126, v124, v126
    v_and_b32 v127, 4, v125
    v_lshlrev_b32 v127, 1, v127
    v_and_b32 v124, 8, v125
    v_lshrrev_b32 v124, 1, v124
    v_or_b32 v127, v127, v124
    v_and_b32 v125, 0x33, v125
    v_or_b32 v125, v125, v127
    v_mul_u32_u24 v125, 7168, v125
    v_lshl_add_u32 v125, v126, 4, v125
    v_add_u32 v118, s4, v125

    s_add_u32 s3, s40, 24
    s_cmp_ge_u32 s3, 14
    s_cselect_b32 s6, 14, 0
    s_cselect_b32 s7, 14352, 0
    s_sub_u32 s3, s3, s6
    s_lshl_b32 s6, s3, 10
    s_add_u32 s56, s6, s7
    s_lshl_b32 s3, s3, 6
    v_add_u32 v124, s3, v164
    v_mul_u32_u24 v125, s5, v124
    v_lshrrev_b32 v125, 16, v125
    v_mul_u32_u24 v126, 14, v125
    v_sub_u32 v126, v124, v126
    v_and_b32 v127, 4, v125
    v_lshlrev_b32 v127, 1, v127
    v_and_b32 v124, 8, v125
    v_lshrrev_b32 v124, 1, v124
    v_or_b32 v127, v127, v124
    v_and_b32 v125, 0x33, v125
    v_or_b32 v125, v125, v127
    v_mul_u32_u24 v125, 7168, v125
    v_lshl_add_u32 v125, v126, 4, v125
    v_add_u32 v119, s4, v125

    s_lshl_b32 s51, s43, 1
    s_mov_b32 s52, s51
    s_lshl_b32 s32, s51, 14
    s_mul_i32 s33, s52, 458752
    s_lshl_b32 s34, s40, 12
    s_mov_b32 s35, 98304
    s_mov_b32 s36, 28704

    s_add_u32 m0, s35, s53
    s_nop 0
    buffer_load_dwordx4 v116, s[12:15], s33 offen lds
    s_add_u32 m0, s35, s54
    s_nop 0
    buffer_load_dwordx4 v117, s[20:23], s33 offen lds
    s_add_u32 m0, s35, s55
    s_nop 0
    buffer_load_dwordx4 v118, s[16:19], s33 offen lds
    s_cmp_ge_u32 s40, 4
    s_cbranch_scc1 L_sequential_preLN__sliding_block__glu_gated_bilinear__prompt_kernel_Cskip_100
    s_add_u32 m0, s35, s56
    s_nop 0
    buffer_load_dwordx4 v119, s[16:19], s33 offen lds
L_sequential_preLN__sliding_block__glu_gated_bilinear__prompt_kernel_Cskip_100:
    s_add_u32 s52, s52, 1
    s_and_b32 s52, s52, 15
    s_mul_i32 s33, s52, 458752
    s_add_u32 s35, s35, s36
    s_sub_u32 s36, 0, s36
    s_add_u32 m0, s35, s53
    s_nop 0
    buffer_load_dwordx4 v116, s[12:15], s33 offen lds
    s_add_u32 m0, s35, s54
    s_nop 0
    buffer_load_dwordx4 v117, s[20:23], s33 offen lds
    s_add_u32 m0, s35, s55
    s_nop 0
    buffer_load_dwordx4 v118, s[16:19], s33 offen lds
    s_cmp_ge_u32 s40, 4
    s_cbranch_scc1 L_sequential_preLN__sliding_block__glu_gated_bilinear__prompt_kernel_Cskip_101
    s_add_u32 m0, s35, s56
    s_nop 0
    buffer_load_dwordx4 v119, s[16:19], s33 offen lds
L_sequential_preLN__sliding_block__glu_gated_bilinear__prompt_kernel_Cskip_101:
    s_add_u32 s52, s52, 1
    s_and_b32 s52, s52, 15
    s_mul_i32 s33, s52, 458752
    s_add_u32 s35, s35, s36
    s_sub_u32 s36, 0, s36

    s_lshl_b32 s3, s43, 19
    s_lshl_b32 s4, s40, 11
    s_add_u32 s3, s3, s4
    v_lshl_add_u32 v112, v164, 4, s3
    v_add_u32 v113, 260096, v112
    v_and_b32 v124, 15, v164
    v_lshrrev_b32 v125, 4, v164
    s_lshl_b32 s3, s47, 6
    v_add_u32 v124, s3, v124
    v_lshlrev_b32 v124, 4, v124
    v_lshl_add_u32 v120, v125, 12, v124
    v_add_u32 v121, 16384, v120
    v_lshrrev_b32 v124, 5, v164
    v_lshlrev_b32 v124, 4, v124
    v_bfe_u32 v125, v164, 4, 1
    v_lshl_add_u32 v124, v125, 2, v124
    v_bfe_u32 v125, v164, 2, 2
    v_add_u32 v124, v124, v125
    v_mul_u32_u24 v124, 224, v124
    s_mul_i32 s3, s48, 112
    s_add_u32 s3, s3, 98304
    v_add_u32 v124, s3, v124
    v_and_b32 v125, 3, v164
    v_lshl_add_u32 v122, v125, 3, v124
    v_and_b32 v126, 1, v125
    v_lshl_add_u32 v124, v126, 3, v124
    v_lshrrev_b32 v126, 1, v125
    v_mul_u32_u24 v126, 14352, v126
    v_add_u32 v124, v124, v126
    v_add_u32 v123, 96, v124

    s_mul_i32 s3, s2, 224
    s_mul_i32 s4, s40, 3
    s_add_u32 s3, s3, s4
    v_add_u32 v124, s3, v164
    v_lshlrev_b32 v124, 7, v124
    v_mov_b32 v125, 0x7fff0000
    v_cmp_gt_u32 vcc, 3, v164
    s_nop 1
    v_cndmask_b32 v160, v125, v124, vcc
    s_mov_b32 s92, s76
    s_mov_b32 s93, s77
    s_mov_b32 s94, 7340032
    s_mov_b32 s95, 0x20000
    s_mov_b32 s96, 0

    s_cmp_eq_u32 s40, 7
    s_cbranch_scc0 L_sequential_preLN__sliding_block__glu_gated_bilinear__prompt_kernel_Cnopoll_103
    s_lshl_b32 s3, s43, 12
    s_add_u32 s57, s3, 262144
    s_mov_b64 s[58:59], 0xffffffff
    v_mbcnt_lo_u32_b32 v136, -1, 0
    v_mbcnt_hi_u32_b32 v136, -1, v136

    v_lshlrev_b32 v136, 7, v136
    v_add_u32 v136, s57, v136
    v_mov_b32 v137, 0x7fff0000
    v_cndmask_b32 v136, v137, v136, s[58:59]
    s_mov_b32 s63, 0

    buffer_load_dword v137, v136, s[28:31], 0 offen sc1
L_sequential_preLN__sliding_block__glu_gated_bilinear__prompt_kernel_poll_104:
    buffer_load_dword v138, v136, s[28:31], 0 offen sc1
    s_waitcnt vmcnt(1)
    v_cmp_eq_u32 vcc, s62, v137
    s_nop 1
    s_and_b64 s[6:7], vcc, s[58:59]
    s_cmp_eq_u64 s[6:7], s[58:59]
    s_cbranch_scc1 L_sequential_preLN__sliding_block__glu_gated_bilinear__prompt_kernel_polld_105
    buffer_load_dword v137, v136, s[28:31], 0 offen sc1
    s_waitcnt vmcnt(1)
    v_cmp_eq_u32 vcc, s62, v138
    s_nop 1
    s_and_b64 s[6:7], vcc, s[58:59]
    s_cmp_eq_u64 s[6:7], s[58:59]
    s_cbranch_scc1 L_sequential_preLN__sliding_block__glu_gated_bilinear__prompt_kernel_polld_105
    s_add_u32 s63, s63, 1
    s_cmp_lt_u32 s63, 40000
    s_cbranch_scc1 L_sequential_preLN__sliding_block__glu_gated_bilinear__prompt_kernel_poll_104
L_sequential_preLN__sliding_block__glu_gated_bilinear__prompt_kernel_polld_105:

L_sequential_preLN__sliding_block__glu_gated_bilinear__prompt_kernel_Cnopoll_103:
    s_barrier
    s_mov_b32 m0, s34
    s_nop 0
    buffer_load_dwordx4 v112, s[8:11], s32 offen offset:0 sc1 lds
    buffer_load_dwordx4 v112, s[8:11], s32 offen offset:1024 sc1 lds
    buffer_load_dwordx4 v113, s[8:11], s32 offen offset:2048 sc1 lds
    buffer_load_dwordx4 v113, s[8:11], s32 offen offset:3072 sc1 lds
    s_add_u32 s51, s51, 1
    s_and_b32 s51, s51, 15
    s_lshl_b32 s32, s51, 14
    s_add_u32 s34, s34, 32768
    s_cmp_ge_u32 s34, 98304
    s_cselect_b32 s3, 98304, 0
    s_sub_u32 s34, s34, s3
    s_mov_b32 m0, s34
    s_nop 0
    buffer_load_dwordx4 v112, s[8:11], s32 offen offset:0 sc1 lds
    buffer_load_dwordx4 v112, s[8:11], s32 offen offset:1024 sc1 lds
    buffer_load_dwordx4 v113, s[8:11], s32 offen offset:2048 sc1 lds
    buffer_load_dwordx4 v113, s[8:11], s32 offen offset:3072 sc1 lds
    s_add_u32 s51, s51, 1
    s_and_b32 s51, s51, 15
    s_lshl_b32 s32, s51, 14
    s_add_u32 s34, s34, 32768
    s_cmp_ge_u32 s34, 98304
    s_cselect_b32 s3, 98304, 0
    s_sub_u32 s34, s34, s3
    s_waitcnt vmcnt(8)
    s_barrier
    s_cmp_lt_u32 s40, 2
    s_cbranch_scc0 L_sequential_preLN__sliding_block__glu_gated_bilinear__prompt_kernel_Cnocs_102
    v_mov_b32 v150, 0x3f803f80
    v_mov_b32 v151, 0x3f803f80
    v_mov_b32 v152, 0x3f803f80
    v_mov_b32 v153, 0x3f803f80
    ds_read_b64_tr_b16 a[32:33], v122 offset:0
    ds_read_b64_tr_b16 a[34:35], v122 offset:1792
    ds_read_b64_tr_b16 a[36:37], v122 offset:32
    ds_read_b64_tr_b16 a[38:39], v122 offset:1824
    ds_read_b64_tr_b16 a[40:41], v122 offset:64
    ds_read_b64_tr_b16 a[42:43], v122 offset:1856
    ds_read_b64_tr_b16 a[44:45], v122 offset:14352
    ds_read_b64_tr_b16 a[46:47], v122 offset:16144
    ds_read_b64_tr_b16 a[48:49], v122 offset:14384
    ds_read_b64_tr_b16 a[50:51], v122 offset:16176
    ds_read_b64_tr_b16 a[52:53], v122 offset:14416
    ds_read_b64_tr_b16 a[54:55], v122 offset:16208
    ds_read_b64_tr_b16 a[56:57], v123 offset:0
    ds_read_b64_tr_b16 a[58:59], v123 offset:1792
    s_waitcnt lgkmcnt(0)
    ds_read_b64_tr_b16 a[60:61], v122 offset:7168
    ds_read_b64_tr_b16 a[62:63], v122 offset:8960
    ds_read_b64_tr_b16 a[64:65], v122 offset:7200
    ds_read_b64_tr_b16 a[66:67], v122 offset:8992
    ds_read_b64_tr_b16 a[68:69], v122 offset:7232
    ds_read_b64_tr_b16 a[70:71], v122 offset:9024
    ds_read_b64_tr_b16 a[72:73], v122 offset:21520
    ds_read_b64_tr_b16 a[74:75], v122 offset:23312
    ds_read_b64_tr_b16 a[76:77], v122 offset:21552
    ds_read_b64_tr_b16 a[78:79], v122 offset:23344
    ds_read_b64_tr_b16 a[80:81], v122 offset:21584
    ds_read_b64_tr_b16 a[82:83], v122 offset:23376
    ds_read_b64_tr_b16 a[84:85], v123 offset:7168
    ds_read_b64_tr_b16 a[86:87], v123 offset:8960
    v_mfma_f32_16x16x32_bf16 a[0:3], a[32:35], v[150:153], 0
    v_mfma_f32_16x16x32_bf16 a[4:7], a[36:39], v[150:153], 0
    v_mfma_f32_16x16x32_bf16 a[8:11], a[40:43], v[150:153], 0
    v_mfma_f32_16x16x32_bf16 a[12:15], a[44:47], v[150:153], 0
    v_mfma_f32_16x16x32_bf16 a[16:19], a[48:51], v[150:153], 0
    v_mfma_f32_16x16x32_bf16 a[20:23], a[52:55], v[150:153], 0
    v_mfma_f32_16x16x32_bf16 a[24:27], a[56:59], v[150:153], 0
    s_waitcnt lgkmcnt(0)
    ds_read_b64_tr_b16 a[32:33], v122 offset:28704
    ds_read_b64_tr_b16 a[34:35], v122 offset:30496
    ds_read_b64_tr_b16 a[36:37], v122 offset:28736
    ds_read_b64_tr_b16 a[38:39], v122 offset:30528
    ds_read_b64_tr_b16 a[40:41], v122 offset:28768
    ds_read_b64_tr_b16 a[42:43], v122 offset:30560
    ds_read_b64_tr_b16 a[44:45], v122 offset:43056
    ds_read_b64_tr_b16 a[46:47], v122 offset:44848
    ds_read_b64_tr_b16 a[48:49], v122 offset:43088
    ds_read_b64_tr_b16 a[50:51], v122 offset:44880
    ds_read_b64_tr_b16 a[52:53], v122 offset:43120
    ds_read_b64_tr_b16 a[54:55], v122 offset:44912
    ds_read_b64_tr_b16 a[56:57], v123 offset:28704
    ds_read_b64_tr_b16 a[58:59], v123 offset:30496
    v_mfma_f32_16x16x32_bf16 a[0:3], a[60:63], v[150:153], a[0:3]
    v_mfma_f32_16x16x32_bf16 a[4:7], a[64:67], v[150:153], a[4:7]
    v_mfma_f32_16x16x32_bf16 a[8:11], a[68:71], v[150:153], a[8:11]
    v_mfma_f32_16x16x32_bf16 a[12:15], a[72:75], v[150:153], a[12:15]
    v_mfma_f32_16x16x32_bf16 a[16:19], a[76:79], v[150:153], a[16:19]
    v_mfma_f32_16x16x32_bf16 a[20:23], a[80:83], v[150:153], a[20:23]
    v_mfma_f32_16x16x32_bf16 a[24:27], a[84:87], v[150:153], a[24:27]
    s_waitcnt lgkmcnt(0)
    ds_read_b64_tr_b16 a[60:61], v122 offset:35872
    ds_read_b64_tr_b16 a[62:63], v122 offset:37664
    ds_read_b64_tr_b16 a[64:65], v122 offset:35904
    ds_read_b64_tr_b16 a[66:67], v122 offset:37696
    ds_read_b64_tr_b16 a[68:69], v122 offset:35936
    ds_read_b64_tr_b16 a[70:71], v122 offset:37728
    ds_read_b64_tr_b16 a[72:73], v122 offset:50224
    ds_read_b64_tr_b16 a[74:75], v122 offset:52016
    ds_read_b64_tr_b16 a[76:77], v122 offset:50256
    ds_read_b64_tr_b16 a[78:79], v122 offset:52048
    ds_read_b64_tr_b16 a[80:81], v122 offset:50288
    ds_read_b64_tr_b16 a[82:83], v122 offset:52080
    ds_read_b64_tr_b16 a[84:85], v123 offset:35872
    ds_read_b64_tr_b16 a[86:87], v123 offset:37664
    v_mfma_f32_16x16x32_bf16 a[0:3], a[32:35], v[150:153], a[0:3]
    v_mfma_f32_16x16x32_bf16 a[4:7], a[36:39], v[150:153], a[4:7]
    v_mfma_f32_16x16x32_bf16 a[8:11], a[40:43], v[150:153], a[8:11]
    v_mfma_f32_16x16x32_bf16 a[12:15], a[44:47], v[150:153], a[12:15]
    v_mfma_f32_16x16x32_bf16 a[16:19], a[48:51], v[150:153], a[16:19]
    v_mfma_f32_16x16x32_bf16 a[20:23], a[52:55], v[150:153], a[20:23]
    v_mfma_f32_16x16x32_bf16 a[24:27], a[56:59], v[150:153], a[24:27]
    s_waitcnt lgkmcnt(0)
    v_mfma_f32_16x16x32_bf16 a[0:3], a[60:63], v[150:153], a[0:3]
    v_mfma_f32_16x16x32_bf16 a[4:7], a[64:67], v[150:153], a[4:7]
    v_mfma_f32_16x16x32_bf16 a[8:11], a[68:71], v[150:153], a[8:11]
    v_mfma_f32_16x16x32_bf16 a[12:15], a[72:75], v[150:153], a[12:15]
    v_mfma_f32_16x16x32_bf16 a[16:19], a[76:79], v[150:153], a[16:19]
    v_mfma_f32_16x16x32_bf16 a[20:23], a[80:83], v[150:153], a[20:23]
    v_mfma_f32_16x16x32_bf16 a[24:27], a[84:87], v[150:153], a[24:27]
    s_add_u32 s24, s82, 46727168
    s_addc_u32 s25, s83, 0
    s_mov_b32 s26, 229376
    s_mov_b32 s27, 0x20000

    s_lshl_b32 s3, s44, 3
    s_add_u32 s3, s3, s43
    s_mul_i32 s3, s3, 896
    s_mul_i32 s4, s48, 448
    s_add_u32 s3, s3, s4
    v_lshrrev_b32 v124, 4, v164
    v_lshlrev_b32 v124, 4, v124
    v_add_u32 v124, s3, v124
    v_and_b32 v125, 15, v164
    v_cmp_eq_u32 vcc, 0, v125
    s_nop 4
    s_and_saveexec_b64 s[6:7], vcc

    buffer_store_dwordx4 a[0:3], v124, s[24:27], 0 offen offset:0 sc1
    buffer_store_dwordx4 a[4:7], v124, s[24:27], 0 offen offset:64 sc1
    buffer_store_dwordx4 a[8:11], v124, s[24:27], 0 offen offset:128 sc1
    buffer_store_dwordx4 a[12:15], v124, s[24:27], 0 offen offset:192 sc1
    buffer_store_dwordx4 a[16:19], v124, s[24:27], 0 offen offset:256 sc1
    buffer_store_dwordx4 a[20:23], v124, s[24:27], 0 offen offset:320 sc1
    buffer_store_dwordx4 a[24:27], v124, s[24:27], 0 offen offset:384 sc1
    s_mov_b64 exec, s[6:7]
    s_waitcnt vmcnt(11)
    s_branch L_sequential_preLN__sliding_block__glu_gated_bilinear__prompt_kernel_Cw2_106
L_sequential_preLN__sliding_block__glu_gated_bilinear__prompt_kernel_Cnocs_102:
    s_waitcnt vmcnt(4)
L_sequential_preLN__sliding_block__glu_gated_bilinear__prompt_kernel_Cw2_106:
    s_barrier
    s_mov_b32 s49, 0
    s_mov_b32 s50, 28704
    ds_read_b128 a[0:3], v120 offset:0
    ds_read_b128 a[4:7], v120 offset:256
    ds_read_b128 a[8:11], v120 offset:512
    ds_read_b128 a[12:15], v120 offset:768
    ds_read_b64_tr_b16 a[32:33], v122 offset:0
    ds_read_b64_tr_b16 a[34:35], v122 offset:1792
    ds_read_b64_tr_b16 a[36:37], v122 offset:32
    ds_read_b64_tr_b16 a[38:39], v122 offset:1824
    ds_read_b64_tr_b16 a[40:41], v122 offset:64
    ds_read_b64_tr_b16 a[42:43], v122 offset:1856
    ds_read_b64_tr_b16 a[44:45], v122 offset:14352
    ds_read_b64_tr_b16 a[46:47], v122 offset:16144
    ds_read_b64_tr_b16 a[48:49], v122 offset:14384
    ds_read_b64_tr_b16 a[50:51], v122 offset:16176
    ds_read_b64_tr_b16 a[52:53], v122 offset:14416
    ds_read_b64_tr_b16 a[54:55], v122 offset:16208
    ds_read_b64_tr_b16 a[56:57], v123 offset:0
    ds_read_b64_tr_b16 a[58:59], v123 offset:1792
    s_waitcnt lgkmcnt(0)
    v_mfma_f32_16x16x32_bf16 v[0:3], a[32:35], a[0:3], 0
    ds_read_b128 a[16:19], v121 offset:0
    v_mfma_f32_16x16x32_bf16 v[4:7], a[32:35], a[4:7], 0
    ds_read_b128 a[20:23], v121 offset:256
    v_mfma_f32_16x16x32_bf16 v[8:11], a[32:35], a[8:11], 0
    s_mov_b32 m0, s34
    s_nop 0
    buffer_load_dwordx4 v112, s[8:11], s32 offen offset:0 sc1 lds
    v_mfma_f32_16x16x32_bf16 v[12:15], a[32:35], a[12:15], 0
    ds_read_b128 a[24:27], v121 offset:512
    ds_read_b128 a[28:31], v121 offset:768
    v_mfma_f32_16x16x32_bf16 v[28:31], a[36:39], a[12:15], 0
    ds_read_b64_tr_b16 a[60:61], v122 offset:7168
    v_mfma_f32_16x16x32_bf16 v[24:27], a[36:39], a[8:11], 0
    ds_read_b64_tr_b16 a[62:63], v122 offset:8960
    buffer_load_dwordx4 v112, s[8:11], s32 offen offset:1024 sc1 lds
    v_mfma_f32_16x16x32_bf16 v[20:23], a[36:39], a[4:7], 0
    ds_read_b64_tr_b16 a[64:65], v122 offset:7200
    v_mfma_f32_16x16x32_bf16 v[16:19], a[36:39], a[0:3], 0
    ds_read_b64_tr_b16 a[66:67], v122 offset:8992
    v_mfma_f32_16x16x32_bf16 v[32:35], a[40:43], a[0:3], 0
    ds_read_b64_tr_b16 a[68:69], v122 offset:7232
    v_mfma_f32_16x16x32_bf16 v[36:39], a[40:43], a[4:7], 0
    v_mfma_f32_16x16x32_bf16 v[40:43], a[40:43], a[8:11], 0
    ds_read_b64_tr_b16 a[70:71], v122 offset:9024
    buffer_load_dwordx4 v113, s[8:11], s32 offen offset:2048 sc1 lds
    v_mfma_f32_16x16x32_bf16 v[44:47], a[40:43], a[12:15], 0
    ds_read_b64_tr_b16 a[72:73], v122 offset:21520
    v_mfma_f32_16x16x32_bf16 v[60:63], a[44:47], a[12:15], 0
    ds_read_b64_tr_b16 a[74:75], v122 offset:23312
    v_mfma_f32_16x16x32_bf16 v[56:59], a[44:47], a[8:11], 0
    ds_read_b64_tr_b16 a[76:77], v122 offset:21552
    v_mfma_f32_16x16x32_bf16 v[52:55], a[44:47], a[4:7], 0
    ds_read_b64_tr_b16 a[78:79], v122 offset:23344
    v_mfma_f32_16x16x32_bf16 v[48:51], a[44:47], a[0:3], 0
    ds_read_b64_tr_b16 a[80:81], v122 offset:21584
    buffer_load_dwordx4 v113, s[8:11], s32 offen offset:3072 sc1 lds
    v_mfma_f32_16x16x32_bf16 v[64:67], a[48:51], a[0:3], 0
    ds_read_b64_tr_b16 a[82:83], v122 offset:23376
    v_mfma_f32_16x16x32_bf16 v[68:71], a[48:51], a[4:7], 0
    ds_read_b64_tr_b16 a[84:85], v123 offset:7168
    v_mfma_f32_16x16x32_bf16 v[72:75], a[48:51], a[8:11], 0
    ds_read_b64_tr_b16 a[86:87], v123 offset:8960
    v_mfma_f32_16x16x32_bf16 v[76:79], a[48:51], a[12:15], 0
    v_mfma_f32_16x16x32_bf16 v[92:95], a[52:55], a[12:15], 0
    s_add_u32 s49, s49, 32768
    s_cmp_ge_u32 s49, 98304
    s_cselect_b32 s39, 98304, 0
    v_mfma_f32_16x16x32_bf16 v[88:91], a[52:55], a[8:11], 0
    s_sub_u32 s49, s49, s39
    s_sub_u32 s38, 32768, s39
    v_mfma_f32_16x16x32_bf16 v[84:87], a[52:55], a[4:7], 0
    buffer_load_dword v161, v160, s[92:95], s96 offen
    s_add_u32 s96, s96, 3072
    v_mfma_f32_16x16x32_bf16 v[80:83], a[52:55], a[0:3], 0
    v_add_u32 v120, s38, v120
    v_add_u32 v121, s38, v121
    v_mfma_f32_16x16x32_bf16 v[96:99], a[56:59], a[0:3], 0
    v_add_u32 v122, s50, v122
    v_add_u32 v123, s50, v123
    s_sub_u32 s50, 0, s50
    v_mfma_f32_16x16x32_bf16 v[100:103], a[56:59], a[4:7], 0
    s_add_u32 s51, s51, 1
    s_and_b32 s51, s51, 15
    s_lshl_b32 s32, s51, 14
    v_mfma_f32_16x16x32_bf16 v[104:107], a[56:59], a[8:11], 0
    s_add_u32 s34, s34, 32768
    s_cmp_ge_u32 s34, 98304
    s_cselect_b32 s3, 98304, 0
    s_sub_u32 s34, s34, s3
    v_mfma_f32_16x16x32_bf16 v[108:111], a[56:59], a[12:15], 0
    s_waitcnt vmcnt(5) lgkmcnt(0)
    s_barrier
    v_mfma_f32_16x16x32_bf16 v[0:3], a[60:63], a[16:19], v[0:3]
    ds_read_b128 a[0:3], v120 offset:0
    v_mfma_f32_16x16x32_bf16 v[4:7], a[60:63], a[20:23], v[4:7]
    ds_read_b128 a[4:7], v120 offset:256
    v_mfma_f32_16x16x32_bf16 v[8:11], a[60:63], a[24:27], v[8:11]
    s_add_u32 m0, s35, s53
    s_nop 0
    buffer_load_dwordx4 v116, s[12:15], s33 offen lds
    v_mfma_f32_16x16x32_bf16 v[12:15], a[60:63], a[28:31], v[12:15]
    ds_read_b128 a[8:11], v120 offset:512
    ds_read_b128 a[12:15], v120 offset:768
    v_mfma_f32_16x16x32_bf16 v[28:31], a[64:67], a[28:31], v[28:31]
    ds_read_b64_tr_b16 a[32:33], v122 offset:0
    v_mfma_f32_16x16x32_bf16 v[24:27], a[64:67], a[24:27], v[24:27]
    s_add_u32 m0, s35, s54
    s_nop 0
    buffer_load_dwordx4 v117, s[20:23], s33 offen lds
    v_mfma_f32_16x16x32_bf16 v[20:23], a[64:67], a[20:23], v[20:23]
    ds_read_b64_tr_b16 a[34:35], v122 offset:1792
    ds_read_b64_tr_b16 a[36:37], v122 offset:32
    v_mfma_f32_16x16x32_bf16 v[16:19], a[64:67], a[16:19], v[16:19]
    ds_read_b64_tr_b16 a[38:39], v122 offset:1824
    v_mfma_f32_16x16x32_bf16 v[32:35], a[68:71], a[16:19], v[32:35]
    ds_read_b64_tr_b16 a[40:41], v122 offset:64
    v_mfma_f32_16x16x32_bf16 v[36:39], a[68:71], a[20:23], v[36:39]
    s_add_u32 m0, s35, s55
    s_nop 0
    buffer_load_dwordx4 v118, s[16:19], s33 offen lds
    v_mfma_f32_16x16x32_bf16 v[40:43], a[68:71], a[24:27], v[40:43]
    ds_read_b64_tr_b16 a[42:43], v122 offset:1856
    v_mfma_f32_16x16x32_bf16 v[44:47], a[68:71], a[28:31], v[44:47]
    ds_read_b64_tr_b16 a[44:45], v122 offset:14352
    v_mfma_f32_16x16x32_bf16 v[60:63], a[72:75], a[28:31], v[60:63]
    ds_read_b64_tr_b16 a[46:47], v122 offset:16144
    v_mfma_f32_16x16x32_bf16 v[56:59], a[72:75], a[24:27], v[56:59]
    s_cmp_ge_u32 s40, 4
    s_cbranch_scc1 L_sequential_preLN__sliding_block__glu_gated_bilinear__prompt_kernel_Cskip_107
    s_add_u32 m0, s35, s56
    s_nop 0
    buffer_load_dwordx4 v119, s[16:19], s33 offen lds
L_sequential_preLN__sliding_block__glu_gated_bilinear__prompt_kernel_Cskip_107:
    v_mfma_f32_16x16x32_bf16 v[52:55], a[72:75], a[20:23], v[52:55]
    ds_read_b64_tr_b16 a[48:49], v122 offset:14384
    ds_read_b64_tr_b16 a[50:51], v122 offset:16176
    v_mfma_f32_16x16x32_bf16 v[48:51], a[72:75], a[16:19], v[48:51]
    ds_read_b64_tr_b16 a[52:53], v122 offset:14416
    v_mfma_f32_16x16x32_bf16 v[64:67], a[76:79], a[16:19], v[64:67]
    ds_read_b64_tr_b16 a[54:55], v122 offset:16208
    v_mfma_f32_16x16x32_bf16 v[68:71], a[76:79], a[20:23], v[68:71]
    ds_read_b64_tr_b16 a[56:57], v123 offset:0
    v_mfma_f32_16x16x32_bf16 v[72:75], a[76:79], a[24:27], v[72:75]
    ds_read_b64_tr_b16 a[58:59], v123 offset:1792
    v_mfma_f32_16x16x32_bf16 v[76:79], a[76:79], a[28:31], v[76:79]
    v_mfma_f32_16x16x32_bf16 v[92:95], a[80:83], a[28:31], v[92:95]
    v_mfma_f32_16x16x32_bf16 v[88:91], a[80:83], a[24:27], v[88:91]
    v_mfma_f32_16x16x32_bf16 v[84:87], a[80:83], a[20:23], v[84:87]
    v_mfma_f32_16x16x32_bf16 v[80:83], a[80:83], a[16:19], v[80:83]
    v_mfma_f32_16x16x32_bf16 v[96:99], a[84:87], a[16:19], v[96:99]
    s_add_u32 s52, s52, 1
    s_and_b32 s52, s52, 15
    s_mul_i32 s33, s52, 458752
    v_mfma_f32_16x16x32_bf16 v[100:103], a[84:87], a[20:23], v[100:103]
    s_add_u32 s35, s35, s36
    s_sub_u32 s36, 0, s36
    v_mfma_f32_16x16x32_bf16 v[104:107], a[84:87], a[24:27], v[104:107]
    v_mfma_f32_16x16x32_bf16 v[108:111], a[84:87], a[28:31], v[108:111]
    s_waitcnt lgkmcnt(0)
    s_mov_b32 s37, 1
L_sequential_preLN__sliding_block__glu_gated_bilinear__prompt_kernel_Cloop_108:

    s_cmp_eq_u32 s37, 1
    s_cbranch_scc0 L_sequential_preLN__sliding_block__glu_gated_bilinear__prompt_kernel_Cnoflag_109
    s_cmp_eq_u32 s40, 6
    s_cbranch_scc0 L_sequential_preLN__sliding_block__glu_gated_bilinear__prompt_kernel_Cnoflag_109
    s_lshl_b32 s3, s44, 12
    s_lshl_b32 s4, s43, 7
    s_add_u32 s3, s3, s4
    s_add_u32 s57, s3, 327680

    v_mov_b32 v136, s57
    v_mov_b32 v137, s62
    s_mov_b64 exec, 1
    buffer_store_dword v137, v136, s[28:31], 0 offen sc1
    s_mov_b64 exec, -1

L_sequential_preLN__sliding_block__glu_gated_bilinear__prompt_kernel_Cnoflag_109:
    v_mfma_f32_16x16x32_bf16 v[0:3], a[32:35], a[0:3], v[0:3]
    ds_read_b128 a[16:19], v121 offset:0
    v_mfma_f32_16x16x32_bf16 v[4:7], a[32:35], a[4:7], v[4:7]
    ds_read_b128 a[20:23], v121 offset:256
    v_mfma_f32_16x16x32_bf16 v[8:11], a[32:35], a[8:11], v[8:11]
    s_mov_b32 m0, s34
    s_nop 0
    buffer_load_dwordx4 v112, s[8:11], s32 offen offset:0 sc1 lds
    v_mfma_f32_16x16x32_bf16 v[12:15], a[32:35], a[12:15], v[12:15]
    ds_read_b128 a[24:27], v121 offset:512
    ds_read_b128 a[28:31], v121 offset:768
    v_mfma_f32_16x16x32_bf16 v[28:31], a[36:39], a[12:15], v[28:31]
    ds_read_b64_tr_b16 a[60:61], v122 offset:7168
    v_mfma_f32_16x16x32_bf16 v[24:27], a[36:39], a[8:11], v[24:27]
    ds_read_b64_tr_b16 a[62:63], v122 offset:8960
    buffer_load_dwordx4 v112, s[8:11], s32 offen offset:1024 sc1 lds
    v_mfma_f32_16x16x32_bf16 v[20:23], a[36:39], a[4:7], v[20:23]
    ds_read_b64_tr_b16 a[64:65], v122 offset:7200
    v_mfma_f32_16x16x32_bf16 v[16:19], a[36:39], a[0:3], v[16:19]
    ds_read_b64_tr_b16 a[66:67], v122 offset:8992
    v_mfma_f32_16x16x32_bf16 v[32:35], a[40:43], a[0:3], v[32:35]
    ds_read_b64_tr_b16 a[68:69], v122 offset:7232
    v_mfma_f32_16x16x32_bf16 v[36:39], a[40:43], a[4:7], v[36:39]
    v_mfma_f32_16x16x32_bf16 v[40:43], a[40:43], a[8:11], v[40:43]
    ds_read_b64_tr_b16 a[70:71], v122 offset:9024
    buffer_load_dwordx4 v113, s[8:11], s32 offen offset:2048 sc1 lds
    v_mfma_f32_16x16x32_bf16 v[44:47], a[40:43], a[12:15], v[44:47]
    ds_read_b64_tr_b16 a[72:73], v122 offset:21520
    v_mfma_f32_16x16x32_bf16 v[60:63], a[44:47], a[12:15], v[60:63]
    ds_read_b64_tr_b16 a[74:75], v122 offset:23312
    v_mfma_f32_16x16x32_bf16 v[56:59], a[44:47], a[8:11], v[56:59]
    ds_read_b64_tr_b16 a[76:77], v122 offset:21552
    v_mfma_f32_16x16x32_bf16 v[52:55], a[44:47], a[4:7], v[52:55]
    ds_read_b64_tr_b16 a[78:79], v122 offset:23344
    v_mfma_f32_16x16x32_bf16 v[48:51], a[44:47], a[0:3], v[48:51]
    ds_read_b64_tr_b16 a[80:81], v122 offset:21584
    buffer_load_dwordx4 v113, s[8:11], s32 offen offset:3072 sc1 lds
    v_mfma_f32_16x16x32_bf16 v[64:67], a[48:51], a[0:3], v[64:67]
    ds_read_b64_tr_b16 a[82:83], v122 offset:23376
    v_mfma_f32_16x16x32_bf16 v[68:71], a[48:51], a[4:7], v[68:71]
    ds_read_b64_tr_b16 a[84:85], v123 offset:7168
    v_mfma_f32_16x16x32_bf16 v[72:75], a[48:51], a[8:11], v[72:75]
    ds_read_b64_tr_b16 a[86:87], v123 offset:8960
    v_mfma_f32_16x16x32_bf16 v[76:79], a[48:51], a[12:15], v[76:79]
    v_mfma_f32_16x16x32_bf16 v[92:95], a[52:55], a[12:15], v[92:95]
    s_add_u32 s49, s49, 32768
    s_cmp_ge_u32 s49, 98304
    s_cselect_b32 s39, 98304, 0
    v_mfma_f32_16x16x32_bf16 v[88:91], a[52:55], a[8:11], v[88:91]
    s_sub_u32 s49, s49, s39
    s_sub_u32 s38, 32768, s39
    v_mfma_f32_16x16x32_bf16 v[84:87], a[52:55], a[4:7], v[84:87]
    buffer_load_dword v161, v160, s[92:95], s96 offen
    s_add_u32 s96, s96, 3072
    v_mfma_f32_16x16x32_bf16 v[80:83], a[52:55], a[0:3], v[80:83]
    v_add_u32 v120, s38, v120
    v_add_u32 v121, s38, v121
    v_mfma_f32_16x16x32_bf16 v[96:99], a[56:59], a[0:3], v[96:99]
    v_add_u32 v122, s50, v122
    v_add_u32 v123, s50, v123
    s_sub_u32 s50, 0, s50
    v_mfma_f32_16x16x32_bf16 v[100:103], a[56:59], a[4:7], v[100:103]
    s_add_u32 s51, s51, 1
    s_and_b32 s51, s51, 15
    s_lshl_b32 s32, s51, 14
    v_mfma_f32_16x16x32_bf16 v[104:107], a[56:59], a[8:11], v[104:107]
    s_add_u32 s34, s34, 32768
    s_cmp_ge_u32 s34, 98304
    s_cselect_b32 s3, 98304, 0
    s_sub_u32 s34, s34, s3
    v_mfma_f32_16x16x32_bf16 v[108:111], a[56:59], a[12:15], v[108:111]
    s_waitcnt vmcnt(5) lgkmcnt(0)
    s_barrier
    v_mfma_f32_16x16x32_bf16 v[0:3], a[60:63], a[16:19], v[0:3]
    ds_read_b128 a[0:3], v120 offset:0
    v_mfma_f32_16x16x32_bf16 v[4:7], a[60:63], a[20:23], v[4:7]
    ds_read_b128 a[4:7], v120 offset:256
    v_mfma_f32_16x16x32_bf16 v[8:11], a[60:63], a[24:27], v[8:11]
    s_add_u32 m0, s35, s53
    s_nop 0
    buffer_load_dwordx4 v116, s[12:15], s33 offen lds
    v_mfma_f32_16x16x32_bf16 v[12:15], a[60:63], a[28:31], v[12:15]
    ds_read_b128 a[8:11], v120 offset:512
    ds_read_b128 a[12:15], v120 offset:768
    v_mfma_f32_16x16x32_bf16 v[28:31], a[64:67], a[28:31], v[28:31]
    ds_read_b64_tr_b16 a[32:33], v122 offset:0
    v_mfma_f32_16x16x32_bf16 v[24:27], a[64:67], a[24:27], v[24:27]
    s_add_u32 m0, s35, s54
    s_nop 0
    buffer_load_dwordx4 v117, s[20:23], s33 offen lds
    v_mfma_f32_16x16x32_bf16 v[20:23], a[64:67], a[20:23], v[20:23]
    ds_read_b64_tr_b16 a[34:35], v122 offset:1792
    ds_read_b64_tr_b16 a[36:37], v122 offset:32
    v_mfma_f32_16x16x32_bf16 v[16:19], a[64:67], a[16:19], v[16:19]
    ds_read_b64_tr_b16 a[38:39], v122 offset:1824
    v_mfma_f32_16x16x32_bf16 v[32:35], a[68:71], a[16:19], v[32:35]
    ds_read_b64_tr_b16 a[40:41], v122 offset:64
    v_mfma_f32_16x16x32_bf16 v[36:39], a[68:71], a[20:23], v[36:39]
    s_add_u32 m0, s35, s55
    s_nop 0
    buffer_load_dwordx4 v118, s[16:19], s33 offen lds
    v_mfma_f32_16x16x32_bf16 v[40:43], a[68:71], a[24:27], v[40:43]
    ds_read_b64_tr_b16 a[42:43], v122 offset:1856
    v_mfma_f32_16x16x32_bf16 v[44:47], a[68:71], a[28:31], v[44:47]
    ds_read_b64_tr_b16 a[44:45], v122 offset:14352
    v_mfma_f32_16x16x32_bf16 v[60:63], a[72:75], a[28:31], v[60:63]
    ds_read_b64_tr_b16 a[46:47], v122 offset:16144
    v_mfma_f32_16x16x32_bf16 v[56:59], a[72:75], a[24:27], v[56:59]
    s_cmp_ge_u32 s40, 4
    s_cbranch_scc1 L_sequential_preLN__sliding_block__glu_gated_bilinear__prompt_kernel_Cskip_110
    s_add_u32 m0, s35, s56
    s_nop 0
    buffer_load_dwordx4 v119, s[16:19], s33 offen lds
L_sequential_preLN__sliding_block__glu_gated_bilinear__prompt_kernel_Cskip_110:
    v_mfma_f32_16x16x32_bf16 v[52:55], a[72:75], a[20:23], v[52:55]
    ds_read_b64_tr_b16 a[48:49], v122 offset:14384
    ds_read_b64_tr_b16 a[50:51], v122 offset:16176
    v_mfma_f32_16x16x32_bf16 v[48:51], a[72:75], a[16:19], v[48:51]
    ds_read_b64_tr_b16 a[52:53], v122 offset:14416
    v_mfma_f32_16x16x32_bf16 v[64:67], a[76:79], a[16:19], v[64:67]
    ds_read_b64_tr_b16 a[54:55], v122 offset:16208
    v_mfma_f32_16x16x32_bf16 v[68:71], a[76:79], a[20:23], v[68:71]
    ds_read_b64_tr_b16 a[56:57], v123 offset:0
    v_mfma_f32_16x16x32_bf16 v[72:75], a[76:79], a[24:27], v[72:75]
    ds_read_b64_tr_b16 a[58:59], v123 offset:1792
    v_mfma_f32_16x16x32_bf16 v[76:79], a[76:79], a[28:31], v[76:79]
    v_mfma_f32_16x16x32_bf16 v[92:95], a[80:83], a[28:31], v[92:95]
    v_mfma_f32_16x16x32_bf16 v[88:91], a[80:83], a[24:27], v[88:91]
    v_mfma_f32_16x16x32_bf16 v[84:87], a[80:83], a[20:23], v[84:87]
    v_mfma_f32_16x16x32_bf16 v[80:83], a[80:83], a[16:19], v[80:83]
    v_mfma_f32_16x16x32_bf16 v[96:99], a[84:87], a[16:19], v[96:99]
    s_add_u32 s52, s52, 1
    s_and_b32 s52, s52, 15
    s_mul_i32 s33, s52, 458752
    v_mfma_f32_16x16x32_bf16 v[100:103], a[84:87], a[20:23], v[100:103]
    s_add_u32 s35, s35, s36
    s_sub_u32 s36, 0, s36
    v_mfma_f32_16x16x32_bf16 v[104:107], a[84:87], a[24:27], v[104:107]
    v_mfma_f32_16x16x32_bf16 v[108:111], a[84:87], a[28:31], v[108:111]
    s_waitcnt lgkmcnt(0)
    s_add_u32 s37, s37, 1
    s_cmp_lt_u32 s37, 13
    s_cbranch_scc1 L_sequential_preLN__sliding_block__glu_gated_bilinear__prompt_kernel_Cloop_108
    s_add_u32 s24, s82, 46727168
    s_addc_u32 s25, s83, 0
    s_mov_b32 s26, 229376
    s_mov_b32 s27, 0x20000

    s_cmp_lt_u32 s40, 4
    s_cbranch_scc0 L_sequential_preLN__sliding_block__glu_gated_bilinear__prompt_kernel_Cg1_113
    s_lshl_b32 s3, s44, 12
    s_add_u32 s57, s3, 327680
    v_lshlrev_b32 v124, 7, v164
    v_add_u32 v124, s57, v124
    s_mov_b64 s[58:59], 0xff
    v_mov_b32 v136, 0x7fff0000
    v_cndmask_b32 v124, v136, v124, s[58:59]
    buffer_load_dword v136, v124, s[28:31], 0 offen sc1
L_sequential_preLN__sliding_block__glu_gated_bilinear__prompt_kernel_Cg1_113:

    v_mfma_f32_16x16x32_bf16 v[0:3], a[32:35], a[0:3], v[0:3]
    ds_read_b128 a[16:19], v121 offset:0
    v_mfma_f32_16x16x32_bf16 v[4:7], a[32:35], a[4:7], v[4:7]
    ds_read_b128 a[20:23], v121 offset:256
    v_mfma_f32_16x16x32_bf16 v[8:11], a[32:35], a[8:11], v[8:11]
    s_mov_b32 m0, s34
    s_nop 0
    buffer_load_dwordx4 v112, s[8:11], s32 offen offset:0 sc1 lds
    v_mfma_f32_16x16x32_bf16 v[12:15], a[32:35], a[12:15], v[12:15]
    ds_read_b128 a[24:27], v121 offset:512
    ds_read_b128 a[28:31], v121 offset:768
    v_mfma_f32_16x16x32_bf16 v[28:31], a[36:39], a[12:15], v[28:31]
    ds_read_b64_tr_b16 a[60:61], v122 offset:7168
    v_mfma_f32_16x16x32_bf16 v[24:27], a[36:39], a[8:11], v[24:27]
    ds_read_b64_tr_b16 a[62:63], v122 offset:8960
    buffer_load_dwordx4 v112, s[8:11], s32 offen offset:1024 sc1 lds
    v_mfma_f32_16x16x32_bf16 v[20:23], a[36:39], a[4:7], v[20:23]
    ds_read_b64_tr_b16 a[64:65], v122 offset:7200
    v_mfma_f32_16x16x32_bf16 v[16:19], a[36:39], a[0:3], v[16:19]
    ds_read_b64_tr_b16 a[66:67], v122 offset:8992
    v_mfma_f32_16x16x32_bf16 v[32:35], a[40:43], a[0:3], v[32:35]
    ds_read_b64_tr_b16 a[68:69], v122 offset:7232
    v_mfma_f32_16x16x32_bf16 v[36:39], a[40:43], a[4:7], v[36:39]
    v_mfma_f32_16x16x32_bf16 v[40:43], a[40:43], a[8:11], v[40:43]
    ds_read_b64_tr_b16 a[70:71], v122 offset:9024
    buffer_load_dwordx4 v113, s[8:11], s32 offen offset:2048 sc1 lds
    v_mfma_f32_16x16x32_bf16 v[44:47], a[40:43], a[12:15], v[44:47]
    ds_read_b64_tr_b16 a[72:73], v122 offset:21520
    v_mfma_f32_16x16x32_bf16 v[60:63], a[44:47], a[12:15], v[60:63]
    ds_read_b64_tr_b16 a[74:75], v122 offset:23312
    v_mfma_f32_16x16x32_bf16 v[56:59], a[44:47], a[8:11], v[56:59]
    ds_read_b64_tr_b16 a[76:77], v122 offset:21552
    v_mfma_f32_16x16x32_bf16 v[52:55], a[44:47], a[4:7], v[52:55]
    ds_read_b64_tr_b16 a[78:79], v122 offset:23344
    v_mfma_f32_16x16x32_bf16 v[48:51], a[44:47], a[0:3], v[48:51]
    ds_read_b64_tr_b16 a[80:81], v122 offset:21584
    buffer_load_dwordx4 v113, s[8:11], s32 offen offset:3072 sc1 lds
    v_mfma_f32_16x16x32_bf16 v[64:67], a[48:51], a[0:3], v[64:67]
    ds_read_b64_tr_b16 a[82:83], v122 offset:23376
    v_mfma_f32_16x16x32_bf16 v[68:71], a[48:51], a[4:7], v[68:71]
    ds_read_b64_tr_b16 a[84:85], v123 offset:7168
    v_mfma_f32_16x16x32_bf16 v[72:75], a[48:51], a[8:11], v[72:75]
    ds_read_b64_tr_b16 a[86:87], v123 offset:8960
    v_mfma_f32_16x16x32_bf16 v[76:79], a[48:51], a[12:15], v[76:79]
    v_mfma_f32_16x16x32_bf16 v[92:95], a[52:55], a[12:15], v[92:95]
    s_add_u32 s49, s49, 32768
    s_cmp_ge_u32 s49, 98304
    s_cselect_b32 s39, 98304, 0
    v_mfma_f32_16x16x32_bf16 v[88:91], a[52:55], a[8:11], v[88:91]
    s_sub_u32 s49, s49, s39
    s_sub_u32 s38, 32768, s39
    v_mfma_f32_16x16x32_bf16 v[84:87], a[52:55], a[4:7], v[84:87]
    buffer_load_dword v161, v160, s[92:95], s96 offen
    s_add_u32 s96, s96, 3072
    v_mfma_f32_16x16x32_bf16 v[80:83], a[52:55], a[0:3], v[80:83]
    v_add_u32 v120, s38, v120
    v_add_u32 v121, s38, v121
    v_mfma_f32_16x16x32_bf16 v[96:99], a[56:59], a[0:3], v[96:99]
    v_add_u32 v122, s50, v122
    v_add_u32 v123, s50, v123
    s_sub_u32 s50, 0, s50
    v_mfma_f32_16x16x32_bf16 v[100:103], a[56:59], a[4:7], v[100:103]
    s_add_u32 s51, s51, 1
    s_and_b32 s51, s51, 15
    s_lshl_b32 s32, s51, 14
    v_mfma_f32_16x16x32_bf16 v[104:107], a[56:59], a[8:11], v[104:107]
    s_add_u32 s34, s34, 32768
    s_cmp_ge_u32 s34, 98304
    s_cselect_b32 s3, 98304, 0
    s_sub_u32 s34, s34, s3
    v_mfma_f32_16x16x32_bf16 v[108:111], a[56:59], a[12:15], v[108:111]
    s_waitcnt vmcnt(5) lgkmcnt(0)
    s_barrier
    v_mfma_f32_16x16x32_bf16 v[0:3], a[60:63], a[16:19], v[0:3]
    ds_read_b128 a[0:3], v120 offset:0
    v_mfma_f32_16x16x32_bf16 v[4:7], a[60:63], a[20:23], v[4:7]
    ds_read_b128 a[4:7], v120 offset:256
    v_mfma_f32_16x16x32_bf16 v[8:11], a[60:63], a[24:27], v[8:11]
    s_add_u32 m0, s35, s53
    s_nop 0
    buffer_load_dwordx4 v116, s[12:15], s33 offen lds
    v_mfma_f32_16x16x32_bf16 v[12:15], a[60:63], a[28:31], v[12:15]
    ds_read_b128 a[8:11], v120 offset:512
    ds_read_b128 a[12:15], v120 offset:768
    v_mfma_f32_16x16x32_bf16 v[28:31], a[64:67], a[28:31], v[28:31]
    ds_read_b64_tr_b16 a[32:33], v122 offset:0
    v_mfma_f32_16x16x32_bf16 v[24:27], a[64:67], a[24:27], v[24:27]
    s_add_u32 m0, s35, s54
    s_nop 0
    buffer_load_dwordx4 v117, s[20:23], s33 offen lds
    v_mfma_f32_16x16x32_bf16 v[20:23], a[64:67], a[20:23], v[20:23]
    ds_read_b64_tr_b16 a[34:35], v122 offset:1792
    ds_read_b64_tr_b16 a[36:37], v122 offset:32
    v_mfma_f32_16x16x32_bf16 v[16:19], a[64:67], a[16:19], v[16:19]
    ds_read_b64_tr_b16 a[38:39], v122 offset:1824
    v_mfma_f32_16x16x32_bf16 v[32:35], a[68:71], a[16:19], v[32:35]
    ds_read_b64_tr_b16 a[40:41], v122 offset:64
    v_mfma_f32_16x16x32_bf16 v[36:39], a[68:71], a[20:23], v[36:39]
    s_add_u32 m0, s35, s55
    s_nop 0
    buffer_load_dwordx4 v118, s[16:19], s33 offen lds
    v_mfma_f32_16x16x32_bf16 v[40:43], a[68:71], a[24:27], v[40:43]
    ds_read_b64_tr_b16 a[42:43], v122 offset:1856
    v_mfma_f32_16x16x32_bf16 v[44:47], a[68:71], a[28:31], v[44:47]
    ds_read_b64_tr_b16 a[44:45], v122 offset:14352
    v_mfma_f32_16x16x32_bf16 v[60:63], a[72:75], a[28:31], v[60:63]
    ds_read_b64_tr_b16 a[46:47], v122 offset:16144
    v_mfma_f32_16x16x32_bf16 v[56:59], a[72:75], a[24:27], v[56:59]
    s_cmp_ge_u32 s40, 4
    s_cbranch_scc1 L_sequential_preLN__sliding_block__glu_gated_bilinear__prompt_kernel_Cskip_118
    s_add_u32 m0, s35, s56
    s_nop 0
    buffer_load_dwordx4 v119, s[16:19], s33 offen lds
L_sequential_preLN__sliding_block__glu_gated_bilinear__prompt_kernel_Cskip_118:
    v_mfma_f32_16x16x32_bf16 v[52:55], a[72:75], a[20:23], v[52:55]
    ds_read_b64_tr_b16 a[48:49], v122 offset:14384
    ds_read_b64_tr_b16 a[50:51], v122 offset:16176
    v_mfma_f32_16x16x32_bf16 v[48:51], a[72:75], a[16:19], v[48:51]
    ds_read_b64_tr_b16 a[52:53], v122 offset:14416
    v_mfma_f32_16x16x32_bf16 v[64:67], a[76:79], a[16:19], v[64:67]
    ds_read_b64_tr_b16 a[54:55], v122 offset:16208
    v_mfma_f32_16x16x32_bf16 v[68:71], a[76:79], a[20:23], v[68:71]
    ds_read_b64_tr_b16 a[56:57], v123 offset:0
    v_mfma_f32_16x16x32_bf16 v[72:75], a[76:79], a[24:27], v[72:75]
    ds_read_b64_tr_b16 a[58:59], v123 offset:1792
    v_mfma_f32_16x16x32_bf16 v[76:79], a[76:79], a[28:31], v[76:79]
    v_mfma_f32_16x16x32_bf16 v[92:95], a[80:83], a[28:31], v[92:95]
    v_mfma_f32_16x16x32_bf16 v[88:91], a[80:83], a[24:27], v[88:91]
    v_mfma_f32_16x16x32_bf16 v[84:87], a[80:83], a[20:23], v[84:87]
    v_mfma_f32_16x16x32_bf16 v[80:83], a[80:83], a[16:19], v[80:83]
    v_mfma_f32_16x16x32_bf16 v[96:99], a[84:87], a[16:19], v[96:99]
    s_add_u32 s52, s52, 1
    s_and_b32 s52, s52, 15
    s_mul_i32 s33, s52, 458752
    v_mfma_f32_16x16x32_bf16 v[100:103], a[84:87], a[20:23], v[100:103]
    s_add_u32 s35, s35, s36
    s_sub_u32 s36, 0, s36
    v_mfma_f32_16x16x32_bf16 v[104:107], a[84:87], a[24:27], v[104:107]
    v_mfma_f32_16x16x32_bf16 v[108:111], a[84:87], a[28:31], v[108:111]
    s_waitcnt lgkmcnt(0)

    s_cmp_lt_u32 s40, 4
    s_cbranch_scc0 L_sequential_preLN__sliding_block__glu_gated_bilinear__prompt_kernel_Cg2_114
    s_mov_b32 s63, 0
    s_mov_b64 s[58:59], 0xff
L_sequential_preLN__sliding_block__glu_gated_bilinear__prompt_kernel_Cgre_111:
    v_cmp_eq_u32 vcc, s62, v136
    s_nop 1
    s_and_b64 s[6:7], vcc, s[58:59]
    s_cmp_eq_u64 s[6:7], s[58:59]
    s_cbranch_scc1 L_sequential_preLN__sliding_block__glu_gated_bilinear__prompt_kernel_Cgok_112
    buffer_load_dword v136, v124, s[28:31], 0 offen sc1
    s_waitcnt vmcnt(0)
    s_add_u32 s63, s63, 1
    s_cmp_lt_u32 s63, 40000
    s_cbranch_scc1 L_sequential_preLN__sliding_block__glu_gated_bilinear__prompt_kernel_Cgre_111
L_sequential_preLN__sliding_block__glu_gated_bilinear__prompt_kernel_Cgok_112:
    v_and_b32 v124, 15, v164
    s_lshl_b32 s3, s40, 4
    v_add_u32 v124, s3, v124
    v_min_u32 v124, 55, v124
    v_lshrrev_b32 v125, 4, v164
    v_mul_u32_u24 v125, 1792, v125
    v_lshl_add_u32 v125, v124, 4, v125
    s_mul_i32 s3, s44, 7168
    v_add_u32 v125, s3, v125
    v_lshlrev_b32 v127, 4, v124
    v_add_u32 v127, 157760, v127
    buffer_load_dwordx4 v[136:139], v125, s[24:27], 0 offen sc1
    buffer_load_dwordx4 v[140:143], v125, s[24:27], 0 offen offset:896 sc1
    s_branch L_sequential_preLN__sliding_block__glu_gated_bilinear__prompt_kernel_Cg2b_116
L_sequential_preLN__sliding_block__glu_gated_bilinear__prompt_kernel_Cg2_114:
    s_sub_u32 s3, s40, 4
    s_lshl_b32 s3, s3, 6
    s_add_u32 s3, s3, s45
    v_add_u32 v124, s3, v164
    v_lshlrev_b32 v124, 3, v124

    s_add_u32 s24, s82, 46465024
    s_addc_u32 s25, s83, 0
    s_mov_b32 s26, 262144
    s_mov_b32 s27, 0x20000
    s_mov_b32 s3, 0
    buffer_load_dwordx2 v[128:129], v124, s[24:27], s3 offen sc1
    s_mov_b32 s3, 16384
    buffer_load_dwordx2 v[130:131], v124, s[24:27], s3 offen sc1
    s_mov_b32 s3, 32768
    buffer_load_dwordx2 v[132:133], v124, s[24:27], s3 offen sc1
    s_mov_b32 s3, 49152
    buffer_load_dwordx2 v[134:135], v124, s[24:27], s3 offen sc1
    s_mov_b32 s3, 65536
    buffer_load_dwordx2 v[136:137], v124, s[24:27], s3 offen sc1
    s_mov_b32 s3, 81920
    buffer_load_dwordx2 v[138:139], v124, s[24:27], s3 offen sc1
    s_mov_b32 s3, 98304
    buffer_load_dwordx2 v[140:141], v124, s[24:27], s3 offen sc1
    s_mov_b32 s3, 114688
    buffer_load_dwordx2 v[142:143], v124, s[24:27], s3 offen sc1
    s_mov_b32 s3, 131072
    buffer_load_dwordx2 v[144:145], v124, s[24:27], s3 offen sc1
    s_mov_b32 s3, 147456
    buffer_load_dwordx2 v[146:147], v124, s[24:27], s3 offen sc1
    s_mov_b32 s3, 163840
    buffer_load_dwordx2 v[148:149], v124, s[24:27], s3 offen sc1
    s_mov_b32 s3, 180224
    buffer_load_dwordx2 v[150:151], v124, s[24:27], s3 offen sc1
    s_mov_b32 s3, 196608
    buffer_load_dwordx2 v[152:153], v124, s[24:27], s3 offen sc1
    s_mov_b32 s3, 212992
    buffer_load_dwordx2 v[154:155], v124, s[24:27], s3 offen sc1
    s_mov_b32 s3, 229376
    buffer_load_dwordx2 v[156:157], v124, s[24:27], s3 offen sc1
    s_mov_b32 s3, 245760
    buffer_load_dwordx2 v[158:159], v124, s[24:27], s3 offen sc1
L_sequential_preLN__sliding_block__glu_gated_bilinear__prompt_kernel_Cg2b_116:
    v_mfma_f32_16x16x32_bf16 v[0:3], a[32:35], a[0:3], v[0:3]
    ds_read_b128 a[16:19], v121 offset:0
    v_mfma_f32_16x16x32_bf16 v[4:7], a[32:35], a[4:7], v[4:7]
    ds_read_b128 a[20:23], v121 offset:256
    v_mfma_f32_16x16x32_bf16 v[8:11], a[32:35], a[8:11], v[8:11]
    ds_read_b128 a[24:27], v121 offset:512
    v_mfma_f32_16x16x32_bf16 v[12:15], a[32:35], a[12:15], v[12:15]
    ds_read_b128 a[28:31], v121 offset:768
    v_mfma_f32_16x16x32_bf16 v[28:31], a[36:39], a[12:15], v[28:31]
    ds_read_b64_tr_b16 a[60:61], v122 offset:7168
    v_mfma_f32_16x16x32_bf16 v[24:27], a[36:39], a[8:11], v[24:27]
    ds_read_b64_tr_b16 a[62:63], v122 offset:8960
    v_mfma_f32_16x16x32_bf16 v[20:23], a[36:39], a[4:7], v[20:23]
    ds_read_b64_tr_b16 a[64:65], v122 offset:7200
    v_mfma_f32_16x16x32_bf16 v[16:19], a[36:39], a[0:3], v[16:19]
    ds_read_b64_tr_b16 a[66:67], v122 offset:8992
    v_mfma_f32_16x16x32_bf16 v[32:35], a[40:43], a[0:3], v[32:35]
    ds_read_b64_tr_b16 a[68:69], v122 offset:7232
    v_mfma_f32_16x16x32_bf16 v[36:39], a[40:43], a[4:7], v[36:39]
    v_mfma_f32_16x16x32_bf16 v[40:43], a[40:43], a[8:11], v[40:43]
    ds_read_b64_tr_b16 a[70:71], v122 offset:9024
    v_mfma_f32_16x16x32_bf16 v[44:47], a[40:43], a[12:15], v[44:47]
    ds_read_b64_tr_b16 a[72:73], v122 offset:21520
    v_mfma_f32_16x16x32_bf16 v[60:63], a[44:47], a[12:15], v[60:63]
    ds_read_b64_tr_b16 a[74:75], v122 offset:23312
    v_mfma_f32_16x16x32_bf16 v[56:59], a[44:47], a[8:11], v[56:59]
    ds_read_b64_tr_b16 a[76:77], v122 offset:21552
    v_mfma_f32_16x16x32_bf16 v[52:55], a[44:47], a[4:7], v[52:55]
    ds_read_b64_tr_b16 a[78:79], v122 offset:23344
    v_mfma_f32_16x16x32_bf16 v[48:51], a[44:47], a[0:3], v[48:51]
    ds_read_b64_tr_b16 a[80:81], v122 offset:21584
    v_mfma_f32_16x16x32_bf16 v[64:67], a[48:51], a[0:3], v[64:67]
    ds_read_b64_tr_b16 a[82:83], v122 offset:23376
    v_mfma_f32_16x16x32_bf16 v[68:71], a[48:51], a[4:7], v[68:71]
    ds_read_b64_tr_b16 a[84:85], v123 offset:7168
    v_mfma_f32_16x16x32_bf16 v[72:75], a[48:51], a[8:11], v[72:75]
    ds_read_b64_tr_b16 a[86:87], v123 offset:8960
    v_mfma_f32_16x16x32_bf16 v[76:79], a[48:51], a[12:15], v[76:79]
    v_mfma_f32_16x16x32_bf16 v[92:95], a[52:55], a[12:15], v[92:95]
    s_add_u32 s49, s49, 32768
    s_cmp_ge_u32 s49, 98304
    s_cselect_b32 s39, 98304, 0
    v_mfma_f32_16x16x32_bf16 v[88:91], a[52:55], a[8:11], v[88:91]
    s_sub_u32 s49, s49, s39
    s_sub_u32 s38, 32768, s39
    v_mfma_f32_16x16x32_bf16 v[84:87], a[52:55], a[4:7], v[84:87]
    v_add_u32 v120, s38, v120
    v_add_u32 v121, s38, v121
    v_mfma_f32_16x16x32_bf16 v[80:83], a[52:55], a[0:3], v[80:83]
    v_add_u32 v122, s50, v122
    v_add_u32 v123, s50, v123
    v_mfma_f32_16x16x32_bf16 v[96:99], a[56:59], a[0:3], v[96:99]
    s_sub_u32 s50, 0, s50
    v_mfma_f32_16x16x32_bf16 v[100:103], a[56:59], a[4:7], v[100:103]
    v_mfma_f32_16x16x32_bf16 v[104:107], a[56:59], a[8:11], v[104:107]
    v_mfma_f32_16x16x32_bf16 v[108:111], a[56:59], a[12:15], v[108:111]
    s_waitcnt vmcnt(0) lgkmcnt(0)
    s_barrier
    v_mfma_f32_16x16x32_bf16 v[0:3], a[60:63], a[16:19], v[0:3]
    ds_read_b128 a[0:3], v120 offset:0
    v_mfma_f32_16x16x32_bf16 v[4:7], a[60:63], a[20:23], v[4:7]
    ds_read_b128 a[4:7], v120 offset:256
    v_mfma_f32_16x16x32_bf16 v[8:11], a[60:63], a[24:27], v[8:11]
    ds_read_b128 a[8:11], v120 offset:512
    v_mfma_f32_16x16x32_bf16 v[12:15], a[60:63], a[28:31], v[12:15]
    ds_read_b128 a[12:15], v120 offset:768
    v_mfma_f32_16x16x32_bf16 v[28:31], a[64:67], a[28:31], v[28:31]
    ds_read_b64_tr_b16 a[32:33], v122 offset:0
    v_mfma_f32_16x16x32_bf16 v[24:27], a[64:67], a[24:27], v[24:27]
    ds_read_b64_tr_b16 a[34:35], v122 offset:1792
    v_mfma_f32_16x16x32_bf16 v[20:23], a[64:67], a[20:23], v[20:23]
    ds_read_b64_tr_b16 a[36:37], v122 offset:32
    v_mfma_f32_16x16x32_bf16 v[16:19], a[64:67], a[16:19], v[16:19]
    ds_read_b64_tr_b16 a[38:39], v122 offset:1824
    v_mfma_f32_16x16x32_bf16 v[32:35], a[68:71], a[16:19], v[32:35]
    ds_read_b64_tr_b16 a[40:41], v122 offset:64
    v_mfma_f32_16x16x32_bf16 v[36:39], a[68:71], a[20:23], v[36:39]
    v_mfma_f32_16x16x32_bf16 v[40:43], a[68:71], a[24:27], v[40:43]
    ds_read_b64_tr_b16 a[42:43], v122 offset:1856
    v_mfma_f32_16x16x32_bf16 v[44:47], a[68:71], a[28:31], v[44:47]
    ds_read_b64_tr_b16 a[44:45], v122 offset:14352
    v_mfma_f32_16x16x32_bf16 v[60:63], a[72:75], a[28:31], v[60:63]
    ds_read_b64_tr_b16 a[46:47], v122 offset:16144
    v_mfma_f32_16x16x32_bf16 v[56:59], a[72:75], a[24:27], v[56:59]
    ds_read_b64_tr_b16 a[48:49], v122 offset:14384
    v_mfma_f32_16x16x32_bf16 v[52:55], a[72:75], a[20:23], v[52:55]
    ds_read_b64_tr_b16 a[50:51], v122 offset:16176
    v_mfma_f32_16x16x32_bf16 v[48:51], a[72:75], a[16:19], v[48:51]
    ds_read_b64_tr_b16 a[52:53], v122 offset:14416
    v_mfma_f32_16x16x32_bf16 v[64:67], a[76:79], a[16:19], v[64:67]
    ds_read_b64_tr_b16 a[54:55], v122 offset:16208
    v_mfma_f32_16x16x32_bf16 v[68:71], a[76:79], a[20:23], v[68:71]
    ds_read_b64_tr_b16 a[56:57], v123 offset:0
    v_mfma_f32_16x16x32_bf16 v[72:75], a[76:79], a[24:27], v[72:75]
    ds_read_b64_tr_b16 a[58:59], v123 offset:1792
    v_mfma_f32_16x16x32_bf16 v[76:79], a[76:79], a[28:31], v[76:79]
    v_mfma_f32_16x16x32_bf16 v[92:95], a[80:83], a[28:31], v[92:95]
    v_mfma_f32_16x16x32_bf16 v[88:91], a[80:83], a[24:27], v[88:91]
    v_mfma_f32_16x16x32_bf16 v[84:87], a[80:83], a[20:23], v[84:87]
    v_mfma_f32_16x16x32_bf16 v[80:83], a[80:83], a[16:19], v[80:83]
    v_mfma_f32_16x16x32_bf16 v[96:99], a[84:87], a[16:19], v[96:99]
    v_mfma_f32_16x16x32_bf16 v[100:103], a[84:87], a[20:23], v[100:103]
    v_mfma_f32_16x16x32_bf16 v[104:107], a[84:87], a[24:27], v[104:107]
    v_mfma_f32_16x16x32_bf16 v[108:111], a[84:87], a[28:31], v[108:111]
    s_waitcnt lgkmcnt(0)
    s_cmp_lt_u32 s40, 4
    s_cbranch_scc0 L_sequential_preLN__sliding_block__glu_gated_bilinear__prompt_kernel_Cg3_115
    v_pk_add_f32 v[136:137], v[136:137], v[140:141]
    v_pk_add_f32 v[138:139], v[138:139], v[142:143]
    v_mov_b32 v140, v136
    v_mov_b32 v141, v137
    v_mov_b32 v142, v138
    v_mov_b32 v143, v139
    s_nop 1
    v_permlane16_swap_b32 v140, v136
    v_permlane16_swap_b32 v141, v137
    v_permlane16_swap_b32 v142, v138
    v_permlane16_swap_b32 v143, v139
    s_nop 1
    v_add_f32 v136, v136, v140
    v_add_f32 v137, v137, v141
    v_add_f32 v138, v138, v142
    v_add_f32 v139, v139, v143
    v_mov_b32 v140, v136
    v_mov_b32 v141, v137
    v_mov_b32 v142, v138
    v_mov_b32 v143, v139
    s_nop 1
    v_permlane32_swap_b32 v140, v136
    v_permlane32_swap_b32 v141, v137
    v_permlane32_swap_b32 v142, v138
    v_permlane32_swap_b32 v143, v139
    s_nop 1
    v_add_f32 v136, v136, v140
    v_add_f32 v137, v137, v141
    v_add_f32 v138, v138, v142
    v_add_f32 v139, v139, v143
    ds_write_b128 v127, v[136:139]
    s_branch L_sequential_preLN__sliding_block__glu_gated_bilinear__prompt_kernel_Cg4_117
L_sequential_preLN__sliding_block__glu_gated_bilinear__prompt_kernel_Cg3_115:
    v_pk_add_f32 v[128:129], v[128:129], v[130:131]
    v_pk_add_f32 v[128:129], v[128:129], v[132:133]
    v_pk_add_f32 v[128:129], v[128:129], v[134:135]
    v_pk_add_f32 v[128:129], v[128:129], v[136:137]
    v_pk_add_f32 v[128:129], v[128:129], v[138:139]
    v_pk_add_f32 v[128:129], v[128:129], v[140:141]
    v_pk_add_f32 v[128:129], v[128:129], v[142:143]
    v_pk_add_f32 v[128:129], v[128:129], v[144:145]
    v_pk_add_f32 v[128:129], v[128:129], v[146:147]
    v_pk_add_f32 v[128:129], v[128:129], v[148:149]
    v_pk_add_f32 v[128:129], v[128:129], v[150:151]
    v_pk_add_f32 v[128:129], v[128:129], v[152:153]
    v_pk_add_f32 v[128:129], v[128:129], v[154:155]
    v_pk_add_f32 v[128:129], v[128:129], v[156:157]
    v_pk_add_f32 v[128:129], v[128:129], v[158:159]

    v_mul_f32 v128, 0x3a800000, v128
    v_mul_f32 v129, 0x3a800000, v129
    v_fma_f32 v129, -v128, v128, v129
    v_max_f32 v129, 0, v129
    v_add_f32 v129, 0x3727c5ac, v129
    v_rsq_f32 v129, v129
    s_sub_u32 s3, s40, 4
    s_lshl_b32 s3, s3, 9
    s_add_u32 s3, s3, 155712
    v_lshl_add_u32 v126, v164, 3, s3
    ds_write_b64 v126, v[128:129]
L_sequential_preLN__sliding_block__glu_gated_bilinear__prompt_kernel_Cg4_117:
    s_waitcnt lgkmcnt(0)

    v_mfma_f32_16x16x32_bf16 v[0:3], a[32:35], a[0:3], v[0:3]
    ds_read_b128 a[16:19], v121 offset:0
    v_mfma_f32_16x16x32_bf16 v[4:7], a[32:35], a[4:7], v[4:7]
    ds_read_b128 a[20:23], v121 offset:256
    v_mfma_f32_16x16x32_bf16 v[8:11], a[32:35], a[8:11], v[8:11]
    ds_read_b128 a[24:27], v121 offset:512
    v_mfma_f32_16x16x32_bf16 v[12:15], a[32:35], a[12:15], v[12:15]
    ds_read_b128 a[28:31], v121 offset:768
    v_mfma_f32_16x16x32_bf16 v[28:31], a[36:39], a[12:15], v[28:31]
    ds_read_b64_tr_b16 a[60:61], v122 offset:7168
    v_mfma_f32_16x16x32_bf16 v[24:27], a[36:39], a[8:11], v[24:27]
    ds_read_b64_tr_b16 a[62:63], v122 offset:8960
    v_mfma_f32_16x16x32_bf16 v[20:23], a[36:39], a[4:7], v[20:23]
    ds_read_b64_tr_b16 a[64:65], v122 offset:7200
    v_mfma_f32_16x16x32_bf16 v[16:19], a[36:39], a[0:3], v[16:19]
    ds_read_b64_tr_b16 a[66:67], v122 offset:8992
    v_mfma_f32_16x16x32_bf16 v[32:35], a[40:43], a[0:3], v[32:35]
    ds_read_b64_tr_b16 a[68:69], v122 offset:7232
    v_mfma_f32_16x16x32_bf16 v[36:39], a[40:43], a[4:7], v[36:39]
    v_mfma_f32_16x16x32_bf16 v[40:43], a[40:43], a[8:11], v[40:43]
    ds_read_b64_tr_b16 a[70:71], v122 offset:9024
    v_mfma_f32_16x16x32_bf16 v[44:47], a[40:43], a[12:15], v[44:47]
    ds_read_b64_tr_b16 a[72:73], v122 offset:21520
    v_mfma_f32_16x16x32_bf16 v[60:63], a[44:47], a[12:15], v[60:63]
    ds_read_b64_tr_b16 a[74:75], v122 offset:23312
    v_mfma_f32_16x16x32_bf16 v[56:59], a[44:47], a[8:11], v[56:59]
    ds_read_b64_tr_b16 a[76:77], v122 offset:21552
    v_mfma_f32_16x16x32_bf16 v[52:55], a[44:47], a[4:7], v[52:55]
    ds_read_b64_tr_b16 a[78:79], v122 offset:23344
    v_mfma_f32_16x16x32_bf16 v[48:51], a[44:47], a[0:3], v[48:51]
    ds_read_b64_tr_b16 a[80:81], v122 offset:21584
    v_mfma_f32_16x16x32_bf16 v[64:67], a[48:51], a[0:3], v[64:67]
    ds_read_b64_tr_b16 a[82:83], v122 offset:23376
    v_mfma_f32_16x16x32_bf16 v[68:71], a[48:51], a[4:7], v[68:71]
    ds_read_b64_tr_b16 a[84:85], v123 offset:7168
    v_mfma_f32_16x16x32_bf16 v[72:75], a[48:51], a[8:11], v[72:75]
    ds_read_b64_tr_b16 a[86:87], v123 offset:8960
    v_mfma_f32_16x16x32_bf16 v[76:79], a[48:51], a[12:15], v[76:79]
    v_mfma_f32_16x16x32_bf16 v[92:95], a[52:55], a[12:15], v[92:95]
    v_mfma_f32_16x16x32_bf16 v[88:91], a[52:55], a[8:11], v[88:91]
    v_mfma_f32_16x16x32_bf16 v[84:87], a[52:55], a[4:7], v[84:87]
    v_mfma_f32_16x16x32_bf16 v[80:83], a[52:55], a[0:3], v[80:83]
    v_mfma_f32_16x16x32_bf16 v[96:99], a[56:59], a[0:3], v[96:99]
    v_mfma_f32_16x16x32_bf16 v[100:103], a[56:59], a[4:7], v[100:103]
    v_mfma_f32_16x16x32_bf16 v[104:107], a[56:59], a[8:11], v[104:107]
    v_mfma_f32_16x16x32_bf16 v[108:111], a[56:59], a[12:15], v[108:111]
    s_waitcnt vmcnt(63) lgkmcnt(0)
    s_barrier
    v_mfma_f32_16x16x32_bf16 v[0:3], a[60:63], a[16:19], v[0:3]
    v_mfma_f32_16x16x32_bf16 v[4:7], a[60:63], a[20:23], v[4:7]
    v_mfma_f32_16x16x32_bf16 v[8:11], a[60:63], a[24:27], v[8:11]
    v_mfma_f32_16x16x32_bf16 v[12:15], a[60:63], a[28:31], v[12:15]
    v_mfma_f32_16x16x32_bf16 v[28:31], a[64:67], a[28:31], v[28:31]
    v_mfma_f32_16x16x32_bf16 v[24:27], a[64:67], a[24:27], v[24:27]
    v_mfma_f32_16x16x32_bf16 v[20:23], a[64:67], a[20:23], v[20:23]
    v_mfma_f32_16x16x32_bf16 v[16:19], a[64:67], a[16:19], v[16:19]
    v_mfma_f32_16x16x32_bf16 v[32:35], a[68:71], a[16:19], v[32:35]
    v_mfma_f32_16x16x32_bf16 v[36:39], a[68:71], a[20:23], v[36:39]
    v_mfma_f32_16x16x32_bf16 v[40:43], a[68:71], a[24:27], v[40:43]
    v_mfma_f32_16x16x32_bf16 v[44:47], a[68:71], a[28:31], v[44:47]
    v_mfma_f32_16x16x32_bf16 v[60:63], a[72:75], a[28:31], v[60:63]
    v_mfma_f32_16x16x32_bf16 v[56:59], a[72:75], a[24:27], v[56:59]
    v_mfma_f32_16x16x32_bf16 v[52:55], a[72:75], a[20:23], v[52:55]
    v_mfma_f32_16x16x32_bf16 v[48:51], a[72:75], a[16:19], v[48:51]
    v_mfma_f32_16x16x32_bf16 v[64:67], a[76:79], a[16:19], v[64:67]
    v_mfma_f32_16x16x32_bf16 v[68:71], a[76:79], a[20:23], v[68:71]
    v_mfma_f32_16x16x32_bf16 v[72:75], a[76:79], a[24:27], v[72:75]
    v_mfma_f32_16x16x32_bf16 v[76:79], a[76:79], a[28:31], v[76:79]
    v_mfma_f32_16x16x32_bf16 v[92:95], a[80:83], a[28:31], v[92:95]
    v_mfma_f32_16x16x32_bf16 v[88:91], a[80:83], a[24:27], v[88:91]
    v_mfma_f32_16x16x32_bf16 v[84:87], a[80:83], a[20:23], v[84:87]
    v_mfma_f32_16x16x32_bf16 v[80:83], a[80:83], a[16:19], v[80:83]
    v_mfma_f32_16x16x32_bf16 v[96:99], a[84:87], a[16:19], v[96:99]
    v_mfma_f32_16x16x32_bf16 v[100:103], a[84:87], a[20:23], v[100:103]
    v_mfma_f32_16x16x32_bf16 v[104:107], a[84:87], a[24:27], v[104:107]
    v_mfma_f32_16x16x32_bf16 v[108:111], a[84:87], a[28:31], v[108:111]

    v_and_b32 v124, 15, v164
    s_lshl_b32 s3, s47, 9
    s_add_u32 s3, s3, 155712
    v_lshl_add_u32 v125, v124, 3, s3

    ds_read_b64 v[112:113], v125 offset:0
    ds_read_b64 v[114:115], v125 offset:128
    ds_read_b64 v[116:117], v125 offset:256
    ds_read_b64 v[118:119], v125 offset:384

    v_lshrrev_b32 v125, 4, v164
    s_mul_i32 s3, s48, 448
    s_add_u32 s3, s3, 157760
    v_lshl_add_u32 v126, v125, 4, s3

    ds_read_b128 v[136:139], v126 offset:0
    ds_read_b128 v[140:143], v126 offset:64
    ds_read_b128 v[144:147], v126 offset:128
    ds_read_b128 v[148:151], v126 offset:192
    ds_read_b128 v[152:155], v126 offset:256
    ds_read_b128 v[156:159], v126 offset:320
    ds_read_b128 v[160:163], v126 offset:384
    s_add_u32 s24, s82, 29360128
    s_addc_u32 s25, s83, 0
    s_mov_b32 s26, 14680064
    s_mov_b32 s27, 0x20000

    s_lshr_b32 s3, s47, 1
    s_lshl_b32 s4, s43, 1
    s_add_u32 s3, s3, s4
    s_mul_i32 s3, s3, 917504
    s_mul_i32 s4, s44, 14
    s_mul_i32 s5, s48, 7
    s_add_u32 s4, s4, s5
    s_lshl_b32 s4, s4, 11
    s_add_u32 s3, s3, s4
    s_and_b32 s4, s47, 1
    s_lshl_b32 s4, s4, 10
    s_add_u32 s3, s3, s4
    v_lshl_add_u32 v124, v124, 4, s3
    v_and_b32 v126, 1, v125
    v_lshrrev_b32 v127, 1, v125
    v_lshl_add_u32 v120, v126, 1, v127
    v_lshl_add_u32 v120, v120, 11, v124
    v_lshlrev_b32 v121, 8, v126
    v_add_u32 v121, v121, v124
    v_lshl_add_u32 v121, v127, 11, v121
    v_lshl_add_u32 v122, v126, 1, v127
    v_lshl_add_u32 v122, v122, 8, v124
    s_waitcnt lgkmcnt(0)

    v_mul_f32 v113, v113, v113
    v_mul_f32 v115, v115, v115
    v_mul_f32 v117, v117, v117
    v_mul_f32 v119, v119, v119
    v_pk_fma_f32 v[0:1], v[136:137], v[112:113], v[0:1] op_sel:[0,0,0] op_sel_hi:[1,0,1] neg_lo:[0,1,0] neg_hi:[0,1,0]
    v_pk_fma_f32 v[2:3], v[138:139], v[112:113], v[2:3] op_sel:[0,0,0] op_sel_hi:[1,0,1] neg_lo:[0,1,0] neg_hi:[0,1,0]
    v_pk_fma_f32 v[48:49], v[148:149], v[112:113], v[48:49] op_sel:[0,0,0] op_sel_hi:[1,0,1] neg_lo:[0,1,0] neg_hi:[0,1,0]
    v_pk_fma_f32 v[50:51], v[150:151], v[112:113], v[50:51] op_sel:[0,0,0] op_sel_hi:[1,0,1] neg_lo:[0,1,0] neg_hi:[0,1,0]
    v_pk_mul_f32 v[0:1], v[0:1], v[48:49]
    v_pk_mul_f32 v[2:3], v[2:3], v[50:51]
    v_pk_mul_f32 v[0:1], v[0:1], v[112:113] op_sel:[0,1] op_sel_hi:[1,1]
    v_pk_mul_f32 v[2:3], v[2:3], v[112:113] op_sel:[0,1] op_sel_hi:[1,1]
    v_pk_fma_f32 v[16:17], v[140:141], v[112:113], v[16:17] op_sel:[0,0,0] op_sel_hi:[1,0,1] neg_lo:[0,1,0] neg_hi:[0,1,0]
    v_pk_fma_f32 v[18:19], v[142:143], v[112:113], v[18:19] op_sel:[0,0,0] op_sel_hi:[1,0,1] neg_lo:[0,1,0] neg_hi:[0,1,0]
    v_pk_fma_f32 v[64:65], v[152:153], v[112:113], v[64:65] op_sel:[0,0,0] op_sel_hi:[1,0,1] neg_lo:[0,1,0] neg_hi:[0,1,0]
    v_pk_fma_f32 v[66:67], v[154:155], v[112:113], v[66:67] op_sel:[0,0,0] op_sel_hi:[1,0,1] neg_lo:[0,1,0] neg_hi:[0,1,0]
    v_pk_mul_f32 v[16:17], v[16:17], v[64:65]
    v_pk_mul_f32 v[18:19], v[18:19], v[66:67]
    v_pk_mul_f32 v[16:17], v[16:17], v[112:113] op_sel:[0,1] op_sel_hi:[1,1]
    v_pk_mul_f32 v[18:19], v[18:19], v[112:113] op_sel:[0,1] op_sel_hi:[1,1]
    v_cvt_pk_bf16_f32 v48, v0, v1
    v_cvt_pk_bf16_f32 v49, v2, v3
    v_cvt_pk_bf16_f32 v50, v16, v17
    v_cvt_pk_bf16_f32 v51, v18, v19
    s_nop 1
    v_permlane16_swap_b32 v48, v50
    v_permlane16_swap_b32 v49, v51
    buffer_store_dwordx4 v[48:51], v120, s[24:27], 0 offen offset:0 sc1
    v_pk_fma_f32 v[4:5], v[136:137], v[114:115], v[4:5] op_sel:[0,0,0] op_sel_hi:[1,0,1] neg_lo:[0,1,0] neg_hi:[0,1,0]
    v_pk_fma_f32 v[6:7], v[138:139], v[114:115], v[6:7] op_sel:[0,0,0] op_sel_hi:[1,0,1] neg_lo:[0,1,0] neg_hi:[0,1,0]
    v_pk_fma_f32 v[52:53], v[148:149], v[114:115], v[52:53] op_sel:[0,0,0] op_sel_hi:[1,0,1] neg_lo:[0,1,0] neg_hi:[0,1,0]
    v_pk_fma_f32 v[54:55], v[150:151], v[114:115], v[54:55] op_sel:[0,0,0] op_sel_hi:[1,0,1] neg_lo:[0,1,0] neg_hi:[0,1,0]
    v_pk_mul_f32 v[4:5], v[4:5], v[52:53]
    v_pk_mul_f32 v[6:7], v[6:7], v[54:55]
    v_pk_mul_f32 v[4:5], v[4:5], v[114:115] op_sel:[0,1] op_sel_hi:[1,1]
    v_pk_mul_f32 v[6:7], v[6:7], v[114:115] op_sel:[0,1] op_sel_hi:[1,1]
    v_pk_fma_f32 v[20:21], v[140:141], v[114:115], v[20:21] op_sel:[0,0,0] op_sel_hi:[1,0,1] neg_lo:[0,1,0] neg_hi:[0,1,0]
    v_pk_fma_f32 v[22:23], v[142:143], v[114:115], v[22:23] op_sel:[0,0,0] op_sel_hi:[1,0,1] neg_lo:[0,1,0] neg_hi:[0,1,0]
    v_pk_fma_f32 v[68:69], v[152:153], v[114:115], v[68:69] op_sel:[0,0,0] op_sel_hi:[1,0,1] neg_lo:[0,1,0] neg_hi:[0,1,0]
    v_pk_fma_f32 v[70:71], v[154:155], v[114:115], v[70:71] op_sel:[0,0,0] op_sel_hi:[1,0,1] neg_lo:[0,1,0] neg_hi:[0,1,0]
    v_pk_mul_f32 v[20:21], v[20:21], v[68:69]
    v_pk_mul_f32 v[22:23], v[22:23], v[70:71]
    v_pk_mul_f32 v[20:21], v[20:21], v[114:115] op_sel:[0,1] op_sel_hi:[1,1]
    v_pk_mul_f32 v[22:23], v[22:23], v[114:115] op_sel:[0,1] op_sel_hi:[1,1]
    v_cvt_pk_bf16_f32 v52, v4, v5
    v_cvt_pk_bf16_f32 v53, v6, v7
    v_cvt_pk_bf16_f32 v54, v20, v21
    v_cvt_pk_bf16_f32 v55, v22, v23
    s_nop 1
    v_permlane16_swap_b32 v52, v54
    v_permlane16_swap_b32 v53, v55
    buffer_store_dwordx4 v[52:55], v120, s[24:27], 0 offen offset:256 sc1
    v_pk_fma_f32 v[8:9], v[136:137], v[116:117], v[8:9] op_sel:[0,0,0] op_sel_hi:[1,0,1] neg_lo:[0,1,0] neg_hi:[0,1,0]
    v_pk_fma_f32 v[10:11], v[138:139], v[116:117], v[10:11] op_sel:[0,0,0] op_sel_hi:[1,0,1] neg_lo:[0,1,0] neg_hi:[0,1,0]
    v_pk_fma_f32 v[56:57], v[148:149], v[116:117], v[56:57] op_sel:[0,0,0] op_sel_hi:[1,0,1] neg_lo:[0,1,0] neg_hi:[0,1,0]
    v_pk_fma_f32 v[58:59], v[150:151], v[116:117], v[58:59] op_sel:[0,0,0] op_sel_hi:[1,0,1] neg_lo:[0,1,0] neg_hi:[0,1,0]
    v_pk_mul_f32 v[8:9], v[8:9], v[56:57]
    v_pk_mul_f32 v[10:11], v[10:11], v[58:59]
    v_pk_mul_f32 v[8:9], v[8:9], v[116:117] op_sel:[0,1] op_sel_hi:[1,1]
    v_pk_mul_f32 v[10:11], v[10:11], v[116:117] op_sel:[0,1] op_sel_hi:[1,1]
    v_pk_fma_f32 v[24:25], v[140:141], v[116:117], v[24:25] op_sel:[0,0,0] op_sel_hi:[1,0,1] neg_lo:[0,1,0] neg_hi:[0,1,0]
    v_pk_fma_f32 v[26:27], v[142:143], v[116:117], v[26:27] op_sel:[0,0,0] op_sel_hi:[1,0,1] neg_lo:[0,1,0] neg_hi:[0,1,0]
    v_pk_fma_f32 v[72:73], v[152:153], v[116:117], v[72:73] op_sel:[0,0,0] op_sel_hi:[1,0,1] neg_lo:[0,1,0] neg_hi:[0,1,0]
    v_pk_fma_f32 v[74:75], v[154:155], v[116:117], v[74:75] op_sel:[0,0,0] op_sel_hi:[1,0,1] neg_lo:[0,1,0] neg_hi:[0,1,0]
    v_pk_mul_f32 v[24:25], v[24:25], v[72:73]
    v_pk_mul_f32 v[26:27], v[26:27], v[74:75]
    v_pk_mul_f32 v[24:25], v[24:25], v[116:117] op_sel:[0,1] op_sel_hi:[1,1]
    v_pk_mul_f32 v[26:27], v[26:27], v[116:117] op_sel:[0,1] op_sel_hi:[1,1]
    v_cvt_pk_bf16_f32 v56, v8, v9
    v_cvt_pk_bf16_f32 v57, v10, v11
    v_cvt_pk_bf16_f32 v58, v24, v25
    v_cvt_pk_bf16_f32 v59, v26, v27
    s_nop 1
    v_permlane16_swap_b32 v56, v58
    v_permlane16_swap_b32 v57, v59
    buffer_store_dwordx4 v[56:59], v120, s[24:27], 0 offen offset:512 sc1
    v_pk_fma_f32 v[12:13], v[136:137], v[118:119], v[12:13] op_sel:[0,0,0] op_sel_hi:[1,0,1] neg_lo:[0,1,0] neg_hi:[0,1,0]
    v_pk_fma_f32 v[14:15], v[138:139], v[118:119], v[14:15] op_sel:[0,0,0] op_sel_hi:[1,0,1] neg_lo:[0,1,0] neg_hi:[0,1,0]
    v_pk_fma_f32 v[60:61], v[148:149], v[118:119], v[60:61] op_sel:[0,0,0] op_sel_hi:[1,0,1] neg_lo:[0,1,0] neg_hi:[0,1,0]
    v_pk_fma_f32 v[62:63], v[150:151], v[118:119], v[62:63] op_sel:[0,0,0] op_sel_hi:[1,0,1] neg_lo:[0,1,0] neg_hi:[0,1,0]
    v_pk_mul_f32 v[12:13], v[12:13], v[60:61]
    v_pk_mul_f32 v[14:15], v[14:15], v[62:63]
    v_pk_mul_f32 v[12:13], v[12:13], v[118:119] op_sel:[0,1] op_sel_hi:[1,1]
    v_pk_mul_f32 v[14:15], v[14:15], v[118:119] op_sel:[0,1] op_sel_hi:[1,1]
    v_pk_fma_f32 v[28:29], v[140:141], v[118:119], v[28:29] op_sel:[0,0,0] op_sel_hi:[1,0,1] neg_lo:[0,1,0] neg_hi:[0,1,0]
    v_pk_fma_f32 v[30:31], v[142:143], v[118:119], v[30:31] op_sel:[0,0,0] op_sel_hi:[1,0,1] neg_lo:[0,1,0] neg_hi:[0,1,0]
    v_pk_fma_f32 v[76:77], v[152:153], v[118:119], v[76:77] op_sel:[0,0,0] op_sel_hi:[1,0,1] neg_lo:[0,1,0] neg_hi:[0,1,0]
    v_pk_fma_f32 v[78:79], v[154:155], v[118:119], v[78:79] op_sel:[0,0,0] op_sel_hi:[1,0,1] neg_lo:[0,1,0] neg_hi:[0,1,0]
    v_pk_mul_f32 v[28:29], v[28:29], v[76:77]
    v_pk_mul_f32 v[30:31], v[30:31], v[78:79]
    v_pk_mul_f32 v[28:29], v[28:29], v[118:119] op_sel:[0,1] op_sel_hi:[1,1]
    v_pk_mul_f32 v[30:31], v[30:31], v[118:119] op_sel:[0,1] op_sel_hi:[1,1]
    v_cvt_pk_bf16_f32 v60, v12, v13
    v_cvt_pk_bf16_f32 v61, v14, v15
    v_cvt_pk_bf16_f32 v62, v28, v29
    v_cvt_pk_bf16_f32 v63, v30, v31
    s_nop 1
    v_permlane16_swap_b32 v60, v62
    v_permlane16_swap_b32 v61, v63
    buffer_store_dwordx4 v[60:63], v120, s[24:27], 0 offen offset:768 sc1
    v_pk_fma_f32 v[32:33], v[144:145], v[112:113], v[32:33] op_sel:[0,0,0] op_sel_hi:[1,0,1] neg_lo:[0,1,0] neg_hi:[0,1,0]
    v_pk_fma_f32 v[34:35], v[146:147], v[112:113], v[34:35] op_sel:[0,0,0] op_sel_hi:[1,0,1] neg_lo:[0,1,0] neg_hi:[0,1,0]
    v_pk_fma_f32 v[80:81], v[156:157], v[112:113], v[80:81] op_sel:[0,0,0] op_sel_hi:[1,0,1] neg_lo:[0,1,0] neg_hi:[0,1,0]
    v_pk_fma_f32 v[82:83], v[158:159], v[112:113], v[82:83] op_sel:[0,0,0] op_sel_hi:[1,0,1] neg_lo:[0,1,0] neg_hi:[0,1,0]
    v_pk_mul_f32 v[32:33], v[32:33], v[80:81]
    v_pk_mul_f32 v[34:35], v[34:35], v[82:83]
    v_pk_mul_f32 v[32:33], v[32:33], v[112:113] op_sel:[0,1] op_sel_hi:[1,1]
    v_pk_mul_f32 v[34:35], v[34:35], v[112:113] op_sel:[0,1] op_sel_hi:[1,1]
    v_pk_fma_f32 v[36:37], v[144:145], v[114:115], v[36:37] op_sel:[0,0,0] op_sel_hi:[1,0,1] neg_lo:[0,1,0] neg_hi:[0,1,0]
    v_pk_fma_f32 v[38:39], v[146:147], v[114:115], v[38:39] op_sel:[0,0,0] op_sel_hi:[1,0,1] neg_lo:[0,1,0] neg_hi:[0,1,0]
    v_pk_fma_f32 v[84:85], v[156:157], v[114:115], v[84:85] op_sel:[0,0,0] op_sel_hi:[1,0,1] neg_lo:[0,1,0] neg_hi:[0,1,0]
    v_pk_fma_f32 v[86:87], v[158:159], v[114:115], v[86:87] op_sel:[0,0,0] op_sel_hi:[1,0,1] neg_lo:[0,1,0] neg_hi:[0,1,0]
    v_pk_mul_f32 v[36:37], v[36:37], v[84:85]
    v_pk_mul_f32 v[38:39], v[38:39], v[86:87]
    v_pk_mul_f32 v[36:37], v[36:37], v[114:115] op_sel:[0,1] op_sel_hi:[1,1]
    v_pk_mul_f32 v[38:39], v[38:39], v[114:115] op_sel:[0,1] op_sel_hi:[1,1]
    v_cvt_pk_bf16_f32 v80, v32, v33
    v_cvt_pk_bf16_f32 v81, v34, v35
    v_cvt_pk_bf16_f32 v82, v36, v37
    v_cvt_pk_bf16_f32 v83, v38, v39
    s_nop 1
    v_permlane16_swap_b32 v80, v82
    v_permlane16_swap_b32 v81, v83
    s_mov_b32 s3, 8192
    buffer_store_dwordx4 v[80:83], v121, s[24:27], s3 offen offset:0 sc1
    v_pk_fma_f32 v[40:41], v[144:145], v[116:117], v[40:41] op_sel:[0,0,0] op_sel_hi:[1,0,1] neg_lo:[0,1,0] neg_hi:[0,1,0]
    v_pk_fma_f32 v[42:43], v[146:147], v[116:117], v[42:43] op_sel:[0,0,0] op_sel_hi:[1,0,1] neg_lo:[0,1,0] neg_hi:[0,1,0]
    v_pk_fma_f32 v[88:89], v[156:157], v[116:117], v[88:89] op_sel:[0,0,0] op_sel_hi:[1,0,1] neg_lo:[0,1,0] neg_hi:[0,1,0]
    v_pk_fma_f32 v[90:91], v[158:159], v[116:117], v[90:91] op_sel:[0,0,0] op_sel_hi:[1,0,1] neg_lo:[0,1,0] neg_hi:[0,1,0]
    v_pk_mul_f32 v[40:41], v[40:41], v[88:89]
    v_pk_mul_f32 v[42:43], v[42:43], v[90:91]
    v_pk_mul_f32 v[40:41], v[40:41], v[116:117] op_sel:[0,1] op_sel_hi:[1,1]
    v_pk_mul_f32 v[42:43], v[42:43], v[116:117] op_sel:[0,1] op_sel_hi:[1,1]
    v_pk_fma_f32 v[44:45], v[144:145], v[118:119], v[44:45] op_sel:[0,0,0] op_sel_hi:[1,0,1] neg_lo:[0,1,0] neg_hi:[0,1,0]
    v_pk_fma_f32 v[46:47], v[146:147], v[118:119], v[46:47] op_sel:[0,0,0] op_sel_hi:[1,0,1] neg_lo:[0,1,0] neg_hi:[0,1,0]
    v_pk_fma_f32 v[92:93], v[156:157], v[118:119], v[92:93] op_sel:[0,0,0] op_sel_hi:[1,0,1] neg_lo:[0,1,0] neg_hi:[0,1,0]
    v_pk_fma_f32 v[94:95], v[158:159], v[118:119], v[94:95] op_sel:[0,0,0] op_sel_hi:[1,0,1] neg_lo:[0,1,0] neg_hi:[0,1,0]
    v_pk_mul_f32 v[44:45], v[44:45], v[92:93]
    v_pk_mul_f32 v[46:47], v[46:47], v[94:95]
    v_pk_mul_f32 v[44:45], v[44:45], v[118:119] op_sel:[0,1] op_sel_hi:[1,1]
    v_pk_mul_f32 v[46:47], v[46:47], v[118:119] op_sel:[0,1] op_sel_hi:[1,1]
    v_cvt_pk_bf16_f32 v88, v40, v41
    v_cvt_pk_bf16_f32 v89, v42, v43
    v_cvt_pk_bf16_f32 v90, v44, v45
    v_cvt_pk_bf16_f32 v91, v46, v47
    s_nop 1
    v_permlane16_swap_b32 v88, v90
    v_permlane16_swap_b32 v89, v91
    s_mov_b32 s3, 8192
    buffer_store_dwordx4 v[88:91], v121, s[24:27], s3 offen offset:512 sc1
    v_pk_fma_f32 v[96:97], v[160:161], v[112:113], v[96:97] op_sel:[0,0,0] op_sel_hi:[1,0,1] neg_lo:[0,1,0] neg_hi:[0,1,0]
    v_pk_fma_f32 v[98:99], v[162:163], v[112:113], v[98:99] op_sel:[0,0,0] op_sel_hi:[1,0,1] neg_lo:[0,1,0] neg_hi:[0,1,0]
    v_pk_fma_f32 v[100:101], v[160:161], v[114:115], v[100:101] op_sel:[0,0,0] op_sel_hi:[1,0,1] neg_lo:[0,1,0] neg_hi:[0,1,0]
    v_pk_fma_f32 v[102:103], v[162:163], v[114:115], v[102:103] op_sel:[0,0,0] op_sel_hi:[1,0,1] neg_lo:[0,1,0] neg_hi:[0,1,0]
    s_nop 1
    v_permlane32_swap_b32 v96, v100
    v_permlane32_swap_b32 v97, v101
    v_permlane32_swap_b32 v98, v102
    v_permlane32_swap_b32 v99, v103
    v_cmp_gt_u32 vcc, 32, v164
    s_nop 1
    v_cndmask_b32 v127, v115, v113, vcc
    v_mul_f32 v96, v96, v100
    v_mul_f32 v97, v97, v101
    v_mul_f32 v98, v98, v102
    v_mul_f32 v99, v99, v103
    v_mul_f32 v96, v96, v127
    v_mul_f32 v97, v97, v127
    v_mul_f32 v98, v98, v127
    v_mul_f32 v99, v99, v127
    v_cvt_pk_bf16_f32 v64, v96, v97
    v_cvt_pk_bf16_f32 v65, v98, v99
    v_pk_fma_f32 v[104:105], v[160:161], v[116:117], v[104:105] op_sel:[0,0,0] op_sel_hi:[1,0,1] neg_lo:[0,1,0] neg_hi:[0,1,0]
    v_pk_fma_f32 v[106:107], v[162:163], v[116:117], v[106:107] op_sel:[0,0,0] op_sel_hi:[1,0,1] neg_lo:[0,1,0] neg_hi:[0,1,0]
    v_pk_fma_f32 v[108:109], v[160:161], v[118:119], v[108:109] op_sel:[0,0,0] op_sel_hi:[1,0,1] neg_lo:[0,1,0] neg_hi:[0,1,0]
    v_pk_fma_f32 v[110:111], v[162:163], v[118:119], v[110:111] op_sel:[0,0,0] op_sel_hi:[1,0,1] neg_lo:[0,1,0] neg_hi:[0,1,0]
    s_nop 1
    v_permlane32_swap_b32 v104, v108
    v_permlane32_swap_b32 v105, v109
    v_permlane32_swap_b32 v106, v110
    v_permlane32_swap_b32 v107, v111
    v_cmp_gt_u32 vcc, 32, v164
    s_nop 1
    v_cndmask_b32 v127, v119, v117, vcc
    v_mul_f32 v104, v104, v108
    v_mul_f32 v105, v105, v109
    v_mul_f32 v106, v106, v110
    v_mul_f32 v107, v107, v111
    v_mul_f32 v104, v104, v127
    v_mul_f32 v105, v105, v127
    v_mul_f32 v106, v106, v127
    v_mul_f32 v107, v107, v127
    v_cvt_pk_bf16_f32 v66, v104, v105
    v_cvt_pk_bf16_f32 v67, v106, v107
    s_nop 1
    v_permlane16_swap_b32 v64, v66
    v_permlane16_swap_b32 v65, v67
    s_mov_b32 s3, 12288
    buffer_store_dwordx4 v[64:67], v122, s[24:27], s3 offen sc1
    s_waitcnt vmcnt(0)
    s_barrier
    s_cmp_eq_u32 s40, 6
    s_cbranch_scc0 L_sequential_preLN__sliding_block__glu_gated_bilinear__prompt_kernel_nopub_119
    s_lshl_b32 s3, s43, 12
    s_lshl_b32 s4, s44, 7
    s_add_u32 s3, s3, s4
    s_add_u32 s47, s3, 458752

    v_mov_b32 v30, s47
    v_mov_b32 v31, s62
    s_mov_b64 exec, 1
    buffer_store_dword v31, v30, s[28:31], 0 offen sc1
    s_mov_b64 exec, -1

L_sequential_preLN__sliding_block__glu_gated_bilinear__prompt_kernel_nopub_119:

    s_and_b32 s3, s2, 7
    s_lshr_b32 s4, s2, 3
    s_and_b32 s5, s3, 3
    s_lshl_b32 s5, s5, 2
    s_and_b32 s6, s4, 3
    s_add_u32 s41, s5, s6
    s_lshr_b32 s5, s3, 2
    s_lshl_b32 s5, s5, 3
    s_lshr_b32 s6, s4, 2
    s_add_u32 s42, s5, s6

    s_add_u32 s8, s82, 29360128
    s_addc_u32 s9, s83, 0
    s_mov_b32 s10, 14680064
    s_mov_b32 s11, 0x20000
    s_mov_b32 s12, s76
    s_mov_b32 s13, s77
    s_mov_b32 s14, 7340032
    s_mov_b32 s15, 0x20000

    s_and_b32 s3, s42, 1
    s_cmp_eq_u32 s3, 0
    s_cselect_b32 s59, 0, 32
    s_cselect_b32 s60, 32, 24
    s_mul_i32 s3, s41, s60
    s_lshr_b32 s58, s3, 4
    s_lshr_b32 s3, s42, 1
    s_and_b32 s3, s3, 3
    s_mul_i32 s3, s3, 0
    s_add_u32 s58, s58, s3
    s_cmp_ge_u32 s58, s60
    s_cselect_b32 s3, s60, 0
    s_sub_u32 s58, s58, s3

    s_and_b32 s57, s42, 1
    s_cmp_ge_u32 s40, 4
    s_cbranch_scc1 L_sequential_preLN__sliding_block__glu_gated_bilinear__prompt_kernel_Dload_120
    v_mbcnt_lo_u32_b32 v80, -1, 0
    v_mbcnt_hi_u32_b32 v80, -1, v80

    s_lshr_b32 s43, s40, 1
    s_and_b32 s44, s40, 1
    v_and_b32 v76, 15, v80
    v_lshrrev_b32 v77, 4, v80
    s_lshl_b32 s3, s43, 6
    v_add_u32 v76, s3, v76
    v_lshlrev_b32 v76, 4, v76
    v_lshl_add_u32 v64, v77, 11, v76
    v_add_u32 v65, 8192, v64
    v_add_u32 v66, 32768, v64
    v_add_u32 v67, 32768, v65
    v_lshrrev_b32 v76, 5, v80
    v_lshlrev_b32 v76, 4, v76
    v_bfe_u32 v77, v80, 4, 1
    v_lshl_add_u32 v76, v77, 2, v76
    v_bfe_u32 v77, v80, 2, 2
    v_add_u32 v76, v76, v77
    v_and_b32 v77, 7, v76
    v_lshlrev_b32 v76, 8, v76
    v_and_b32 v78, 1, v80
    v_lshl_add_u32 v76, v78, 3, v76
    v_bfe_u32 v78, v80, 1, 1
    v_lshl_add_u32 v76, v78, 4, v76
    v_add_u32 v76, 65536, v76

    s_lshl_b32 s3, s44, 2
    s_add_u32 s3, s3, 0
    v_xor_b32 v78, s3, v77
    v_lshl_add_u32 v68, v78, 5, v76
    v_add_u32 v72, 32768, v68

    s_lshl_b32 s3, s44, 2
    s_add_u32 s3, s3, 1
    v_xor_b32 v78, s3, v77
    v_lshl_add_u32 v69, v78, 5, v76
    v_add_u32 v73, 32768, v69

    s_lshl_b32 s3, s44, 2
    s_add_u32 s3, s3, 2
    v_xor_b32 v78, s3, v77
    v_lshl_add_u32 v70, v78, 5, v76
    v_add_u32 v74, 32768, v70

    s_lshl_b32 s3, s44, 2
    s_add_u32 s3, s3, 3
    v_xor_b32 v78, s3, v77
    v_lshl_add_u32 v71, v78, 5, v76
    v_add_u32 v75, 32768, v71

    s_add_u32 s16, s82, 20971520
    s_addc_u32 s17, s83, 0
    s_mov_b32 s18, 4194304
    s_mov_b32 s19, 0x20000
    s_mov_b32 s20, s78
    s_mov_b32 s21, s79
    s_mov_b32 s22, 4194304
    s_mov_b32 s23, 0x20000
    s_add_u32 s24, s82, 50331648
    s_addc_u32 s25, s83, 0
    s_mov_b32 s26, 8388608
    s_mov_b32 s27, 0x20000

    v_and_b32 v76, 15, v80
    s_lshl_b32 s3, s41, 7
    s_lshl_b32 s4, s43, 6
    s_add_u32 s3, s3, s4
    v_add_u32 v76, s3, v76
    v_lshlrev_b32 v76, 11, v76
    v_lshrrev_b32 v77, 4, v80
    v_and_b32 v78, 1, v77
    v_lshrrev_b32 v77, 1, v77
    v_lshl_add_u32 v76, v78, 5, v76
    v_lshl_add_u32 v76, v77, 4, v76
    s_lshr_b32 s3, s42, 1
    s_lshl_b32 s3, s3, 8
    s_lshl_b32 s4, s44, 7
    s_add_u32 s3, s3, s4
    v_add_u32 v81, s3, v76
    s_lshl_b32 s3, s41, 3
    s_lshr_b32 s4, s42, 1
    s_add_u32 s3, s3, s4
    s_lshl_b32 s3, s3, 15
    s_lshl_b32 s4, s40, 13
    s_add_u32 s3, s3, s4
    v_lshl_add_u32 v82, v80, 4, s3

    v_and_b32 v76, 15, v80
    s_lshl_b32 s3, s43, 6
    v_add_u32 v76, s3, v76
    v_lshlrev_b32 v76, 4, v76
    v_lshrrev_b32 v77, 4, v80
    v_and_b32 v78, 1, v77
    v_lshrrev_b32 v77, 1, v77
    v_lshl_add_u32 v76, v78, 3, v76
    v_lshl_add_u32 v76, v77, 11, v76
    s_lshr_b32 s3, s42, 1
    s_lshl_b32 s3, s3, 4
    s_lshl_b32 s4, s44, 3
    s_add_u32 s3, s3, s4
    s_lshl_b32 s3, s3, 11
    s_lshl_b32 s4, s41, 18
    s_add_u32 s3, s3, s4
    v_add_u32 v83, s3, v76

    s_cmp_eq_u32 s57, 0
    s_cbranch_scc0 L_sequential_preLN__sliding_block__glu_gated_bilinear__prompt_kernel_Dnores_123
    s_lshr_b32 s3, s41, 1
    s_lshl_b32 s3, s3, 12
    s_add_u32 s49, s3, 262144
    s_mov_b64 s[50:51], 0xffffffff
    v_mbcnt_lo_u32_b32 v116, -1, 0
    v_mbcnt_hi_u32_b32 v116, -1, v116

    v_lshlrev_b32 v116, 7, v116
    v_add_u32 v116, s49, v116
    v_mov_b32 v117, 0x7fff0000
    v_cndmask_b32 v116, v117, v116, s[50:51]
    s_mov_b32 s63, 0

    buffer_load_dword v117, v116, s[28:31], 0 offen sc1
L_sequential_preLN__sliding_block__glu_gated_bilinear__prompt_kernel_poll_125:
    buffer_load_dword v118, v116, s[28:31], 0 offen sc1
    s_waitcnt vmcnt(1)
    v_cmp_eq_u32 vcc, s62, v117
    s_nop 1
    s_and_b64 s[6:7], vcc, s[50:51]
    s_cmp_eq_u64 s[6:7], s[50:51]
    s_cbranch_scc1 L_sequential_preLN__sliding_block__glu_gated_bilinear__prompt_kernel_polld_126
    buffer_load_dword v117, v116, s[28:31], 0 offen sc1
    s_waitcnt vmcnt(1)
    v_cmp_eq_u32 vcc, s62, v118
    s_nop 1
    s_and_b64 s[6:7], vcc, s[50:51]
    s_cmp_eq_u64 s[6:7], s[50:51]
    s_cbranch_scc1 L_sequential_preLN__sliding_block__glu_gated_bilinear__prompt_kernel_polld_126
    s_add_u32 s63, s63, 1
    s_cmp_lt_u32 s63, 40000
    s_cbranch_scc1 L_sequential_preLN__sliding_block__glu_gated_bilinear__prompt_kernel_poll_125
L_sequential_preLN__sliding_block__glu_gated_bilinear__prompt_kernel_polld_126:

    s_mov_b32 s3, 0
    buffer_load_dwordx2 v[84:85], v83, s[16:19], s3 offen offset:0 sc1
    s_mov_b32 s3, 0
    buffer_load_dwordx2 v[86:87], v83, s[16:19], s3 offen offset:256 sc1
    s_mov_b32 s3, 0
    buffer_load_dwordx2 v[88:89], v83, s[16:19], s3 offen offset:512 sc1
    s_mov_b32 s3, 0
    buffer_load_dwordx2 v[90:91], v83, s[16:19], s3 offen offset:768 sc1
    s_mov_b32 s3, 4096
    buffer_load_dwordx2 v[92:93], v83, s[16:19], s3 offen offset:0 sc1
    s_mov_b32 s3, 4096
    buffer_load_dwordx2 v[94:95], v83, s[16:19], s3 offen offset:256 sc1
    s_mov_b32 s3, 4096
    buffer_load_dwordx2 v[96:97], v83, s[16:19], s3 offen offset:512 sc1
    s_mov_b32 s3, 4096
    buffer_load_dwordx2 v[98:99], v83, s[16:19], s3 offen offset:768 sc1
    s_mov_b32 s3, 8192
    buffer_load_dwordx2 v[100:101], v83, s[16:19], s3 offen offset:0 sc1
    s_mov_b32 s3, 8192
    buffer_load_dwordx2 v[102:103], v83, s[16:19], s3 offen offset:256 sc1
    s_mov_b32 s3, 8192
    buffer_load_dwordx2 v[104:105], v83, s[16:19], s3 offen offset:512 sc1
    s_mov_b32 s3, 8192
    buffer_load_dwordx2 v[106:107], v83, s[16:19], s3 offen offset:768 sc1
    s_mov_b32 s3, 12288
    buffer_load_dwordx2 v[108:109], v83, s[16:19], s3 offen offset:0 sc1
    s_mov_b32 s3, 12288
    buffer_load_dwordx2 v[110:111], v83, s[16:19], s3 offen offset:256 sc1
    s_mov_b32 s3, 12288
    buffer_load_dwordx2 v[112:113], v83, s[16:19], s3 offen offset:512 sc1
    s_mov_b32 s3, 12288
    buffer_load_dwordx2 v[114:115], v83, s[16:19], s3 offen offset:768 sc1
    s_waitcnt vmcnt(0)
    v_lshlrev_b32 v0, 16, v84
    v_and_b32 v1, 0xffff0000, v84
    v_lshlrev_b32 v2, 16, v85
    v_and_b32 v3, 0xffff0000, v85
    v_lshlrev_b32 v4, 16, v86
    v_and_b32 v5, 0xffff0000, v86
    v_lshlrev_b32 v6, 16, v87
    v_and_b32 v7, 0xffff0000, v87
    v_lshlrev_b32 v8, 16, v88
    v_and_b32 v9, 0xffff0000, v88
    v_lshlrev_b32 v10, 16, v89
    v_and_b32 v11, 0xffff0000, v89
    v_lshlrev_b32 v12, 16, v90
    v_and_b32 v13, 0xffff0000, v90
    v_lshlrev_b32 v14, 16, v91
    v_and_b32 v15, 0xffff0000, v91
    v_lshlrev_b32 v16, 16, v92
    v_and_b32 v17, 0xffff0000, v92
    v_lshlrev_b32 v18, 16, v93
    v_and_b32 v19, 0xffff0000, v93
    v_lshlrev_b32 v20, 16, v94
    v_and_b32 v21, 0xffff0000, v94
    v_lshlrev_b32 v22, 16, v95
    v_and_b32 v23, 0xffff0000, v95
    v_lshlrev_b32 v24, 16, v96
    v_and_b32 v25, 0xffff0000, v96
    v_lshlrev_b32 v26, 16, v97
    v_and_b32 v27, 0xffff0000, v97
    v_lshlrev_b32 v28, 16, v98
    v_and_b32 v29, 0xffff0000, v98
    v_lshlrev_b32 v30, 16, v99
    v_and_b32 v31, 0xffff0000, v99
    v_lshlrev_b32 v32, 16, v100
    v_and_b32 v33, 0xffff0000, v100
    v_lshlrev_b32 v34, 16, v101
    v_and_b32 v35, 0xffff0000, v101
    v_lshlrev_b32 v36, 16, v102
    v_and_b32 v37, 0xffff0000, v102
    v_lshlrev_b32 v38, 16, v103
    v_and_b32 v39, 0xffff0000, v103
    v_lshlrev_b32 v40, 16, v104
    v_and_b32 v41, 0xffff0000, v104
    v_lshlrev_b32 v42, 16, v105
    v_and_b32 v43, 0xffff0000, v105
    v_lshlrev_b32 v44, 16, v106
    v_and_b32 v45, 0xffff0000, v106
    v_lshlrev_b32 v46, 16, v107
    v_and_b32 v47, 0xffff0000, v107
    v_lshlrev_b32 v48, 16, v108
    v_and_b32 v49, 0xffff0000, v108
    v_lshlrev_b32 v50, 16, v109
    v_and_b32 v51, 0xffff0000, v109
    v_lshlrev_b32 v52, 16, v110
    v_and_b32 v53, 0xffff0000, v110
    v_lshlrev_b32 v54, 16, v111
    v_and_b32 v55, 0xffff0000, v111
    v_lshlrev_b32 v56, 16, v112
    v_and_b32 v57, 0xffff0000, v112
    v_lshlrev_b32 v58, 16, v113
    v_and_b32 v59, 0xffff0000, v113
    v_lshlrev_b32 v60, 16, v114
    v_and_b32 v61, 0xffff0000, v114
    v_lshlrev_b32 v62, 16, v115
    v_and_b32 v63, 0xffff0000, v115
    s_branch L_sequential_preLN__sliding_block__glu_gated_bilinear__prompt_kernel_Dresdone_124
L_sequential_preLN__sliding_block__glu_gated_bilinear__prompt_kernel_Dnores_123:
    v_mov_b32 v0, 0
    v_mov_b32 v1, 0
    v_mov_b32 v2, 0
    v_mov_b32 v3, 0
    v_mov_b32 v4, 0
    v_mov_b32 v5, 0
    v_mov_b32 v6, 0
    v_mov_b32 v7, 0
    v_mov_b32 v8, 0
    v_mov_b32 v9, 0
    v_mov_b32 v10, 0
    v_mov_b32 v11, 0
    v_mov_b32 v12, 0
    v_mov_b32 v13, 0
    v_mov_b32 v14, 0
    v_mov_b32 v15, 0
    v_mov_b32 v16, 0
    v_mov_b32 v17, 0
    v_mov_b32 v18, 0
    v_mov_b32 v19, 0
    v_mov_b32 v20, 0
    v_mov_b32 v21, 0
    v_mov_b32 v22, 0
    v_mov_b32 v23, 0
    v_mov_b32 v24, 0
    v_mov_b32 v25, 0
    v_mov_b32 v26, 0
    v_mov_b32 v27, 0
    v_mov_b32 v28, 0
    v_mov_b32 v29, 0
    v_mov_b32 v30, 0
    v_mov_b32 v31, 0
    v_mov_b32 v32, 0
    v_mov_b32 v33, 0
    v_mov_b32 v34, 0
    v_mov_b32 v35, 0
    v_mov_b32 v36, 0
    v_mov_b32 v37, 0
    v_mov_b32 v38, 0
    v_mov_b32 v39, 0
    v_mov_b32 v40, 0
    v_mov_b32 v41, 0
    v_mov_b32 v42, 0
    v_mov_b32 v43, 0
    v_mov_b32 v44, 0
    v_mov_b32 v45, 0
    v_mov_b32 v46, 0
    v_mov_b32 v47, 0
    v_mov_b32 v48, 0
    v_mov_b32 v49, 0
    v_mov_b32 v50, 0
    v_mov_b32 v51, 0
    v_mov_b32 v52, 0
    v_mov_b32 v53, 0
    v_mov_b32 v54, 0
    v_mov_b32 v55, 0
    v_mov_b32 v56, 0
    v_mov_b32 v57, 0
    v_mov_b32 v58, 0
    v_mov_b32 v59, 0
    v_mov_b32 v60, 0
    v_mov_b32 v61, 0
    v_mov_b32 v62, 0
    v_mov_b32 v63, 0
L_sequential_preLN__sliding_block__glu_gated_bilinear__prompt_kernel_Dresdone_124:
    s_barrier
    s_waitcnt vmcnt(0)
    s_barrier
    ds_read_b128 a[0:3], v64 offset:0
    ds_read_b128 a[4:7], v64 offset:256
    ds_read_b128 a[8:11], v64 offset:512
    ds_read_b128 a[12:15], v64 offset:768
    ds_read_b64_tr_b16 a[32:33], v68 offset:0
    ds_read_b64_tr_b16 a[34:35], v68 offset:2048
    ds_read_b64_tr_b16 a[36:37], v69 offset:0
    ds_read_b64_tr_b16 a[38:39], v69 offset:2048
    ds_read_b64_tr_b16 a[40:41], v70 offset:0
    ds_read_b64_tr_b16 a[42:43], v70 offset:2048
    ds_read_b64_tr_b16 a[44:45], v71 offset:0
    ds_read_b64_tr_b16 a[46:47], v71 offset:2048
    s_waitcnt lgkmcnt(0)
    v_mfma_f32_16x16x32_bf16 v[0:3], a[32:35], a[0:3], v[0:3]
    ds_read_b128 a[16:19], v65 offset:0
    ds_read_b128 a[20:23], v65 offset:256
    v_mfma_f32_16x16x32_bf16 v[4:7], a[32:35], a[4:7], v[4:7]
    ds_read_b128 a[24:27], v65 offset:512
    v_mfma_f32_16x16x32_bf16 v[8:11], a[32:35], a[8:11], v[8:11]
    ds_read_b128 a[28:31], v65 offset:768
    v_mfma_f32_16x16x32_bf16 v[12:15], a[32:35], a[12:15], v[12:15]
    ds_read_b64_tr_b16 a[48:49], v68 offset:8192
    v_mfma_f32_16x16x32_bf16 v[28:31], a[36:39], a[12:15], v[28:31]
    ds_read_b64_tr_b16 a[50:51], v68 offset:10240
    v_mfma_f32_16x16x32_bf16 v[24:27], a[36:39], a[8:11], v[24:27]
    ds_read_b64_tr_b16 a[52:53], v69 offset:8192
    v_mfma_f32_16x16x32_bf16 v[20:23], a[36:39], a[4:7], v[20:23]
    ds_read_b64_tr_b16 a[54:55], v69 offset:10240
    v_mfma_f32_16x16x32_bf16 v[16:19], a[36:39], a[0:3], v[16:19]
    ds_read_b64_tr_b16 a[56:57], v70 offset:8192
    v_mfma_f32_16x16x32_bf16 v[32:35], a[40:43], a[0:3], v[32:35]
    ds_read_b64_tr_b16 a[58:59], v70 offset:10240
    v_mfma_f32_16x16x32_bf16 v[36:39], a[40:43], a[4:7], v[36:39]
    ds_read_b64_tr_b16 a[60:61], v71 offset:8192
    v_mfma_f32_16x16x32_bf16 v[40:43], a[40:43], a[8:11], v[40:43]
    ds_read_b64_tr_b16 a[62:63], v71 offset:10240
    v_mfma_f32_16x16x32_bf16 v[44:47], a[40:43], a[12:15], v[44:47]
    v_mfma_f32_16x16x32_bf16 v[60:63], a[44:47], a[12:15], v[60:63]
    v_mfma_f32_16x16x32_bf16 v[56:59], a[44:47], a[8:11], v[56:59]
    v_mfma_f32_16x16x32_bf16 v[52:55], a[44:47], a[4:7], v[52:55]
    v_mfma_f32_16x16x32_bf16 v[48:51], a[44:47], a[0:3], v[48:51]
    s_waitcnt lgkmcnt(0)
    s_barrier
    v_mfma_f32_16x16x32_bf16 v[0:3], a[48:51], a[16:19], v[0:3]
    ds_read_b128 a[0:3], v64 offset:16384
    ds_read_b128 a[4:7], v64 offset:16640
    v_mfma_f32_16x16x32_bf16 v[4:7], a[48:51], a[20:23], v[4:7]
    ds_read_b128 a[8:11], v64 offset:16896
    v_mfma_f32_16x16x32_bf16 v[8:11], a[48:51], a[24:27], v[8:11]
    ds_read_b128 a[12:15], v64 offset:17152
    v_mfma_f32_16x16x32_bf16 v[12:15], a[48:51], a[28:31], v[12:15]
    ds_read_b64_tr_b16 a[32:33], v68 offset:16384
    v_mfma_f32_16x16x32_bf16 v[28:31], a[52:55], a[28:31], v[28:31]
    ds_read_b64_tr_b16 a[34:35], v68 offset:18432
    v_mfma_f32_16x16x32_bf16 v[24:27], a[52:55], a[24:27], v[24:27]
    ds_read_b64_tr_b16 a[36:37], v69 offset:16384
    v_mfma_f32_16x16x32_bf16 v[20:23], a[52:55], a[20:23], v[20:23]
    ds_read_b64_tr_b16 a[38:39], v69 offset:18432
    v_mfma_f32_16x16x32_bf16 v[16:19], a[52:55], a[16:19], v[16:19]
    ds_read_b64_tr_b16 a[40:41], v70 offset:16384
    v_mfma_f32_16x16x32_bf16 v[32:35], a[56:59], a[16:19], v[32:35]
    ds_read_b64_tr_b16 a[42:43], v70 offset:18432
    v_mfma_f32_16x16x32_bf16 v[36:39], a[56:59], a[20:23], v[36:39]
    ds_read_b64_tr_b16 a[44:45], v71 offset:16384
    v_mfma_f32_16x16x32_bf16 v[40:43], a[56:59], a[24:27], v[40:43]
    ds_read_b64_tr_b16 a[46:47], v71 offset:18432
    v_mfma_f32_16x16x32_bf16 v[44:47], a[56:59], a[28:31], v[44:47]
    v_mfma_f32_16x16x32_bf16 v[60:63], a[60:63], a[28:31], v[60:63]
    v_mfma_f32_16x16x32_bf16 v[56:59], a[60:63], a[24:27], v[56:59]
    v_mfma_f32_16x16x32_bf16 v[52:55], a[60:63], a[20:23], v[52:55]
    v_mfma_f32_16x16x32_bf16 v[48:51], a[60:63], a[16:19], v[48:51]
    s_waitcnt lgkmcnt(0)
    v_mfma_f32_16x16x32_bf16 v[0:3], a[32:35], a[0:3], v[0:3]
    ds_read_b128 a[16:19], v65 offset:16384
    ds_read_b128 a[20:23], v65 offset:16640
    v_mfma_f32_16x16x32_bf16 v[4:7], a[32:35], a[4:7], v[4:7]
    ds_read_b128 a[24:27], v65 offset:16896
    v_mfma_f32_16x16x32_bf16 v[8:11], a[32:35], a[8:11], v[8:11]
    ds_read_b128 a[28:31], v65 offset:17152
    v_mfma_f32_16x16x32_bf16 v[12:15], a[32:35], a[12:15], v[12:15]
    ds_read_b64_tr_b16 a[48:49], v68 offset:24576
    v_mfma_f32_16x16x32_bf16 v[28:31], a[36:39], a[12:15], v[28:31]
    ds_read_b64_tr_b16 a[50:51], v68 offset:26624
    v_mfma_f32_16x16x32_bf16 v[24:27], a[36:39], a[8:11], v[24:27]
    ds_read_b64_tr_b16 a[52:53], v69 offset:24576
    v_mfma_f32_16x16x32_bf16 v[20:23], a[36:39], a[4:7], v[20:23]
    ds_read_b64_tr_b16 a[54:55], v69 offset:26624
    v_mfma_f32_16x16x32_bf16 v[16:19], a[36:39], a[0:3], v[16:19]
    ds_read_b64_tr_b16 a[56:57], v70 offset:24576
    v_mfma_f32_16x16x32_bf16 v[32:35], a[40:43], a[0:3], v[32:35]
    ds_read_b64_tr_b16 a[58:59], v70 offset:26624
    v_mfma_f32_16x16x32_bf16 v[36:39], a[40:43], a[4:7], v[36:39]
    ds_read_b64_tr_b16 a[60:61], v71 offset:24576
    v_mfma_f32_16x16x32_bf16 v[40:43], a[40:43], a[8:11], v[40:43]
    ds_read_b64_tr_b16 a[62:63], v71 offset:26624
    v_mfma_f32_16x16x32_bf16 v[44:47], a[40:43], a[12:15], v[44:47]
    v_mfma_f32_16x16x32_bf16 v[60:63], a[44:47], a[12:15], v[60:63]
    v_mfma_f32_16x16x32_bf16 v[56:59], a[44:47], a[8:11], v[56:59]
    v_mfma_f32_16x16x32_bf16 v[52:55], a[44:47], a[4:7], v[52:55]
    v_mfma_f32_16x16x32_bf16 v[48:51], a[44:47], a[0:3], v[48:51]
    s_waitcnt lgkmcnt(0)
    s_barrier
    v_mfma_f32_16x16x32_bf16 v[0:3], a[48:51], a[16:19], v[0:3]
    ds_read_b128 a[0:3], v66 offset:0
    ds_read_b128 a[4:7], v66 offset:256
    v_mfma_f32_16x16x32_bf16 v[4:7], a[48:51], a[20:23], v[4:7]
    ds_read_b128 a[8:11], v66 offset:512
    v_mfma_f32_16x16x32_bf16 v[8:11], a[48:51], a[24:27], v[8:11]
    ds_read_b128 a[12:15], v66 offset:768
    v_mfma_f32_16x16x32_bf16 v[12:15], a[48:51], a[28:31], v[12:15]
    ds_read_b64_tr_b16 a[32:33], v72 offset:0
    v_mfma_f32_16x16x32_bf16 v[28:31], a[52:55], a[28:31], v[28:31]
    ds_read_b64_tr_b16 a[34:35], v72 offset:2048
    v_mfma_f32_16x16x32_bf16 v[24:27], a[52:55], a[24:27], v[24:27]
    ds_read_b64_tr_b16 a[36:37], v73 offset:0
    v_mfma_f32_16x16x32_bf16 v[20:23], a[52:55], a[20:23], v[20:23]
    ds_read_b64_tr_b16 a[38:39], v73 offset:2048
    v_mfma_f32_16x16x32_bf16 v[16:19], a[52:55], a[16:19], v[16:19]
    ds_read_b64_tr_b16 a[40:41], v74 offset:0
    v_mfma_f32_16x16x32_bf16 v[32:35], a[56:59], a[16:19], v[32:35]
    ds_read_b64_tr_b16 a[42:43], v74 offset:2048
    v_mfma_f32_16x16x32_bf16 v[36:39], a[56:59], a[20:23], v[36:39]
    ds_read_b64_tr_b16 a[44:45], v75 offset:0
    v_mfma_f32_16x16x32_bf16 v[40:43], a[56:59], a[24:27], v[40:43]
    ds_read_b64_tr_b16 a[46:47], v75 offset:2048
    v_mfma_f32_16x16x32_bf16 v[44:47], a[56:59], a[28:31], v[44:47]
    v_mfma_f32_16x16x32_bf16 v[60:63], a[60:63], a[28:31], v[60:63]
    v_mfma_f32_16x16x32_bf16 v[56:59], a[60:63], a[24:27], v[56:59]
    v_mfma_f32_16x16x32_bf16 v[52:55], a[60:63], a[20:23], v[52:55]
    v_mfma_f32_16x16x32_bf16 v[48:51], a[60:63], a[16:19], v[48:51]
    s_waitcnt lgkmcnt(0)
    v_mfma_f32_16x16x32_bf16 v[0:3], a[32:35], a[0:3], v[0:3]
    ds_read_b128 a[16:19], v67 offset:0
    ds_read_b128 a[20:23], v67 offset:256
    v_mfma_f32_16x16x32_bf16 v[4:7], a[32:35], a[4:7], v[4:7]
    ds_read_b128 a[24:27], v67 offset:512
    v_mfma_f32_16x16x32_bf16 v[8:11], a[32:35], a[8:11], v[8:11]
    ds_read_b128 a[28:31], v67 offset:768
    v_mfma_f32_16x16x32_bf16 v[12:15], a[32:35], a[12:15], v[12:15]
    ds_read_b64_tr_b16 a[48:49], v72 offset:8192
    v_mfma_f32_16x16x32_bf16 v[28:31], a[36:39], a[12:15], v[28:31]
    ds_read_b64_tr_b16 a[50:51], v72 offset:10240
    v_mfma_f32_16x16x32_bf16 v[24:27], a[36:39], a[8:11], v[24:27]
    ds_read_b64_tr_b16 a[52:53], v73 offset:8192
    v_mfma_f32_16x16x32_bf16 v[20:23], a[36:39], a[4:7], v[20:23]
    ds_read_b64_tr_b16 a[54:55], v73 offset:10240
    v_mfma_f32_16x16x32_bf16 v[16:19], a[36:39], a[0:3], v[16:19]
    ds_read_b64_tr_b16 a[56:57], v74 offset:8192
    v_mfma_f32_16x16x32_bf16 v[32:35], a[40:43], a[0:3], v[32:35]
    ds_read_b64_tr_b16 a[58:59], v74 offset:10240
    v_mfma_f32_16x16x32_bf16 v[36:39], a[40:43], a[4:7], v[36:39]
    ds_read_b64_tr_b16 a[60:61], v75 offset:8192
    v_mfma_f32_16x16x32_bf16 v[40:43], a[40:43], a[8:11], v[40:43]
    ds_read_b64_tr_b16 a[62:63], v75 offset:10240
    v_mfma_f32_16x16x32_bf16 v[44:47], a[40:43], a[12:15], v[44:47]
    v_mfma_f32_16x16x32_bf16 v[60:63], a[44:47], a[12:15], v[60:63]
    v_mfma_f32_16x16x32_bf16 v[56:59], a[44:47], a[8:11], v[56:59]
    v_mfma_f32_16x16x32_bf16 v[52:55], a[44:47], a[4:7], v[52:55]
    v_mfma_f32_16x16x32_bf16 v[48:51], a[44:47], a[0:3], v[48:51]
    s_waitcnt lgkmcnt(0)
    s_barrier
    v_mfma_f32_16x16x32_bf16 v[0:3], a[48:51], a[16:19], v[0:3]
    ds_read_b128 a[0:3], v66 offset:16384
    ds_read_b128 a[4:7], v66 offset:16640
    v_mfma_f32_16x16x32_bf16 v[4:7], a[48:51], a[20:23], v[4:7]
    ds_read_b128 a[8:11], v66 offset:16896
    v_mfma_f32_16x16x32_bf16 v[8:11], a[48:51], a[24:27], v[8:11]
    ds_read_b128 a[12:15], v66 offset:17152
    v_mfma_f32_16x16x32_bf16 v[12:15], a[48:51], a[28:31], v[12:15]
    ds_read_b64_tr_b16 a[32:33], v72 offset:16384
    v_mfma_f32_16x16x32_bf16 v[28:31], a[52:55], a[28:31], v[28:31]
    ds_read_b64_tr_b16 a[34:35], v72 offset:18432
    v_mfma_f32_16x16x32_bf16 v[24:27], a[52:55], a[24:27], v[24:27]
    ds_read_b64_tr_b16 a[36:37], v73 offset:16384
    v_mfma_f32_16x16x32_bf16 v[20:23], a[52:55], a[20:23], v[20:23]
    ds_read_b64_tr_b16 a[38:39], v73 offset:18432
    v_mfma_f32_16x16x32_bf16 v[16:19], a[52:55], a[16:19], v[16:19]
    ds_read_b64_tr_b16 a[40:41], v74 offset:16384
    v_mfma_f32_16x16x32_bf16 v[32:35], a[56:59], a[16:19], v[32:35]
    ds_read_b64_tr_b16 a[42:43], v74 offset:18432
    v_mfma_f32_16x16x32_bf16 v[36:39], a[56:59], a[20:23], v[36:39]
    ds_read_b64_tr_b16 a[44:45], v75 offset:16384
    v_mfma_f32_16x16x32_bf16 v[40:43], a[56:59], a[24:27], v[40:43]
    ds_read_b64_tr_b16 a[46:47], v75 offset:18432
    v_mfma_f32_16x16x32_bf16 v[44:47], a[56:59], a[28:31], v[44:47]
    v_mfma_f32_16x16x32_bf16 v[60:63], a[60:63], a[28:31], v[60:63]
    v_mfma_f32_16x16x32_bf16 v[56:59], a[60:63], a[24:27], v[56:59]
    v_mfma_f32_16x16x32_bf16 v[52:55], a[60:63], a[20:23], v[52:55]
    v_mfma_f32_16x16x32_bf16 v[48:51], a[60:63], a[16:19], v[48:51]
    s_waitcnt lgkmcnt(0)
    v_mfma_f32_16x16x32_bf16 v[0:3], a[32:35], a[0:3], v[0:3]
    ds_read_b128 a[16:19], v67 offset:16384
    ds_read_b128 a[20:23], v67 offset:16640
    v_mfma_f32_16x16x32_bf16 v[4:7], a[32:35], a[4:7], v[4:7]
    ds_read_b128 a[24:27], v67 offset:16896
    v_mfma_f32_16x16x32_bf16 v[8:11], a[32:35], a[8:11], v[8:11]
    ds_read_b128 a[28:31], v67 offset:17152
    v_mfma_f32_16x16x32_bf16 v[12:15], a[32:35], a[12:15], v[12:15]
    ds_read_b64_tr_b16 a[48:49], v72 offset:24576
    v_mfma_f32_16x16x32_bf16 v[28:31], a[36:39], a[12:15], v[28:31]
    ds_read_b64_tr_b16 a[50:51], v72 offset:26624
    v_mfma_f32_16x16x32_bf16 v[24:27], a[36:39], a[8:11], v[24:27]
    ds_read_b64_tr_b16 a[52:53], v73 offset:24576
    v_mfma_f32_16x16x32_bf16 v[20:23], a[36:39], a[4:7], v[20:23]
    ds_read_b64_tr_b16 a[54:55], v73 offset:26624
    v_mfma_f32_16x16x32_bf16 v[16:19], a[36:39], a[0:3], v[16:19]
    ds_read_b64_tr_b16 a[56:57], v74 offset:24576
    v_mfma_f32_16x16x32_bf16 v[32:35], a[40:43], a[0:3], v[32:35]
    ds_read_b64_tr_b16 a[58:59], v74 offset:26624
    v_mfma_f32_16x16x32_bf16 v[36:39], a[40:43], a[4:7], v[36:39]
    ds_read_b64_tr_b16 a[60:61], v75 offset:24576
    v_mfma_f32_16x16x32_bf16 v[40:43], a[40:43], a[8:11], v[40:43]
    ds_read_b64_tr_b16 a[62:63], v75 offset:26624
    v_mfma_f32_16x16x32_bf16 v[44:47], a[40:43], a[12:15], v[44:47]
    v_mfma_f32_16x16x32_bf16 v[60:63], a[44:47], a[12:15], v[60:63]
    v_mfma_f32_16x16x32_bf16 v[56:59], a[44:47], a[8:11], v[56:59]
    v_mfma_f32_16x16x32_bf16 v[52:55], a[44:47], a[4:7], v[52:55]
    v_mfma_f32_16x16x32_bf16 v[48:51], a[44:47], a[0:3], v[48:51]
    s_waitcnt lgkmcnt(0)
    s_barrier
    v_mfma_f32_16x16x32_bf16 v[0:3], a[48:51], a[16:19], v[0:3]
    ds_read_b128 a[0:3], v64 offset:0
    ds_read_b128 a[4:7], v64 offset:256
    v_mfma_f32_16x16x32_bf16 v[4:7], a[48:51], a[20:23], v[4:7]
    ds_read_b128 a[8:11], v64 offset:512
    v_mfma_f32_16x16x32_bf16 v[8:11], a[48:51], a[24:27], v[8:11]
    ds_read_b128 a[12:15], v64 offset:768
    v_mfma_f32_16x16x32_bf16 v[12:15], a[48:51], a[28:31], v[12:15]
    ds_read_b64_tr_b16 a[32:33], v68 offset:0
    v_mfma_f32_16x16x32_bf16 v[28:31], a[52:55], a[28:31], v[28:31]
    ds_read_b64_tr_b16 a[34:35], v68 offset:2048
    v_mfma_f32_16x16x32_bf16 v[24:27], a[52:55], a[24:27], v[24:27]
    ds_read_b64_tr_b16 a[36:37], v69 offset:0
    v_mfma_f32_16x16x32_bf16 v[20:23], a[52:55], a[20:23], v[20:23]
    ds_read_b64_tr_b16 a[38:39], v69 offset:2048
    v_mfma_f32_16x16x32_bf16 v[16:19], a[52:55], a[16:19], v[16:19]
    ds_read_b64_tr_b16 a[40:41], v70 offset:0
    v_mfma_f32_16x16x32_bf16 v[32:35], a[56:59], a[16:19], v[32:35]
    ds_read_b64_tr_b16 a[42:43], v70 offset:2048
    v_mfma_f32_16x16x32_bf16 v[36:39], a[56:59], a[20:23], v[36:39]
    ds_read_b64_tr_b16 a[44:45], v71 offset:0
    v_mfma_f32_16x16x32_bf16 v[40:43], a[56:59], a[24:27], v[40:43]
    ds_read_b64_tr_b16 a[46:47], v71 offset:2048
    v_mfma_f32_16x16x32_bf16 v[44:47], a[56:59], a[28:31], v[44:47]
    v_mfma_f32_16x16x32_bf16 v[60:63], a[60:63], a[28:31], v[60:63]
    v_mfma_f32_16x16x32_bf16 v[56:59], a[60:63], a[24:27], v[56:59]
    v_mfma_f32_16x16x32_bf16 v[52:55], a[60:63], a[20:23], v[52:55]
    v_mfma_f32_16x16x32_bf16 v[48:51], a[60:63], a[16:19], v[48:51]
    s_waitcnt lgkmcnt(0)
    s_lshr_b32 s46, s60, 2
    s_sub_u32 s46, s46, 2
L_sequential_preLN__sliding_block__glu_gated_bilinear__prompt_kernel_Dcloop_127:
    v_mfma_f32_16x16x32_bf16 v[0:3], a[32:35], a[0:3], v[0:3]
    ds_read_b128 a[16:19], v65 offset:0
    ds_read_b128 a[20:23], v65 offset:256
    v_mfma_f32_16x16x32_bf16 v[4:7], a[32:35], a[4:7], v[4:7]
    ds_read_b128 a[24:27], v65 offset:512
    v_mfma_f32_16x16x32_bf16 v[8:11], a[32:35], a[8:11], v[8:11]
    ds_read_b128 a[28:31], v65 offset:768
    v_mfma_f32_16x16x32_bf16 v[12:15], a[32:35], a[12:15], v[12:15]
    ds_read_b64_tr_b16 a[48:49], v68 offset:8192
    v_mfma_f32_16x16x32_bf16 v[28:31], a[36:39], a[12:15], v[28:31]
    ds_read_b64_tr_b16 a[50:51], v68 offset:10240
    v_mfma_f32_16x16x32_bf16 v[24:27], a[36:39], a[8:11], v[24:27]
    ds_read_b64_tr_b16 a[52:53], v69 offset:8192
    v_mfma_f32_16x16x32_bf16 v[20:23], a[36:39], a[4:7], v[20:23]
    ds_read_b64_tr_b16 a[54:55], v69 offset:10240
    v_mfma_f32_16x16x32_bf16 v[16:19], a[36:39], a[0:3], v[16:19]
    ds_read_b64_tr_b16 a[56:57], v70 offset:8192
    v_mfma_f32_16x16x32_bf16 v[32:35], a[40:43], a[0:3], v[32:35]
    ds_read_b64_tr_b16 a[58:59], v70 offset:10240
    v_mfma_f32_16x16x32_bf16 v[36:39], a[40:43], a[4:7], v[36:39]
    ds_read_b64_tr_b16 a[60:61], v71 offset:8192
    v_mfma_f32_16x16x32_bf16 v[40:43], a[40:43], a[8:11], v[40:43]
    ds_read_b64_tr_b16 a[62:63], v71 offset:10240
    v_mfma_f32_16x16x32_bf16 v[44:47], a[40:43], a[12:15], v[44:47]
    v_mfma_f32_16x16x32_bf16 v[60:63], a[44:47], a[12:15], v[60:63]
    v_mfma_f32_16x16x32_bf16 v[56:59], a[44:47], a[8:11], v[56:59]
    v_mfma_f32_16x16x32_bf16 v[52:55], a[44:47], a[4:7], v[52:55]
    v_mfma_f32_16x16x32_bf16 v[48:51], a[44:47], a[0:3], v[48:51]
    s_waitcnt lgkmcnt(0)
    s_barrier
    v_mfma_f32_16x16x32_bf16 v[0:3], a[48:51], a[16:19], v[0:3]
    ds_read_b128 a[0:3], v64 offset:16384
    ds_read_b128 a[4:7], v64 offset:16640
    v_mfma_f32_16x16x32_bf16 v[4:7], a[48:51], a[20:23], v[4:7]
    ds_read_b128 a[8:11], v64 offset:16896
    v_mfma_f32_16x16x32_bf16 v[8:11], a[48:51], a[24:27], v[8:11]
    ds_read_b128 a[12:15], v64 offset:17152
    v_mfma_f32_16x16x32_bf16 v[12:15], a[48:51], a[28:31], v[12:15]
    ds_read_b64_tr_b16 a[32:33], v68 offset:16384
    v_mfma_f32_16x16x32_bf16 v[28:31], a[52:55], a[28:31], v[28:31]
    ds_read_b64_tr_b16 a[34:35], v68 offset:18432
    v_mfma_f32_16x16x32_bf16 v[24:27], a[52:55], a[24:27], v[24:27]
    ds_read_b64_tr_b16 a[36:37], v69 offset:16384
    v_mfma_f32_16x16x32_bf16 v[20:23], a[52:55], a[20:23], v[20:23]
    ds_read_b64_tr_b16 a[38:39], v69 offset:18432
    v_mfma_f32_16x16x32_bf16 v[16:19], a[52:55], a[16:19], v[16:19]
    ds_read_b64_tr_b16 a[40:41], v70 offset:16384
    v_mfma_f32_16x16x32_bf16 v[32:35], a[56:59], a[16:19], v[32:35]
    ds_read_b64_tr_b16 a[42:43], v70 offset:18432
    v_mfma_f32_16x16x32_bf16 v[36:39], a[56:59], a[20:23], v[36:39]
    ds_read_b64_tr_b16 a[44:45], v71 offset:16384
    v_mfma_f32_16x16x32_bf16 v[40:43], a[56:59], a[24:27], v[40:43]
    ds_read_b64_tr_b16 a[46:47], v71 offset:18432
    v_mfma_f32_16x16x32_bf16 v[44:47], a[56:59], a[28:31], v[44:47]
    v_mfma_f32_16x16x32_bf16 v[60:63], a[60:63], a[28:31], v[60:63]
    v_mfma_f32_16x16x32_bf16 v[56:59], a[60:63], a[24:27], v[56:59]
    v_mfma_f32_16x16x32_bf16 v[52:55], a[60:63], a[20:23], v[52:55]
    v_mfma_f32_16x16x32_bf16 v[48:51], a[60:63], a[16:19], v[48:51]
    s_waitcnt lgkmcnt(0)
    v_mfma_f32_16x16x32_bf16 v[0:3], a[32:35], a[0:3], v[0:3]
    ds_read_b128 a[16:19], v65 offset:16384
    ds_read_b128 a[20:23], v65 offset:16640
    v_mfma_f32_16x16x32_bf16 v[4:7], a[32:35], a[4:7], v[4:7]
    ds_read_b128 a[24:27], v65 offset:16896
    v_mfma_f32_16x16x32_bf16 v[8:11], a[32:35], a[8:11], v[8:11]
    ds_read_b128 a[28:31], v65 offset:17152
    v_mfma_f32_16x16x32_bf16 v[12:15], a[32:35], a[12:15], v[12:15]
    ds_read_b64_tr_b16 a[48:49], v68 offset:24576
    v_mfma_f32_16x16x32_bf16 v[28:31], a[36:39], a[12:15], v[28:31]
    ds_read_b64_tr_b16 a[50:51], v68 offset:26624
    v_mfma_f32_16x16x32_bf16 v[24:27], a[36:39], a[8:11], v[24:27]
    ds_read_b64_tr_b16 a[52:53], v69 offset:24576
    v_mfma_f32_16x16x32_bf16 v[20:23], a[36:39], a[4:7], v[20:23]
    ds_read_b64_tr_b16 a[54:55], v69 offset:26624
    v_mfma_f32_16x16x32_bf16 v[16:19], a[36:39], a[0:3], v[16:19]
    ds_read_b64_tr_b16 a[56:57], v70 offset:24576
    v_mfma_f32_16x16x32_bf16 v[32:35], a[40:43], a[0:3], v[32:35]
    ds_read_b64_tr_b16 a[58:59], v70 offset:26624
    v_mfma_f32_16x16x32_bf16 v[36:39], a[40:43], a[4:7], v[36:39]
    ds_read_b64_tr_b16 a[60:61], v71 offset:24576
    v_mfma_f32_16x16x32_bf16 v[40:43], a[40:43], a[8:11], v[40:43]
    ds_read_b64_tr_b16 a[62:63], v71 offset:26624
    v_mfma_f32_16x16x32_bf16 v[44:47], a[40:43], a[12:15], v[44:47]
    v_mfma_f32_16x16x32_bf16 v[60:63], a[44:47], a[12:15], v[60:63]
    v_mfma_f32_16x16x32_bf16 v[56:59], a[44:47], a[8:11], v[56:59]
    v_mfma_f32_16x16x32_bf16 v[52:55], a[44:47], a[4:7], v[52:55]
    v_mfma_f32_16x16x32_bf16 v[48:51], a[44:47], a[0:3], v[48:51]
    s_waitcnt lgkmcnt(0)
    s_barrier
    v_mfma_f32_16x16x32_bf16 v[0:3], a[48:51], a[16:19], v[0:3]
    ds_read_b128 a[0:3], v66 offset:0
    ds_read_b128 a[4:7], v66 offset:256
    v_mfma_f32_16x16x32_bf16 v[4:7], a[48:51], a[20:23], v[4:7]
    ds_read_b128 a[8:11], v66 offset:512
    v_mfma_f32_16x16x32_bf16 v[8:11], a[48:51], a[24:27], v[8:11]
    ds_read_b128 a[12:15], v66 offset:768
    v_mfma_f32_16x16x32_bf16 v[12:15], a[48:51], a[28:31], v[12:15]
    ds_read_b64_tr_b16 a[32:33], v72 offset:0
    v_mfma_f32_16x16x32_bf16 v[28:31], a[52:55], a[28:31], v[28:31]
    ds_read_b64_tr_b16 a[34:35], v72 offset:2048
    v_mfma_f32_16x16x32_bf16 v[24:27], a[52:55], a[24:27], v[24:27]
    ds_read_b64_tr_b16 a[36:37], v73 offset:0
    v_mfma_f32_16x16x32_bf16 v[20:23], a[52:55], a[20:23], v[20:23]
    ds_read_b64_tr_b16 a[38:39], v73 offset:2048
    v_mfma_f32_16x16x32_bf16 v[16:19], a[52:55], a[16:19], v[16:19]
    ds_read_b64_tr_b16 a[40:41], v74 offset:0
    v_mfma_f32_16x16x32_bf16 v[32:35], a[56:59], a[16:19], v[32:35]
    ds_read_b64_tr_b16 a[42:43], v74 offset:2048
    v_mfma_f32_16x16x32_bf16 v[36:39], a[56:59], a[20:23], v[36:39]
    ds_read_b64_tr_b16 a[44:45], v75 offset:0
    v_mfma_f32_16x16x32_bf16 v[40:43], a[56:59], a[24:27], v[40:43]
    ds_read_b64_tr_b16 a[46:47], v75 offset:2048
    v_mfma_f32_16x16x32_bf16 v[44:47], a[56:59], a[28:31], v[44:47]
    v_mfma_f32_16x16x32_bf16 v[60:63], a[60:63], a[28:31], v[60:63]
    v_mfma_f32_16x16x32_bf16 v[56:59], a[60:63], a[24:27], v[56:59]
    v_mfma_f32_16x16x32_bf16 v[52:55], a[60:63], a[20:23], v[52:55]
    v_mfma_f32_16x16x32_bf16 v[48:51], a[60:63], a[16:19], v[48:51]
    s_waitcnt lgkmcnt(0)
    v_mfma_f32_16x16x32_bf16 v[0:3], a[32:35], a[0:3], v[0:3]
    ds_read_b128 a[16:19], v67 offset:0
    ds_read_b128 a[20:23], v67 offset:256
    v_mfma_f32_16x16x32_bf16 v[4:7], a[32:35], a[4:7], v[4:7]
    ds_read_b128 a[24:27], v67 offset:512
    v_mfma_f32_16x16x32_bf16 v[8:11], a[32:35], a[8:11], v[8:11]
    ds_read_b128 a[28:31], v67 offset:768
    v_mfma_f32_16x16x32_bf16 v[12:15], a[32:35], a[12:15], v[12:15]
    ds_read_b64_tr_b16 a[48:49], v72 offset:8192
    v_mfma_f32_16x16x32_bf16 v[28:31], a[36:39], a[12:15], v[28:31]
    ds_read_b64_tr_b16 a[50:51], v72 offset:10240
    v_mfma_f32_16x16x32_bf16 v[24:27], a[36:39], a[8:11], v[24:27]
    ds_read_b64_tr_b16 a[52:53], v73 offset:8192
    v_mfma_f32_16x16x32_bf16 v[20:23], a[36:39], a[4:7], v[20:23]
    ds_read_b64_tr_b16 a[54:55], v73 offset:10240
    v_mfma_f32_16x16x32_bf16 v[16:19], a[36:39], a[0:3], v[16:19]
    ds_read_b64_tr_b16 a[56:57], v74 offset:8192
    v_mfma_f32_16x16x32_bf16 v[32:35], a[40:43], a[0:3], v[32:35]
    ds_read_b64_tr_b16 a[58:59], v74 offset:10240
    v_mfma_f32_16x16x32_bf16 v[36:39], a[40:43], a[4:7], v[36:39]
    ds_read_b64_tr_b16 a[60:61], v75 offset:8192
    v_mfma_f32_16x16x32_bf16 v[40:43], a[40:43], a[8:11], v[40:43]
    ds_read_b64_tr_b16 a[62:63], v75 offset:10240
    v_mfma_f32_16x16x32_bf16 v[44:47], a[40:43], a[12:15], v[44:47]
    v_mfma_f32_16x16x32_bf16 v[60:63], a[44:47], a[12:15], v[60:63]
    v_mfma_f32_16x16x32_bf16 v[56:59], a[44:47], a[8:11], v[56:59]
    v_mfma_f32_16x16x32_bf16 v[52:55], a[44:47], a[4:7], v[52:55]
    v_mfma_f32_16x16x32_bf16 v[48:51], a[44:47], a[0:3], v[48:51]
    s_waitcnt lgkmcnt(0)
    s_barrier
    v_mfma_f32_16x16x32_bf16 v[0:3], a[48:51], a[16:19], v[0:3]
    ds_read_b128 a[0:3], v66 offset:16384
    ds_read_b128 a[4:7], v66 offset:16640
    v_mfma_f32_16x16x32_bf16 v[4:7], a[48:51], a[20:23], v[4:7]
    ds_read_b128 a[8:11], v66 offset:16896
    v_mfma_f32_16x16x32_bf16 v[8:11], a[48:51], a[24:27], v[8:11]
    ds_read_b128 a[12:15], v66 offset:17152
    v_mfma_f32_16x16x32_bf16 v[12:15], a[48:51], a[28:31], v[12:15]
    ds_read_b64_tr_b16 a[32:33], v72 offset:16384
    v_mfma_f32_16x16x32_bf16 v[28:31], a[52:55], a[28:31], v[28:31]
    ds_read_b64_tr_b16 a[34:35], v72 offset:18432
    v_mfma_f32_16x16x32_bf16 v[24:27], a[52:55], a[24:27], v[24:27]
    ds_read_b64_tr_b16 a[36:37], v73 offset:16384
    v_mfma_f32_16x16x32_bf16 v[20:23], a[52:55], a[20:23], v[20:23]
    ds_read_b64_tr_b16 a[38:39], v73 offset:18432
    v_mfma_f32_16x16x32_bf16 v[16:19], a[52:55], a[16:19], v[16:19]
    ds_read_b64_tr_b16 a[40:41], v74 offset:16384
    v_mfma_f32_16x16x32_bf16 v[32:35], a[56:59], a[16:19], v[32:35]
    ds_read_b64_tr_b16 a[42:43], v74 offset:18432
    v_mfma_f32_16x16x32_bf16 v[36:39], a[56:59], a[20:23], v[36:39]
    ds_read_b64_tr_b16 a[44:45], v75 offset:16384
    v_mfma_f32_16x16x32_bf16 v[40:43], a[56:59], a[24:27], v[40:43]
    ds_read_b64_tr_b16 a[46:47], v75 offset:18432
    v_mfma_f32_16x16x32_bf16 v[44:47], a[56:59], a[28:31], v[44:47]
    v_mfma_f32_16x16x32_bf16 v[60:63], a[60:63], a[28:31], v[60:63]
    v_mfma_f32_16x16x32_bf16 v[56:59], a[60:63], a[24:27], v[56:59]
    v_mfma_f32_16x16x32_bf16 v[52:55], a[60:63], a[20:23], v[52:55]
    v_mfma_f32_16x16x32_bf16 v[48:51], a[60:63], a[16:19], v[48:51]
    s_waitcnt lgkmcnt(0)
    v_mfma_f32_16x16x32_bf16 v[0:3], a[32:35], a[0:3], v[0:3]
    ds_read_b128 a[16:19], v67 offset:16384
    ds_read_b128 a[20:23], v67 offset:16640
    v_mfma_f32_16x16x32_bf16 v[4:7], a[32:35], a[4:7], v[4:7]
    ds_read_b128 a[24:27], v67 offset:16896
    v_mfma_f32_16x16x32_bf16 v[8:11], a[32:35], a[8:11], v[8:11]
    ds_read_b128 a[28:31], v67 offset:17152
    v_mfma_f32_16x16x32_bf16 v[12:15], a[32:35], a[12:15], v[12:15]
    ds_read_b64_tr_b16 a[48:49], v72 offset:24576
    v_mfma_f32_16x16x32_bf16 v[28:31], a[36:39], a[12:15], v[28:31]
    ds_read_b64_tr_b16 a[50:51], v72 offset:26624
    v_mfma_f32_16x16x32_bf16 v[24:27], a[36:39], a[8:11], v[24:27]
    ds_read_b64_tr_b16 a[52:53], v73 offset:24576
    v_mfma_f32_16x16x32_bf16 v[20:23], a[36:39], a[4:7], v[20:23]
    ds_read_b64_tr_b16 a[54:55], v73 offset:26624
    v_mfma_f32_16x16x32_bf16 v[16:19], a[36:39], a[0:3], v[16:19]
    ds_read_b64_tr_b16 a[56:57], v74 offset:24576
    v_mfma_f32_16x16x32_bf16 v[32:35], a[40:43], a[0:3], v[32:35]
    ds_read_b64_tr_b16 a[58:59], v74 offset:26624
    v_mfma_f32_16x16x32_bf16 v[36:39], a[40:43], a[4:7], v[36:39]
    ds_read_b64_tr_b16 a[60:61], v75 offset:24576
    v_mfma_f32_16x16x32_bf16 v[40:43], a[40:43], a[8:11], v[40:43]
    ds_read_b64_tr_b16 a[62:63], v75 offset:26624
    v_mfma_f32_16x16x32_bf16 v[44:47], a[40:43], a[12:15], v[44:47]
    v_mfma_f32_16x16x32_bf16 v[60:63], a[44:47], a[12:15], v[60:63]
    v_mfma_f32_16x16x32_bf16 v[56:59], a[44:47], a[8:11], v[56:59]
    v_mfma_f32_16x16x32_bf16 v[52:55], a[44:47], a[4:7], v[52:55]
    v_mfma_f32_16x16x32_bf16 v[48:51], a[44:47], a[0:3], v[48:51]
    s_waitcnt lgkmcnt(0)
    s_barrier
    v_mfma_f32_16x16x32_bf16 v[0:3], a[48:51], a[16:19], v[0:3]
    ds_read_b128 a[0:3], v64 offset:0
    ds_read_b128 a[4:7], v64 offset:256
    v_mfma_f32_16x16x32_bf16 v[4:7], a[48:51], a[20:23], v[4:7]
    ds_read_b128 a[8:11], v64 offset:512
    v_mfma_f32_16x16x32_bf16 v[8:11], a[48:51], a[24:27], v[8:11]
    ds_read_b128 a[12:15], v64 offset:768
    v_mfma_f32_16x16x32_bf16 v[12:15], a[48:51], a[28:31], v[12:15]
    ds_read_b64_tr_b16 a[32:33], v68 offset:0
    v_mfma_f32_16x16x32_bf16 v[28:31], a[52:55], a[28:31], v[28:31]
    ds_read_b64_tr_b16 a[34:35], v68 offset:2048
    v_mfma_f32_16x16x32_bf16 v[24:27], a[52:55], a[24:27], v[24:27]
    ds_read_b64_tr_b16 a[36:37], v69 offset:0
    v_mfma_f32_16x16x32_bf16 v[20:23], a[52:55], a[20:23], v[20:23]
    ds_read_b64_tr_b16 a[38:39], v69 offset:2048
    v_mfma_f32_16x16x32_bf16 v[16:19], a[52:55], a[16:19], v[16:19]
    ds_read_b64_tr_b16 a[40:41], v70 offset:0
    v_mfma_f32_16x16x32_bf16 v[32:35], a[56:59], a[16:19], v[32:35]
    ds_read_b64_tr_b16 a[42:43], v70 offset:2048
    v_mfma_f32_16x16x32_bf16 v[36:39], a[56:59], a[20:23], v[36:39]
    ds_read_b64_tr_b16 a[44:45], v71 offset:0
    v_mfma_f32_16x16x32_bf16 v[40:43], a[56:59], a[24:27], v[40:43]
    ds_read_b64_tr_b16 a[46:47], v71 offset:2048
    v_mfma_f32_16x16x32_bf16 v[44:47], a[56:59], a[28:31], v[44:47]
    v_mfma_f32_16x16x32_bf16 v[60:63], a[60:63], a[28:31], v[60:63]
    v_mfma_f32_16x16x32_bf16 v[56:59], a[60:63], a[24:27], v[56:59]
    s_sub_u32 s46, s46, 1
    s_cmp_lg_u32 s46, 0
    v_mfma_f32_16x16x32_bf16 v[52:55], a[60:63], a[20:23], v[52:55]
    v_mfma_f32_16x16x32_bf16 v[48:51], a[60:63], a[16:19], v[48:51]
    s_waitcnt lgkmcnt(0)
    s_cbranch_scc1 L_sequential_preLN__sliding_block__glu_gated_bilinear__prompt_kernel_Dcloop_127
    v_mfma_f32_16x16x32_bf16 v[0:3], a[32:35], a[0:3], v[0:3]
    ds_read_b128 a[16:19], v65 offset:0
    ds_read_b128 a[20:23], v65 offset:256
    v_mfma_f32_16x16x32_bf16 v[4:7], a[32:35], a[4:7], v[4:7]
    ds_read_b128 a[24:27], v65 offset:512
    v_mfma_f32_16x16x32_bf16 v[8:11], a[32:35], a[8:11], v[8:11]
    ds_read_b128 a[28:31], v65 offset:768
    v_mfma_f32_16x16x32_bf16 v[12:15], a[32:35], a[12:15], v[12:15]
    ds_read_b64_tr_b16 a[48:49], v68 offset:8192
    v_mfma_f32_16x16x32_bf16 v[28:31], a[36:39], a[12:15], v[28:31]
    ds_read_b64_tr_b16 a[50:51], v68 offset:10240
    v_mfma_f32_16x16x32_bf16 v[24:27], a[36:39], a[8:11], v[24:27]
    ds_read_b64_tr_b16 a[52:53], v69 offset:8192
    v_mfma_f32_16x16x32_bf16 v[20:23], a[36:39], a[4:7], v[20:23]
    ds_read_b64_tr_b16 a[54:55], v69 offset:10240
    v_mfma_f32_16x16x32_bf16 v[16:19], a[36:39], a[0:3], v[16:19]
    ds_read_b64_tr_b16 a[56:57], v70 offset:8192
    v_mfma_f32_16x16x32_bf16 v[32:35], a[40:43], a[0:3], v[32:35]
    ds_read_b64_tr_b16 a[58:59], v70 offset:10240
    v_mfma_f32_16x16x32_bf16 v[36:39], a[40:43], a[4:7], v[36:39]
    ds_read_b64_tr_b16 a[60:61], v71 offset:8192
    v_mfma_f32_16x16x32_bf16 v[40:43], a[40:43], a[8:11], v[40:43]
    ds_read_b64_tr_b16 a[62:63], v71 offset:10240
    v_mfma_f32_16x16x32_bf16 v[44:47], a[40:43], a[12:15], v[44:47]
    v_mfma_f32_16x16x32_bf16 v[60:63], a[44:47], a[12:15], v[60:63]
    v_mfma_f32_16x16x32_bf16 v[56:59], a[44:47], a[8:11], v[56:59]
    v_mfma_f32_16x16x32_bf16 v[52:55], a[44:47], a[4:7], v[52:55]
    v_mfma_f32_16x16x32_bf16 v[48:51], a[44:47], a[0:3], v[48:51]
    s_waitcnt lgkmcnt(0)
    s_barrier
    v_mfma_f32_16x16x32_bf16 v[0:3], a[48:51], a[16:19], v[0:3]
    ds_read_b128 a[0:3], v64 offset:16384
    ds_read_b128 a[4:7], v64 offset:16640
    v_mfma_f32_16x16x32_bf16 v[4:7], a[48:51], a[20:23], v[4:7]
    ds_read_b128 a[8:11], v64 offset:16896
    v_mfma_f32_16x16x32_bf16 v[8:11], a[48:51], a[24:27], v[8:11]
    ds_read_b128 a[12:15], v64 offset:17152
    v_mfma_f32_16x16x32_bf16 v[12:15], a[48:51], a[28:31], v[12:15]
    ds_read_b64_tr_b16 a[32:33], v68 offset:16384
    v_mfma_f32_16x16x32_bf16 v[28:31], a[52:55], a[28:31], v[28:31]
    ds_read_b64_tr_b16 a[34:35], v68 offset:18432
    v_mfma_f32_16x16x32_bf16 v[24:27], a[52:55], a[24:27], v[24:27]
    ds_read_b64_tr_b16 a[36:37], v69 offset:16384
    v_mfma_f32_16x16x32_bf16 v[20:23], a[52:55], a[20:23], v[20:23]
    ds_read_b64_tr_b16 a[38:39], v69 offset:18432
    v_mfma_f32_16x16x32_bf16 v[16:19], a[52:55], a[16:19], v[16:19]
    ds_read_b64_tr_b16 a[40:41], v70 offset:16384
    v_mfma_f32_16x16x32_bf16 v[32:35], a[56:59], a[16:19], v[32:35]
    ds_read_b64_tr_b16 a[42:43], v70 offset:18432
    v_mfma_f32_16x16x32_bf16 v[36:39], a[56:59], a[20:23], v[36:39]
    ds_read_b64_tr_b16 a[44:45], v71 offset:16384
    v_mfma_f32_16x16x32_bf16 v[40:43], a[56:59], a[24:27], v[40:43]
    ds_read_b64_tr_b16 a[46:47], v71 offset:18432
    v_mfma_f32_16x16x32_bf16 v[44:47], a[56:59], a[28:31], v[44:47]
    v_mfma_f32_16x16x32_bf16 v[60:63], a[60:63], a[28:31], v[60:63]
    v_mfma_f32_16x16x32_bf16 v[56:59], a[60:63], a[24:27], v[56:59]
    v_mfma_f32_16x16x32_bf16 v[52:55], a[60:63], a[20:23], v[52:55]
    v_mfma_f32_16x16x32_bf16 v[48:51], a[60:63], a[16:19], v[48:51]
    s_waitcnt lgkmcnt(0)
    v_mfma_f32_16x16x32_bf16 v[0:3], a[32:35], a[0:3], v[0:3]
    ds_read_b128 a[16:19], v65 offset:16384
    ds_read_b128 a[20:23], v65 offset:16640
    v_mfma_f32_16x16x32_bf16 v[4:7], a[32:35], a[4:7], v[4:7]
    ds_read_b128 a[24:27], v65 offset:16896
    v_mfma_f32_16x16x32_bf16 v[8:11], a[32:35], a[8:11], v[8:11]
    ds_read_b128 a[28:31], v65 offset:17152
    v_mfma_f32_16x16x32_bf16 v[12:15], a[32:35], a[12:15], v[12:15]
    ds_read_b64_tr_b16 a[48:49], v68 offset:24576
    v_mfma_f32_16x16x32_bf16 v[28:31], a[36:39], a[12:15], v[28:31]
    ds_read_b64_tr_b16 a[50:51], v68 offset:26624
    v_mfma_f32_16x16x32_bf16 v[24:27], a[36:39], a[8:11], v[24:27]
    ds_read_b64_tr_b16 a[52:53], v69 offset:24576
    v_mfma_f32_16x16x32_bf16 v[20:23], a[36:39], a[4:7], v[20:23]
    ds_read_b64_tr_b16 a[54:55], v69 offset:26624
    v_mfma_f32_16x16x32_bf16 v[16:19], a[36:39], a[0:3], v[16:19]
    ds_read_b64_tr_b16 a[56:57], v70 offset:24576
    v_mfma_f32_16x16x32_bf16 v[32:35], a[40:43], a[0:3], v[32:35]
    ds_read_b64_tr_b16 a[58:59], v70 offset:26624
    v_mfma_f32_16x16x32_bf16 v[36:39], a[40:43], a[4:7], v[36:39]
    ds_read_b64_tr_b16 a[60:61], v71 offset:24576
    v_mfma_f32_16x16x32_bf16 v[40:43], a[40:43], a[8:11], v[40:43]
    ds_read_b64_tr_b16 a[62:63], v71 offset:26624
    v_mfma_f32_16x16x32_bf16 v[44:47], a[40:43], a[12:15], v[44:47]
    v_mfma_f32_16x16x32_bf16 v[60:63], a[44:47], a[12:15], v[60:63]
    v_mfma_f32_16x16x32_bf16 v[56:59], a[44:47], a[8:11], v[56:59]
    v_mfma_f32_16x16x32_bf16 v[52:55], a[44:47], a[4:7], v[52:55]
    v_mfma_f32_16x16x32_bf16 v[48:51], a[44:47], a[0:3], v[48:51]
    s_waitcnt lgkmcnt(0)
    s_barrier
    s_cmp_eq_u32 s57, 0
    s_cbranch_scc0 L_sequential_preLN__sliding_block__glu_gated_bilinear__prompt_kernel_Dnopar_128
    s_mov_b32 s3, 0
    buffer_load_dwordx4 v[116:119], v82, s[24:27], s3 offen sc1
    s_mov_b32 s3, 1024
    buffer_load_dwordx4 v[120:123], v82, s[24:27], s3 offen sc1
    s_mov_b32 s3, 2048
    buffer_load_dwordx4 v[124:127], v82, s[24:27], s3 offen sc1
    s_mov_b32 s3, 3072
    buffer_load_dwordx4 v[128:131], v82, s[24:27], s3 offen sc1
    s_mov_b32 s3, 4096
    buffer_load_dwordx4 v[132:135], v82, s[24:27], s3 offen sc1
    s_mov_b32 s3, 5120
    buffer_load_dwordx4 v[136:139], v82, s[24:27], s3 offen sc1
    s_mov_b32 s3, 6144
    buffer_load_dwordx4 v[140:143], v82, s[24:27], s3 offen sc1
    s_mov_b32 s3, 7168
    buffer_load_dwordx4 v[144:147], v82, s[24:27], s3 offen sc1
L_sequential_preLN__sliding_block__glu_gated_bilinear__prompt_kernel_Dnopar_128:
    v_mfma_f32_16x16x32_bf16 v[0:3], a[48:51], a[16:19], v[0:3]
    ds_read_b128 a[0:3], v66 offset:0
    ds_read_b128 a[4:7], v66 offset:256
    v_mfma_f32_16x16x32_bf16 v[4:7], a[48:51], a[20:23], v[4:7]
    ds_read_b128 a[8:11], v66 offset:512
    v_mfma_f32_16x16x32_bf16 v[8:11], a[48:51], a[24:27], v[8:11]
    ds_read_b128 a[12:15], v66 offset:768
    v_mfma_f32_16x16x32_bf16 v[12:15], a[48:51], a[28:31], v[12:15]
    ds_read_b64_tr_b16 a[32:33], v72 offset:0
    v_mfma_f32_16x16x32_bf16 v[28:31], a[52:55], a[28:31], v[28:31]
    ds_read_b64_tr_b16 a[34:35], v72 offset:2048
    v_mfma_f32_16x16x32_bf16 v[24:27], a[52:55], a[24:27], v[24:27]
    ds_read_b64_tr_b16 a[36:37], v73 offset:0
    v_mfma_f32_16x16x32_bf16 v[20:23], a[52:55], a[20:23], v[20:23]
    ds_read_b64_tr_b16 a[38:39], v73 offset:2048
    v_mfma_f32_16x16x32_bf16 v[16:19], a[52:55], a[16:19], v[16:19]
    ds_read_b64_tr_b16 a[40:41], v74 offset:0
    v_mfma_f32_16x16x32_bf16 v[32:35], a[56:59], a[16:19], v[32:35]
    ds_read_b64_tr_b16 a[42:43], v74 offset:2048
    v_mfma_f32_16x16x32_bf16 v[36:39], a[56:59], a[20:23], v[36:39]
    ds_read_b64_tr_b16 a[44:45], v75 offset:0
    v_mfma_f32_16x16x32_bf16 v[40:43], a[56:59], a[24:27], v[40:43]
    ds_read_b64_tr_b16 a[46:47], v75 offset:2048
    v_mfma_f32_16x16x32_bf16 v[44:47], a[56:59], a[28:31], v[44:47]
    v_mfma_f32_16x16x32_bf16 v[60:63], a[60:63], a[28:31], v[60:63]
    v_mfma_f32_16x16x32_bf16 v[56:59], a[60:63], a[24:27], v[56:59]
    v_mfma_f32_16x16x32_bf16 v[52:55], a[60:63], a[20:23], v[52:55]
    v_mfma_f32_16x16x32_bf16 v[48:51], a[60:63], a[16:19], v[48:51]
    s_waitcnt lgkmcnt(0)
    v_mfma_f32_16x16x32_bf16 v[0:3], a[32:35], a[0:3], v[0:3]
    ds_read_b128 a[16:19], v67 offset:0
    ds_read_b128 a[20:23], v67 offset:256
    v_mfma_f32_16x16x32_bf16 v[4:7], a[32:35], a[4:7], v[4:7]
    ds_read_b128 a[24:27], v67 offset:512
    v_mfma_f32_16x16x32_bf16 v[8:11], a[32:35], a[8:11], v[8:11]
    ds_read_b128 a[28:31], v67 offset:768
    v_mfma_f32_16x16x32_bf16 v[12:15], a[32:35], a[12:15], v[12:15]
    ds_read_b64_tr_b16 a[48:49], v72 offset:8192
    v_mfma_f32_16x16x32_bf16 v[28:31], a[36:39], a[12:15], v[28:31]
    ds_read_b64_tr_b16 a[50:51], v72 offset:10240
    v_mfma_f32_16x16x32_bf16 v[24:27], a[36:39], a[8:11], v[24:27]
    ds_read_b64_tr_b16 a[52:53], v73 offset:8192
    v_mfma_f32_16x16x32_bf16 v[20:23], a[36:39], a[4:7], v[20:23]
    ds_read_b64_tr_b16 a[54:55], v73 offset:10240
    v_mfma_f32_16x16x32_bf16 v[16:19], a[36:39], a[0:3], v[16:19]
    ds_read_b64_tr_b16 a[56:57], v74 offset:8192
    v_mfma_f32_16x16x32_bf16 v[32:35], a[40:43], a[0:3], v[32:35]
    ds_read_b64_tr_b16 a[58:59], v74 offset:10240
    v_mfma_f32_16x16x32_bf16 v[36:39], a[40:43], a[4:7], v[36:39]
    ds_read_b64_tr_b16 a[60:61], v75 offset:8192
    v_mfma_f32_16x16x32_bf16 v[40:43], a[40:43], a[8:11], v[40:43]
    ds_read_b64_tr_b16 a[62:63], v75 offset:10240
    v_mfma_f32_16x16x32_bf16 v[44:47], a[40:43], a[12:15], v[44:47]
    v_mfma_f32_16x16x32_bf16 v[60:63], a[44:47], a[12:15], v[60:63]
    v_mfma_f32_16x16x32_bf16 v[56:59], a[44:47], a[8:11], v[56:59]
    v_mfma_f32_16x16x32_bf16 v[52:55], a[44:47], a[4:7], v[52:55]
    v_mfma_f32_16x16x32_bf16 v[48:51], a[44:47], a[0:3], v[48:51]
    s_waitcnt lgkmcnt(0)
    s_barrier
    v_mfma_f32_16x16x32_bf16 v[0:3], a[48:51], a[16:19], v[0:3]
    ds_read_b128 a[0:3], v66 offset:16384
    ds_read_b128 a[4:7], v66 offset:16640
    v_mfma_f32_16x16x32_bf16 v[4:7], a[48:51], a[20:23], v[4:7]
    ds_read_b128 a[8:11], v66 offset:16896
    v_mfma_f32_16x16x32_bf16 v[8:11], a[48:51], a[24:27], v[8:11]
    ds_read_b128 a[12:15], v66 offset:17152
    v_mfma_f32_16x16x32_bf16 v[12:15], a[48:51], a[28:31], v[12:15]
    ds_read_b64_tr_b16 a[32:33], v72 offset:16384
    v_mfma_f32_16x16x32_bf16 v[28:31], a[52:55], a[28:31], v[28:31]
    ds_read_b64_tr_b16 a[34:35], v72 offset:18432
    v_mfma_f32_16x16x32_bf16 v[24:27], a[52:55], a[24:27], v[24:27]
    ds_read_b64_tr_b16 a[36:37], v73 offset:16384
    v_mfma_f32_16x16x32_bf16 v[20:23], a[52:55], a[20:23], v[20:23]
    ds_read_b64_tr_b16 a[38:39], v73 offset:18432
    v_mfma_f32_16x16x32_bf16 v[16:19], a[52:55], a[16:19], v[16:19]
    ds_read_b64_tr_b16 a[40:41], v74 offset:16384
    v_mfma_f32_16x16x32_bf16 v[32:35], a[56:59], a[16:19], v[32:35]
    ds_read_b64_tr_b16 a[42:43], v74 offset:18432
    v_mfma_f32_16x16x32_bf16 v[36:39], a[56:59], a[20:23], v[36:39]
    ds_read_b64_tr_b16 a[44:45], v75 offset:16384
    v_mfma_f32_16x16x32_bf16 v[40:43], a[56:59], a[24:27], v[40:43]
    ds_read_b64_tr_b16 a[46:47], v75 offset:18432
    v_mfma_f32_16x16x32_bf16 v[44:47], a[56:59], a[28:31], v[44:47]
    v_mfma_f32_16x16x32_bf16 v[60:63], a[60:63], a[28:31], v[60:63]
    v_mfma_f32_16x16x32_bf16 v[56:59], a[60:63], a[24:27], v[56:59]
    v_mfma_f32_16x16x32_bf16 v[52:55], a[60:63], a[20:23], v[52:55]
    v_mfma_f32_16x16x32_bf16 v[48:51], a[60:63], a[16:19], v[48:51]
    s_waitcnt lgkmcnt(0)
    v_mfma_f32_16x16x32_bf16 v[0:3], a[32:35], a[0:3], v[0:3]
    ds_read_b128 a[16:19], v67 offset:16384
    ds_read_b128 a[20:23], v67 offset:16640
    v_mfma_f32_16x16x32_bf16 v[4:7], a[32:35], a[4:7], v[4:7]
    ds_read_b128 a[24:27], v67 offset:16896
    v_mfma_f32_16x16x32_bf16 v[8:11], a[32:35], a[8:11], v[8:11]
    ds_read_b128 a[28:31], v67 offset:17152
    v_mfma_f32_16x16x32_bf16 v[12:15], a[32:35], a[12:15], v[12:15]
    ds_read_b64_tr_b16 a[48:49], v72 offset:24576
    v_mfma_f32_16x16x32_bf16 v[28:31], a[36:39], a[12:15], v[28:31]
    ds_read_b64_tr_b16 a[50:51], v72 offset:26624
    v_mfma_f32_16x16x32_bf16 v[24:27], a[36:39], a[8:11], v[24:27]
    ds_read_b64_tr_b16 a[52:53], v73 offset:24576
    v_mfma_f32_16x16x32_bf16 v[20:23], a[36:39], a[4:7], v[20:23]
    ds_read_b64_tr_b16 a[54:55], v73 offset:26624
    v_mfma_f32_16x16x32_bf16 v[16:19], a[36:39], a[0:3], v[16:19]
    ds_read_b64_tr_b16 a[56:57], v74 offset:24576
    v_mfma_f32_16x16x32_bf16 v[32:35], a[40:43], a[0:3], v[32:35]
    ds_read_b64_tr_b16 a[58:59], v74 offset:26624
    v_mfma_f32_16x16x32_bf16 v[36:39], a[40:43], a[4:7], v[36:39]
    ds_read_b64_tr_b16 a[60:61], v75 offset:24576
    v_mfma_f32_16x16x32_bf16 v[40:43], a[40:43], a[8:11], v[40:43]
    ds_read_b64_tr_b16 a[62:63], v75 offset:26624
    v_mfma_f32_16x16x32_bf16 v[44:47], a[40:43], a[12:15], v[44:47]
    v_mfma_f32_16x16x32_bf16 v[60:63], a[44:47], a[12:15], v[60:63]
    v_mfma_f32_16x16x32_bf16 v[56:59], a[44:47], a[8:11], v[56:59]
    v_mfma_f32_16x16x32_bf16 v[52:55], a[44:47], a[4:7], v[52:55]
    v_mfma_f32_16x16x32_bf16 v[48:51], a[44:47], a[0:3], v[48:51]
    s_waitcnt lgkmcnt(0)
    s_barrier
    v_mfma_f32_16x16x32_bf16 v[0:3], a[48:51], a[16:19], v[0:3]
    v_mfma_f32_16x16x32_bf16 v[4:7], a[48:51], a[20:23], v[4:7]
    v_mfma_f32_16x16x32_bf16 v[8:11], a[48:51], a[24:27], v[8:11]
    v_mfma_f32_16x16x32_bf16 v[12:15], a[48:51], a[28:31], v[12:15]
    v_mfma_f32_16x16x32_bf16 v[28:31], a[52:55], a[28:31], v[28:31]
    v_mfma_f32_16x16x32_bf16 v[24:27], a[52:55], a[24:27], v[24:27]
    v_mfma_f32_16x16x32_bf16 v[20:23], a[52:55], a[20:23], v[20:23]
    v_mfma_f32_16x16x32_bf16 v[16:19], a[52:55], a[16:19], v[16:19]
    v_mfma_f32_16x16x32_bf16 v[32:35], a[56:59], a[16:19], v[32:35]
    v_mfma_f32_16x16x32_bf16 v[36:39], a[56:59], a[20:23], v[36:39]
    v_mfma_f32_16x16x32_bf16 v[40:43], a[56:59], a[24:27], v[40:43]
    v_mfma_f32_16x16x32_bf16 v[44:47], a[56:59], a[28:31], v[44:47]
    v_mfma_f32_16x16x32_bf16 v[60:63], a[60:63], a[28:31], v[60:63]
    v_mfma_f32_16x16x32_bf16 v[56:59], a[60:63], a[24:27], v[56:59]
    v_mfma_f32_16x16x32_bf16 v[52:55], a[60:63], a[20:23], v[52:55]
    v_mfma_f32_16x16x32_bf16 v[48:51], a[60:63], a[16:19], v[48:51]
    s_cmp_eq_u32 s57, 0
    s_cbranch_scc1 L_sequential_preLN__sliding_block__glu_gated_bilinear__prompt_kernel_Down_129
    s_nop 7
    v_cvt_pk_bf16_f32 v116, v0, v1
    v_cvt_pk_bf16_f32 v117, v2, v3
    v_cvt_pk_bf16_f32 v118, v4, v5
    v_cvt_pk_bf16_f32 v119, v6, v7
    s_mov_b32 s3, 0
    buffer_store_dwordx4 v[116:119], v82, s[24:27], s3 offen sc1
    v_cvt_pk_bf16_f32 v120, v8, v9
    v_cvt_pk_bf16_f32 v121, v10, v11
    v_cvt_pk_bf16_f32 v122, v12, v13
    v_cvt_pk_bf16_f32 v123, v14, v15
    s_mov_b32 s3, 1024
    buffer_store_dwordx4 v[120:123], v82, s[24:27], s3 offen sc1
    v_cvt_pk_bf16_f32 v124, v16, v17
    v_cvt_pk_bf16_f32 v125, v18, v19
    v_cvt_pk_bf16_f32 v126, v20, v21
    v_cvt_pk_bf16_f32 v127, v22, v23
    s_mov_b32 s3, 2048
    buffer_store_dwordx4 v[124:127], v82, s[24:27], s3 offen sc1
    v_cvt_pk_bf16_f32 v128, v24, v25
    v_cvt_pk_bf16_f32 v129, v26, v27
    v_cvt_pk_bf16_f32 v130, v28, v29
    v_cvt_pk_bf16_f32 v131, v30, v31
    s_mov_b32 s3, 3072
    buffer_store_dwordx4 v[128:131], v82, s[24:27], s3 offen sc1
    v_cvt_pk_bf16_f32 v132, v32, v33
    v_cvt_pk_bf16_f32 v133, v34, v35
    v_cvt_pk_bf16_f32 v134, v36, v37
    v_cvt_pk_bf16_f32 v135, v38, v39
    s_mov_b32 s3, 4096
    buffer_store_dwordx4 v[132:135], v82, s[24:27], s3 offen sc1
    v_cvt_pk_bf16_f32 v136, v40, v41
    v_cvt_pk_bf16_f32 v137, v42, v43
    v_cvt_pk_bf16_f32 v138, v44, v45
    v_cvt_pk_bf16_f32 v139, v46, v47
    s_mov_b32 s3, 5120
    buffer_store_dwordx4 v[136:139], v82, s[24:27], s3 offen sc1
    v_cvt_pk_bf16_f32 v140, v48, v49
    v_cvt_pk_bf16_f32 v141, v50, v51
    v_cvt_pk_bf16_f32 v142, v52, v53
    v_cvt_pk_bf16_f32 v143, v54, v55
    s_mov_b32 s3, 6144
    buffer_store_dwordx4 v[140:143], v82, s[24:27], s3 offen sc1
    v_cvt_pk_bf16_f32 v144, v56, v57
    v_cvt_pk_bf16_f32 v145, v58, v59
    v_cvt_pk_bf16_f32 v146, v60, v61
    v_cvt_pk_bf16_f32 v147, v62, v63
    s_mov_b32 s3, 7168
    buffer_store_dwordx4 v[144:147], v82, s[24:27], s3 offen sc1
    s_waitcnt vmcnt(0)
    s_branch L_sequential_preLN__sliding_block__glu_gated_bilinear__prompt_kernel_Dend_121
L_sequential_preLN__sliding_block__glu_gated_bilinear__prompt_kernel_Down_129:
    s_waitcnt vmcnt(0)
    s_nop 4
    s_mov_b32 s4, 0x3f80
    s_mov_b32 s5, 0x3f800000
    v_dot2_f32_bf16 v0, v116, s4, v0
    v_dot2_f32_bf16 v1, v116, s5, v1
    v_dot2_f32_bf16 v2, v117, s4, v2
    v_dot2_f32_bf16 v3, v117, s5, v3
    v_dot2_f32_bf16 v4, v118, s4, v4
    v_dot2_f32_bf16 v5, v118, s5, v5
    v_dot2_f32_bf16 v6, v119, s4, v6
    v_dot2_f32_bf16 v7, v119, s5, v7
    v_dot2_f32_bf16 v8, v120, s4, v8
    v_dot2_f32_bf16 v9, v120, s5, v9
    v_dot2_f32_bf16 v10, v121, s4, v10
    v_dot2_f32_bf16 v11, v121, s5, v11
    v_dot2_f32_bf16 v12, v122, s4, v12
    v_dot2_f32_bf16 v13, v122, s5, v13
    v_dot2_f32_bf16 v14, v123, s4, v14
    v_dot2_f32_bf16 v15, v123, s5, v15
    v_dot2_f32_bf16 v16, v124, s4, v16
    v_dot2_f32_bf16 v17, v124, s5, v17
    v_dot2_f32_bf16 v18, v125, s4, v18
    v_dot2_f32_bf16 v19, v125, s5, v19
    v_dot2_f32_bf16 v20, v126, s4, v20
    v_dot2_f32_bf16 v21, v126, s5, v21
    v_dot2_f32_bf16 v22, v127, s4, v22
    v_dot2_f32_bf16 v23, v127, s5, v23
    v_dot2_f32_bf16 v24, v128, s4, v24
    v_dot2_f32_bf16 v25, v128, s5, v25
    v_dot2_f32_bf16 v26, v129, s4, v26
    v_dot2_f32_bf16 v27, v129, s5, v27
    v_dot2_f32_bf16 v28, v130, s4, v28
    v_dot2_f32_bf16 v29, v130, s5, v29
    v_dot2_f32_bf16 v30, v131, s4, v30
    v_dot2_f32_bf16 v31, v131, s5, v31
    v_dot2_f32_bf16 v32, v132, s4, v32
    v_dot2_f32_bf16 v33, v132, s5, v33
    v_dot2_f32_bf16 v34, v133, s4, v34
    v_dot2_f32_bf16 v35, v133, s5, v35
    v_dot2_f32_bf16 v36, v134, s4, v36
    v_dot2_f32_bf16 v37, v134, s5, v37
    v_dot2_f32_bf16 v38, v135, s4, v38
    v_dot2_f32_bf16 v39, v135, s5, v39
    v_dot2_f32_bf16 v40, v136, s4, v40
    v_dot2_f32_bf16 v41, v136, s5, v41
    v_dot2_f32_bf16 v42, v137, s4, v42
    v_dot2_f32_bf16 v43, v137, s5, v43
    v_dot2_f32_bf16 v44, v138, s4, v44
    v_dot2_f32_bf16 v45, v138, s5, v45
    v_dot2_f32_bf16 v46, v139, s4, v46
    v_dot2_f32_bf16 v47, v139, s5, v47
    v_dot2_f32_bf16 v48, v140, s4, v48
    v_dot2_f32_bf16 v49, v140, s5, v49
    v_dot2_f32_bf16 v50, v141, s4, v50
    v_dot2_f32_bf16 v51, v141, s5, v51
    v_dot2_f32_bf16 v52, v142, s4, v52
    v_dot2_f32_bf16 v53, v142, s5, v53
    v_dot2_f32_bf16 v54, v143, s4, v54
    v_dot2_f32_bf16 v55, v143, s5, v55
    v_dot2_f32_bf16 v56, v144, s4, v56
    v_dot2_f32_bf16 v57, v144, s5, v57
    v_dot2_f32_bf16 v58, v145, s4, v58
    v_dot2_f32_bf16 v59, v145, s5, v59
    v_dot2_f32_bf16 v60, v146, s4, v60
    v_dot2_f32_bf16 v61, v146, s5, v61
    v_dot2_f32_bf16 v62, v147, s4, v62
    v_dot2_f32_bf16 v63, v147, s5, v63

    v_and_b32 v76, 15, v80
    v_lshrrev_b32 v77, 4, v80
    v_and_b32 v78, 1, v77
    v_lshrrev_b32 v77, 1, v77
    v_lshl_add_u32 v77, v78, 1, v77
    s_lshl_b32 s3, s44, 3
    v_add_u32 v77, s3, v77
    v_xor_b32 v78, v77, v76
    v_xor_b32 v79, 4, v78
    s_lshl_b32 s3, s43, 6
    v_add_u32 v76, s3, v76
    v_lshlrev_b32 v76, 8, v76
    v_lshl_add_u32 v81, v78, 4, v76
    v_lshl_add_u32 v83, v79, 4, v76

    v_cvt_pk_bf16_f32 v84, v0, v1
    v_cvt_pk_bf16_f32 v85, v2, v3
    v_cvt_pk_bf16_f32 v86, v16, v17
    v_cvt_pk_bf16_f32 v87, v18, v19
    s_nop 1
    v_permlane16_swap_b32 v84, v86
    v_permlane16_swap_b32 v85, v87
    ds_write_b128 v81, v[84:87] offset:0
    v_cvt_pk_bf16_f32 v88, v32, v33
    v_cvt_pk_bf16_f32 v89, v34, v35
    v_cvt_pk_bf16_f32 v90, v48, v49
    v_cvt_pk_bf16_f32 v91, v50, v51
    s_nop 1
    v_permlane16_swap_b32 v88, v90
    v_permlane16_swap_b32 v89, v91
    ds_write_b128 v83, v[88:91] offset:0
    v_cvt_pk_bf16_f32 v92, v4, v5
    v_cvt_pk_bf16_f32 v93, v6, v7
    v_cvt_pk_bf16_f32 v94, v20, v21
    v_cvt_pk_bf16_f32 v95, v22, v23
    s_nop 1
    v_permlane16_swap_b32 v92, v94
    v_permlane16_swap_b32 v93, v95
    ds_write_b128 v81, v[92:95] offset:4096
    v_cvt_pk_bf16_f32 v96, v36, v37
    v_cvt_pk_bf16_f32 v97, v38, v39
    v_cvt_pk_bf16_f32 v98, v52, v53
    v_cvt_pk_bf16_f32 v99, v54, v55
    s_nop 1
    v_permlane16_swap_b32 v96, v98
    v_permlane16_swap_b32 v97, v99
    ds_write_b128 v83, v[96:99] offset:4096
    v_cvt_pk_bf16_f32 v100, v8, v9
    v_cvt_pk_bf16_f32 v101, v10, v11
    v_cvt_pk_bf16_f32 v102, v24, v25
    v_cvt_pk_bf16_f32 v103, v26, v27
    s_nop 1
    v_permlane16_swap_b32 v100, v102
    v_permlane16_swap_b32 v101, v103
    ds_write_b128 v81, v[100:103] offset:8192
    v_cvt_pk_bf16_f32 v104, v40, v41
    v_cvt_pk_bf16_f32 v105, v42, v43
    v_cvt_pk_bf16_f32 v106, v56, v57
    v_cvt_pk_bf16_f32 v107, v58, v59
    s_nop 1
    v_permlane16_swap_b32 v104, v106
    v_permlane16_swap_b32 v105, v107
    ds_write_b128 v83, v[104:107] offset:8192
    v_cvt_pk_bf16_f32 v108, v12, v13
    v_cvt_pk_bf16_f32 v109, v14, v15
    v_cvt_pk_bf16_f32 v110, v28, v29
    v_cvt_pk_bf16_f32 v111, v30, v31
    s_nop 1
    v_permlane16_swap_b32 v108, v110
    v_permlane16_swap_b32 v109, v111
    ds_write_b128 v81, v[108:111] offset:12288
    v_cvt_pk_bf16_f32 v112, v44, v45
    v_cvt_pk_bf16_f32 v113, v46, v47
    v_cvt_pk_bf16_f32 v114, v60, v61
    v_cvt_pk_bf16_f32 v115, v62, v63
    s_nop 1
    v_permlane16_swap_b32 v112, v114
    v_permlane16_swap_b32 v113, v115
    ds_write_b128 v83, v[112:115] offset:12288
    s_waitcnt lgkmcnt(0)
    s_branch L_sequential_preLN__sliding_block__glu_gated_bilinear__prompt_kernel_Dcopy_130
L_sequential_preLN__sliding_block__glu_gated_bilinear__prompt_kernel_Dload_120:
    v_mbcnt_lo_u32_b32 v3, -1, 0
    v_mbcnt_hi_u32_b32 v3, -1, v3

    s_sub_u32 s43, s40, 4
    s_mul_i32 s3, s41, 917504
    s_lshl_b32 s4, s43, 12
    s_add_u32 s3, s3, s4
    v_lshl_add_u32 v4, v3, 4, s3

    v_lshrrev_b32 v31, 4, v3
    v_add_u32 v31, 0, v31
    v_and_b32 v32, 7, v31
    v_lshlrev_b32 v32, 1, v32
    v_and_b32 v33, 15, v3
    v_xor_b32 v32, v32, v33
    v_and_b32 v33, 4, v31
    v_lshlrev_b32 v33, 1, v33
    v_and_b32 v30, 8, v31
    v_lshrrev_b32 v30, 1, v30
    v_or_b32 v33, v33, v30
    v_and_b32 v31, 3, v31
    v_or_b32 v31, v31, v33
    s_lshl_b32 s3, s43, 4
    v_add_u32 v31, s3, v31
    v_lshlrev_b32 v31, 11, v31
    v_lshl_add_u32 v31, v32, 4, v31
    s_lshr_b32 s3, s42, 1
    s_lshl_b32 s3, s3, 8
    v_add_u32 v31, s3, v31
    v_add_u32 v8, 0, v31

    v_lshrrev_b32 v31, 4, v3
    v_add_u32 v31, 4, v31
    v_and_b32 v32, 7, v31
    v_lshlrev_b32 v32, 1, v32
    v_and_b32 v33, 15, v3
    v_xor_b32 v32, v32, v33
    v_and_b32 v33, 4, v31
    v_lshlrev_b32 v33, 1, v33
    v_and_b32 v30, 8, v31
    v_lshrrev_b32 v30, 1, v30
    v_or_b32 v33, v33, v30
    v_and_b32 v31, 3, v31
    v_or_b32 v31, v31, v33
    s_lshl_b32 s3, s43, 4
    v_add_u32 v31, s3, v31
    v_lshlrev_b32 v31, 11, v31
    v_lshl_add_u32 v31, v32, 4, v31
    s_lshr_b32 s3, s42, 1
    s_lshl_b32 s3, s3, 8
    v_add_u32 v31, s3, v31
    v_add_u32 v9, 4294966272, v31

    v_lshrrev_b32 v31, 4, v3
    v_add_u32 v31, 8, v31
    v_and_b32 v32, 7, v31
    v_lshlrev_b32 v32, 1, v32
    v_and_b32 v33, 15, v3
    v_xor_b32 v32, v32, v33
    v_and_b32 v33, 4, v31
    v_lshlrev_b32 v33, 1, v33
    v_and_b32 v30, 8, v31
    v_lshrrev_b32 v30, 1, v30
    v_or_b32 v33, v33, v30
    v_and_b32 v31, 3, v31
    v_or_b32 v31, v31, v33
    s_lshl_b32 s3, s43, 4
    v_add_u32 v31, s3, v31
    v_lshlrev_b32 v31, 11, v31
    v_lshl_add_u32 v31, v32, 4, v31
    s_lshr_b32 s3, s42, 1
    s_lshl_b32 s3, s3, 8
    v_add_u32 v31, s3, v31
    v_add_u32 v10, 4294965248, v31

    v_lshrrev_b32 v31, 4, v3
    v_add_u32 v31, 12, v31
    v_and_b32 v32, 7, v31
    v_lshlrev_b32 v32, 1, v32
    v_and_b32 v33, 15, v3
    v_xor_b32 v32, v32, v33
    v_and_b32 v33, 4, v31
    v_lshlrev_b32 v33, 1, v33
    v_and_b32 v30, 8, v31
    v_lshrrev_b32 v30, 1, v30
    v_or_b32 v33, v33, v30
    v_and_b32 v31, 3, v31
    v_or_b32 v31, v31, v33
    s_lshl_b32 s3, s43, 4
    v_add_u32 v31, s3, v31
    v_lshlrev_b32 v31, 11, v31
    v_lshl_add_u32 v31, v32, 4, v31
    s_lshr_b32 s3, s42, 1
    s_lshl_b32 s3, s3, 8
    v_add_u32 v31, s3, v31
    v_add_u32 v11, 4294964224, v31

    s_mov_b32 s44, 0
    s_mov_b32 s45, s58
    s_add_u32 s3, s45, s59
    s_lshl_b32 s48, s3, 17
    s_lshl_b32 s4, s43, 12
    s_add_u32 s4, s4, s44
    s_add_u32 m0, s4, 65536
    s_nop 0
    buffer_load_dwordx4 v8, s[12:15], s48 offen offset:0 lds
    buffer_load_dwordx4 v9, s[12:15], s48 offen offset:1024 lds
    buffer_load_dwordx4 v10, s[12:15], s48 offen offset:2048 lds
    buffer_load_dwordx4 v11, s[12:15], s48 offen offset:3072 lds

    s_add_u32 s45, s45, 1
    s_cmp_ge_u32 s45, s60
    s_cselect_b32 s45, 0, s45
    s_add_u32 s44, s44, 16384
    s_cmp_ge_u32 s44, 65536
    s_cselect_b32 s44, 0, s44

    s_add_u32 s3, s45, s59
    s_lshl_b32 s48, s3, 17
    s_lshl_b32 s4, s43, 12
    s_add_u32 s4, s4, s44
    s_add_u32 m0, s4, 65536
    s_nop 0
    buffer_load_dwordx4 v8, s[12:15], s48 offen offset:0 lds
    buffer_load_dwordx4 v9, s[12:15], s48 offen offset:1024 lds
    buffer_load_dwordx4 v10, s[12:15], s48 offen offset:2048 lds
    buffer_load_dwordx4 v11, s[12:15], s48 offen offset:3072 lds

    s_add_u32 s45, s45, 1
    s_cmp_ge_u32 s45, s60
    s_cselect_b32 s45, 0, s45
    s_add_u32 s44, s44, 16384
    s_cmp_ge_u32 s44, 65536
    s_cselect_b32 s44, 0, s44

    s_add_u32 s3, s45, s59
    s_lshl_b32 s48, s3, 17
    s_lshl_b32 s4, s43, 12
    s_add_u32 s4, s4, s44
    s_add_u32 m0, s4, 65536
    s_nop 0
    buffer_load_dwordx4 v8, s[12:15], s48 offen offset:0 lds
    buffer_load_dwordx4 v9, s[12:15], s48 offen offset:1024 lds
    buffer_load_dwordx4 v10, s[12:15], s48 offen offset:2048 lds
    buffer_load_dwordx4 v11, s[12:15], s48 offen offset:3072 lds

    s_add_u32 s45, s45, 1
    s_cmp_ge_u32 s45, s60
    s_cselect_b32 s45, 0, s45
    s_add_u32 s44, s44, 16384
    s_cmp_ge_u32 s44, 65536
    s_cselect_b32 s44, 0, s44

    s_add_u32 s3, s45, s59
    s_lshl_b32 s48, s3, 17
    s_lshl_b32 s4, s43, 12
    s_add_u32 s4, s4, s44
    s_add_u32 m0, s4, 65536
    s_nop 0
    buffer_load_dwordx4 v8, s[12:15], s48 offen offset:0 lds
    buffer_load_dwordx4 v9, s[12:15], s48 offen offset:1024 lds
    buffer_load_dwordx4 v10, s[12:15], s48 offen offset:2048 lds
    buffer_load_dwordx4 v11, s[12:15], s48 offen offset:3072 lds

    s_add_u32 s45, s45, 1
    s_cmp_ge_u32 s45, s60
    s_cselect_b32 s45, 0, s45
    s_add_u32 s44, s44, 16384
    s_cmp_ge_u32 s44, 65536
    s_cselect_b32 s44, 0, s44

    s_mov_b32 s44, 0
    s_mov_b32 s45, s58
    s_cmp_eq_u32 s40, 7
    s_cbranch_scc0 L_sequential_preLN__sliding_block__glu_gated_bilinear__prompt_kernel_Dnopoll_131
    s_lshr_b32 s3, s41, 1
    s_lshl_b32 s3, s3, 12
    s_add_u32 s49, s3, 458752
    s_mov_b32 s50, 524287
    s_mov_b32 s51, 4294705152
    s_cmp_eq_u32 s57, 0
    s_cselect_b32 s50, s50, s51
    s_mov_b32 s51, 0
    v_mbcnt_lo_u32_b32 v30, -1, 0
    v_mbcnt_hi_u32_b32 v30, -1, v30

    v_lshlrev_b32 v30, 7, v30
    v_add_u32 v30, s49, v30
    v_mov_b32 v31, 0x7fff0000
    v_cndmask_b32 v30, v31, v30, s[50:51]
    s_mov_b32 s63, 0

    buffer_load_dword v31, v30, s[28:31], 0 offen sc1
L_sequential_preLN__sliding_block__glu_gated_bilinear__prompt_kernel_poll_132:
    buffer_load_dword v32, v30, s[28:31], 0 offen sc1
    s_waitcnt vmcnt(1)
    v_cmp_eq_u32 vcc, s62, v31
    s_nop 1
    s_and_b64 s[6:7], vcc, s[50:51]
    s_cmp_eq_u64 s[6:7], s[50:51]
    s_cbranch_scc1 L_sequential_preLN__sliding_block__glu_gated_bilinear__prompt_kernel_polld_133
    buffer_load_dword v31, v30, s[28:31], 0 offen sc1
    s_waitcnt vmcnt(1)
    v_cmp_eq_u32 vcc, s62, v32
    s_nop 1
    s_and_b64 s[6:7], vcc, s[50:51]
    s_cmp_eq_u64 s[6:7], s[50:51]
    s_cbranch_scc1 L_sequential_preLN__sliding_block__glu_gated_bilinear__prompt_kernel_polld_133
    s_add_u32 s63, s63, 1
    s_cmp_lt_u32 s63, 40000
    s_cbranch_scc1 L_sequential_preLN__sliding_block__glu_gated_bilinear__prompt_kernel_poll_132
L_sequential_preLN__sliding_block__glu_gated_bilinear__prompt_kernel_polld_133:

L_sequential_preLN__sliding_block__glu_gated_bilinear__prompt_kernel_Dnopoll_131:
    s_barrier
    s_add_u32 s3, s45, s59
    s_lshl_b32 s47, s3, 14
    s_lshl_b32 s4, s43, 12
    s_add_u32 m0, s4, s44
    s_nop 0
    buffer_load_dwordx4 v4, s[8:11], s47 offen offset:0 sc1 lds
    buffer_load_dwordx4 v4, s[8:11], s47 offen offset:1024 sc1 lds
    buffer_load_dwordx4 v4, s[8:11], s47 offen offset:2048 sc1 lds
    buffer_load_dwordx4 v4, s[8:11], s47 offen offset:3072 sc1 lds

    s_add_u32 s45, s45, 1
    s_cmp_ge_u32 s45, s60
    s_cselect_b32 s45, 0, s45
    s_add_u32 s44, s44, 16384
    s_cmp_ge_u32 s44, 65536
    s_cselect_b32 s44, 0, s44

    s_waitcnt vmcnt(0)
    s_barrier
    s_add_u32 s3, s45, s59
    s_lshl_b32 s47, s3, 14
    s_lshl_b32 s4, s43, 12
    s_add_u32 m0, s4, s44
    s_nop 0
    buffer_load_dwordx4 v4, s[8:11], s47 offen offset:0 sc1 lds
    buffer_load_dwordx4 v4, s[8:11], s47 offen offset:1024 sc1 lds
    buffer_load_dwordx4 v4, s[8:11], s47 offen offset:2048 sc1 lds
    buffer_load_dwordx4 v4, s[8:11], s47 offen offset:3072 sc1 lds

    s_add_u32 s45, s45, 1
    s_cmp_ge_u32 s45, s60
    s_cselect_b32 s45, 0, s45
    s_add_u32 s44, s44, 16384
    s_cmp_ge_u32 s44, 65536
    s_cselect_b32 s44, 0, s44

    s_add_u32 s3, s45, s59
    s_lshl_b32 s47, s3, 14
    s_lshl_b32 s4, s43, 12
    s_add_u32 m0, s4, s44
    s_nop 0
    buffer_load_dwordx4 v4, s[8:11], s47 offen offset:0 sc1 lds
    buffer_load_dwordx4 v4, s[8:11], s47 offen offset:1024 sc1 lds
    buffer_load_dwordx4 v4, s[8:11], s47 offen offset:2048 sc1 lds
    buffer_load_dwordx4 v4, s[8:11], s47 offen offset:3072 sc1 lds

    s_add_u32 s45, s45, 1
    s_cmp_ge_u32 s45, s60
    s_cselect_b32 s45, 0, s45
    s_add_u32 s44, s44, 16384
    s_cmp_ge_u32 s44, 65536
    s_cselect_b32 s44, 0, s44

    s_add_u32 s3, s45, s59
    s_lshl_b32 s47, s3, 14
    s_lshl_b32 s4, s43, 12
    s_add_u32 m0, s4, s44
    s_nop 0
    buffer_load_dwordx4 v4, s[8:11], s47 offen offset:0 sc1 lds
    buffer_load_dwordx4 v4, s[8:11], s47 offen offset:1024 sc1 lds
    buffer_load_dwordx4 v4, s[8:11], s47 offen offset:2048 sc1 lds
    buffer_load_dwordx4 v4, s[8:11], s47 offen offset:3072 sc1 lds

    s_add_u32 s45, s45, 1
    s_cmp_ge_u32 s45, s60
    s_cselect_b32 s45, 0, s45
    s_add_u32 s44, s44, 16384
    s_cmp_ge_u32 s44, 65536
    s_cselect_b32 s44, 0, s44

    s_waitcnt vmcnt(8)
    s_barrier
    s_add_u32 s3, s45, s59
    s_lshl_b32 s47, s3, 14
    s_lshl_b32 s4, s43, 12
    s_add_u32 m0, s4, s44
    s_nop 0
    buffer_load_dwordx4 v4, s[8:11], s47 offen offset:0 sc1 lds
    buffer_load_dwordx4 v4, s[8:11], s47 offen offset:1024 sc1 lds
    buffer_load_dwordx4 v4, s[8:11], s47 offen offset:2048 sc1 lds
    buffer_load_dwordx4 v4, s[8:11], s47 offen offset:3072 sc1 lds
    s_add_u32 s3, s45, s59
    s_lshl_b32 s48, s3, 17
    s_lshl_b32 s4, s43, 12
    s_add_u32 s4, s4, s44
    s_add_u32 m0, s4, 65536
    s_nop 0
    buffer_load_dwordx4 v8, s[12:15], s48 offen offset:0 lds
    buffer_load_dwordx4 v9, s[12:15], s48 offen offset:1024 lds
    buffer_load_dwordx4 v10, s[12:15], s48 offen offset:2048 lds
    buffer_load_dwordx4 v11, s[12:15], s48 offen offset:3072 lds

    s_add_u32 s45, s45, 1
    s_cmp_ge_u32 s45, s60
    s_cselect_b32 s45, 0, s45
    s_add_u32 s44, s44, 16384
    s_cmp_ge_u32 s44, 65536
    s_cselect_b32 s44, 0, s44

    s_waitcnt vmcnt(12)
    s_barrier
    s_add_u32 s3, s45, s59
    s_lshl_b32 s47, s3, 14
    s_lshl_b32 s4, s43, 12
    s_add_u32 m0, s4, s44
    s_nop 0
    buffer_load_dwordx4 v4, s[8:11], s47 offen offset:0 sc1 lds
    buffer_load_dwordx4 v4, s[8:11], s47 offen offset:1024 sc1 lds
    buffer_load_dwordx4 v4, s[8:11], s47 offen offset:2048 sc1 lds
    buffer_load_dwordx4 v4, s[8:11], s47 offen offset:3072 sc1 lds
    s_add_u32 s3, s45, s59
    s_lshl_b32 s48, s3, 17
    s_lshl_b32 s4, s43, 12
    s_add_u32 s4, s4, s44
    s_add_u32 m0, s4, 65536
    s_nop 0
    buffer_load_dwordx4 v8, s[12:15], s48 offen offset:0 lds
    buffer_load_dwordx4 v9, s[12:15], s48 offen offset:1024 lds
    buffer_load_dwordx4 v10, s[12:15], s48 offen offset:2048 lds
    buffer_load_dwordx4 v11, s[12:15], s48 offen offset:3072 lds

    s_add_u32 s45, s45, 1
    s_cmp_ge_u32 s45, s60
    s_cselect_b32 s45, 0, s45
    s_add_u32 s44, s44, 16384
    s_cmp_ge_u32 s44, 65536
    s_cselect_b32 s44, 0, s44

    s_waitcnt vmcnt(16)
    s_barrier
    s_add_u32 s3, s45, s59
    s_lshl_b32 s47, s3, 14
    s_lshl_b32 s4, s43, 12
    s_add_u32 m0, s4, s44
    s_nop 0
    buffer_load_dwordx4 v4, s[8:11], s47 offen offset:0 sc1 lds
    buffer_load_dwordx4 v4, s[8:11], s47 offen offset:1024 sc1 lds
    buffer_load_dwordx4 v4, s[8:11], s47 offen offset:2048 sc1 lds
    buffer_load_dwordx4 v4, s[8:11], s47 offen offset:3072 sc1 lds
    s_add_u32 s3, s45, s59
    s_lshl_b32 s48, s3, 17
    s_lshl_b32 s4, s43, 12
    s_add_u32 s4, s4, s44
    s_add_u32 m0, s4, 65536
    s_nop 0
    buffer_load_dwordx4 v8, s[12:15], s48 offen offset:0 lds
    buffer_load_dwordx4 v9, s[12:15], s48 offen offset:1024 lds
    buffer_load_dwordx4 v10, s[12:15], s48 offen offset:2048 lds
    buffer_load_dwordx4 v11, s[12:15], s48 offen offset:3072 lds

    s_add_u32 s45, s45, 1
    s_cmp_ge_u32 s45, s60
    s_cselect_b32 s45, 0, s45
    s_add_u32 s44, s44, 16384
    s_cmp_ge_u32 s44, 65536
    s_cselect_b32 s44, 0, s44

    s_sub_u32 s52, s60, 7
L_sequential_preLN__sliding_block__glu_gated_bilinear__prompt_kernel_Dlloop_134:
    s_waitcnt vmcnt(16)
    s_barrier
    s_add_u32 s3, s45, s59
    s_lshl_b32 s47, s3, 14
    s_lshl_b32 s4, s43, 12
    s_add_u32 m0, s4, s44
    s_nop 0
    buffer_load_dwordx4 v4, s[8:11], s47 offen offset:0 sc1 lds
    buffer_load_dwordx4 v4, s[8:11], s47 offen offset:1024 sc1 lds
    buffer_load_dwordx4 v4, s[8:11], s47 offen offset:2048 sc1 lds
    buffer_load_dwordx4 v4, s[8:11], s47 offen offset:3072 sc1 lds
    s_add_u32 s3, s45, s59
    s_lshl_b32 s48, s3, 17
    s_lshl_b32 s4, s43, 12
    s_add_u32 s4, s4, s44
    s_add_u32 m0, s4, 65536
    s_nop 0
    buffer_load_dwordx4 v8, s[12:15], s48 offen offset:0 lds
    buffer_load_dwordx4 v9, s[12:15], s48 offen offset:1024 lds
    buffer_load_dwordx4 v10, s[12:15], s48 offen offset:2048 lds
    buffer_load_dwordx4 v11, s[12:15], s48 offen offset:3072 lds

    s_add_u32 s45, s45, 1
    s_cmp_ge_u32 s45, s60
    s_cselect_b32 s45, 0, s45
    s_add_u32 s44, s44, 16384
    s_cmp_ge_u32 s44, 65536
    s_cselect_b32 s44, 0, s44

    s_sub_u32 s52, s52, 1
    s_cmp_lg_u32 s52, 0
    s_cbranch_scc1 L_sequential_preLN__sliding_block__glu_gated_bilinear__prompt_kernel_Dlloop_134
    s_waitcnt vmcnt(16)
    s_barrier
    s_waitcnt vmcnt(8)
    s_cmp_eq_u32 s40, 7
    s_cbranch_scc0 L_sequential_preLN__sliding_block__glu_gated_bilinear__prompt_kernel_Dnopp_135
    s_cmp_eq_u32 s57, 0
    s_cbranch_scc0 L_sequential_preLN__sliding_block__glu_gated_bilinear__prompt_kernel_Dnopp_135
    s_lshl_b32 s3, s41, 3
    s_lshr_b32 s4, s42, 1
    s_add_u32 s3, s3, s4
    s_lshl_b32 s3, s3, 7
    s_add_u32 s49, s3, 524288
    s_mov_b64 s[50:51], 1
    v_mbcnt_lo_u32_b32 v30, -1, 0
    v_mbcnt_hi_u32_b32 v30, -1, v30

    v_lshlrev_b32 v30, 7, v30
    v_add_u32 v30, s49, v30
    v_mov_b32 v31, 0x7fff0000
    v_cndmask_b32 v30, v31, v30, s[50:51]
    s_mov_b32 s63, 0

    buffer_load_dword v31, v30, s[28:31], 0 offen sc1
L_sequential_preLN__sliding_block__glu_gated_bilinear__prompt_kernel_poll_136:
    buffer_load_dword v32, v30, s[28:31], 0 offen sc1
    s_waitcnt vmcnt(1)
    v_cmp_eq_u32 vcc, s62, v31
    s_nop 1
    s_and_b64 s[6:7], vcc, s[50:51]
    s_cmp_eq_u64 s[6:7], s[50:51]
    s_cbranch_scc1 L_sequential_preLN__sliding_block__glu_gated_bilinear__prompt_kernel_polld_137
    buffer_load_dword v31, v30, s[28:31], 0 offen sc1
    s_waitcnt vmcnt(1)
    v_cmp_eq_u32 vcc, s62, v32
    s_nop 1
    s_and_b64 s[6:7], vcc, s[50:51]
    s_cmp_eq_u64 s[6:7], s[50:51]
    s_cbranch_scc1 L_sequential_preLN__sliding_block__glu_gated_bilinear__prompt_kernel_polld_137
    s_add_u32 s63, s63, 1
    s_cmp_lt_u32 s63, 40000
    s_cbranch_scc1 L_sequential_preLN__sliding_block__glu_gated_bilinear__prompt_kernel_poll_136
L_sequential_preLN__sliding_block__glu_gated_bilinear__prompt_kernel_polld_137:

L_sequential_preLN__sliding_block__glu_gated_bilinear__prompt_kernel_Dnopp_135:
    s_barrier
    s_waitcnt vmcnt(0)
    s_barrier
    s_waitcnt vmcnt(0)
    s_barrier
    s_cmp_eq_u32 s57, 0
    s_cbranch_scc1 L_sequential_preLN__sliding_block__glu_gated_bilinear__prompt_kernel_Dcopy_130
L_sequential_preLN__sliding_block__glu_gated_bilinear__prompt_kernel_Dend_121:
    s_barrier
    s_cmp_eq_u32 s40, 6
    s_cbranch_scc0 L_sequential_preLN__sliding_block__glu_gated_bilinear__prompt_kernel_nopub_138
    s_lshl_b32 s3, s41, 3
    s_lshr_b32 s4, s42, 1
    s_add_u32 s3, s3, s4
    s_lshl_b32 s3, s3, 7
    s_add_u32 s47, s3, 524288

    v_mov_b32 v30, s47
    v_mov_b32 v31, s62
    s_mov_b64 exec, 1
    buffer_store_dword v31, v30, s[28:31], 0 offen sc1
    s_mov_b64 exec, -1

L_sequential_preLN__sliding_block__glu_gated_bilinear__prompt_kernel_nopub_138:
    s_branch L_sequential_preLN__sliding_block__glu_gated_bilinear__prompt_kernel_Dfin_122
L_sequential_preLN__sliding_block__glu_gated_bilinear__prompt_kernel_Dcopy_130:
    s_mov_b32 s20, s78
    s_mov_b32 s21, s79
    s_mov_b32 s22, 4194304
    s_mov_b32 s23, 0x20000
    v_mbcnt_lo_u32_b32 v120, -1, 0
    v_mbcnt_hi_u32_b32 v120, -1, v120

    v_lshrrev_b32 v121, 4, v120
    s_lshl_b32 s3, s40, 4
    v_add_u32 v121, s3, v121
    v_and_b32 v122, 15, v120
    v_lshlrev_b32 v123, 8, v121
    v_lshl_add_u32 v123, v122, 4, v123
    s_lshl_b32 s3, s41, 7
    s_lshr_b32 s4, s42, 1
    s_lshl_b32 s4, s4, 8

    v_add_u32 v124, 0, v121
    v_and_b32 v125, 15, v124
    v_xor_b32 v125, v125, v122
    v_add_u32 v124, s3, v124
    v_lshlrev_b32 v124, 11, v124
    v_lshl_add_u32 v124, v125, 4, v124
    v_add_u32 v128, s4, v124

    v_add_u32 v124, 4, v121
    v_and_b32 v125, 15, v124
    v_xor_b32 v125, v125, v122
    v_add_u32 v124, s3, v124
    v_lshlrev_b32 v124, 11, v124
    v_lshl_add_u32 v124, v125, 4, v124
    v_add_u32 v129, s4, v124

    v_add_u32 v124, 8, v121
    v_and_b32 v125, 15, v124
    v_xor_b32 v125, v125, v122
    v_add_u32 v124, s3, v124
    v_lshlrev_b32 v124, 11, v124
    v_lshl_add_u32 v124, v125, 4, v124
    v_add_u32 v130, s4, v124

    v_add_u32 v124, 12, v121
    v_and_b32 v125, 15, v124
    v_xor_b32 v125, v125, v122
    v_add_u32 v124, s3, v124
    v_lshlrev_b32 v124, 11, v124
    v_lshl_add_u32 v124, v125, 4, v124
    v_add_u32 v131, s4, v124

    s_barrier
    ds_read_b128 v[132:135], v123 offset:0
    ds_read_b128 v[136:139], v123 offset:1024
    ds_read_b128 v[140:143], v123 offset:2048
    ds_read_b128 v[144:147], v123 offset:3072
    s_waitcnt lgkmcnt(3)
    buffer_store_dwordx4 v[132:135], v128, s[20:23], 0 offen
    s_waitcnt lgkmcnt(2)
    buffer_store_dwordx4 v[136:139], v129, s[20:23], 0 offen
    s_waitcnt lgkmcnt(1)
    buffer_store_dwordx4 v[140:143], v130, s[20:23], 0 offen
    s_waitcnt lgkmcnt(0)
    buffer_store_dwordx4 v[144:147], v131, s[20:23], 0 offen
L_sequential_preLN__sliding_block__glu_gated_bilinear__prompt_kernel_Dfin_122:
L_end_sequential_preLN__sliding_block__glu_gated_bilinear__prompt_kernel:
    s_endpgm
.section .rodata,"a"
.p2align 6
.amdhsa_kernel sequential_preLN__sliding_block__glu_gated_bilinear__prompt_kernel
  .amdhsa_next_free_vgpr 256
  .amdhsa_next_free_sgpr 102
  .amdhsa_accum_offset 168
  .amdhsa_group_segment_fixed_size 0
  .amdhsa_kernarg_size 80
  .amdhsa_user_sgpr_count 2
  .amdhsa_user_sgpr_kernarg_segment_ptr 1
  .amdhsa_system_sgpr_workgroup_id_x 1
  .amdhsa_float_denorm_mode_32 3
.end_amdhsa_kernel
```
